```python
import torch

def _softmax(x, axis=-1):
    return torch.softmax(x, dim=axis)
def _gelu(x):
    return torch.nn.functional.gelu(x, approximate="tanh")
def _silu(x):
    return torch.nn.functional.silu(x)
def _sigmoid(x):
    return torch.sigmoid(x)
def _layernorm(x, axis=-1, eps=1e-5):
    m = x.mean(dim=axis, keepdim=True)
    v = x.var(dim=axis, keepdim=True, unbiased=False)
    return (x - m) / torch.sqrt(v + eps)
def _scatter_add(tgt, idx, src, axis=0):
    return tgt.clone().index_add_(axis, idx, src)
def _segment_sum(src, seg, n):
    out = torch.zeros((n,) + src.shape[1:], dtype=src.dtype)
    return out.index_add_(0, seg, src)
def _pad(x, pw):
    flat = tuple(v for pair in reversed(pw) for v in pair)
    return torch.nn.functional.pad(x, flat)

kernel_name = 'gated_mix__ssm_conv_s5__swiglu_ffn__prompt'

def setup_inputs():

    _w = (lambda a: (lambda t: t.to(torch.bfloat16) if t.is_floating_point() else t)(torch.as_tensor(a)))
    def _A_setup():
        B, S, D = 1, 2048, 512
        P = D
        Lambda_re = -0.5 * (lambda _x: torch.exp(torch.as_tensor(_x)))((lambda *s: torch.randn(*s, dtype=torch.bfloat16) * 0.2)(P))
        Lambda_im = (lambda *s: torch.randn(*s, dtype=torch.bfloat16) * 0.4)(P) * 1.0
        B_re = (lambda *s: torch.randn(*s, dtype=torch.bfloat16) * 0.2)(P, D) * (D ** -0.5)
        B_im = (lambda *s: torch.randn(*s, dtype=torch.bfloat16) * 0.2)(P, D) * (D ** -0.5)
        C_re = (lambda *s: torch.randn(*s, dtype=torch.bfloat16) * 0.2)(D, P) * (P ** -0.5)
        C_im = (lambda *s: torch.randn(*s, dtype=torch.bfloat16) * 0.2)(D, P) * (P ** -0.5)
        log_dt = (lambda *s: torch.randn(*s, dtype=torch.bfloat16) * 0.2)(P) * 0.3 - 2.0
        Dskip = (lambda *s: torch.randn(*s, dtype=torch.bfloat16) * 0.05)(D)
        return {
            "x": _w((lambda *s: torch.randn(*s, dtype=torch.bfloat16) * 0.05)(B, S, D)),
            "Lambda_re": _w(Lambda_re),
            "Lambda_im": _w(Lambda_im),
            "B_re": _w(B_re),
            "B_im": _w(B_im),
            "C_re": _w(C_re),
            "C_im": _w(C_im),
            "log_dt": _w(log_dt),
            "Dskip": _w(Dskip),
        }
    _A_in = _A_setup()

    def _B_setup():
        B, S, D, F = 1, 2048, 512, 1792
        return {
            "x": _w((lambda *s: torch.randn(*s, dtype=torch.bfloat16) * 0.05)(B, S, D)),
            "w_gate": _w((lambda *s: torch.randn(*s, dtype=torch.bfloat16) * 0.05)(D, F)),
            "w_up": _w((lambda *s: torch.randn(*s, dtype=torch.bfloat16) * 0.05)(D, F)),
            "w_down": _w((lambda *s: torch.randn(*s, dtype=torch.bfloat16) * 0.05)(F, D)),
        }
    _B_in = _B_setup()

    return {
        "A_x": _A_in["x"],
        "A_Lambda_re": _A_in["Lambda_re"],
        "A_Lambda_im": _A_in["Lambda_im"],
        "A_B_re": _A_in["B_re"],
        "A_B_im": _A_in["B_im"],
        "A_C_re": _A_in["C_re"],
        "A_C_im": _A_in["C_im"],
        "A_log_dt": _A_in["log_dt"],
        "A_Dskip": _A_in["Dskip"],
        "B_x": _B_in["x"],
        "B_w_gate": _B_in["w_gate"],
        "B_w_up": _B_in["w_up"],
        "B_w_down": _B_in["w_down"],
        "gate_w": _w((lambda *s: torch.randn(*s, dtype=torch.bfloat16) * 0.05)(512) * 16.0),
    }

def reference(A_x, A_Lambda_re, A_Lambda_im, A_B_re, A_B_im, A_C_re, A_C_im, A_log_dt, A_Dskip, B_x, B_w_gate, B_w_up, B_w_down, gate_w):
    def _A_ref(x, Lambda_re, Lambda_im, B_re, B_im, C_re, C_im, log_dt, Dskip):
        Bsz, L, H = x.shape
        Lam = Lambda_re + 1j * Lambda_im
        Bmat = B_re + 1j * B_im
        Cmat = C_re + 1j * C_im
        dt = torch.exp(log_dt)
        Lam_bar = torch.exp(dt * Lam)
        B_bar = ((Lam_bar - 1.0) / Lam)[:, None] * Bmat
        Bu = torch.einsum("bld,pd->blp", x + 0j, B_bar)
        h = torch.zeros_like(Bu[:, 0, :])
        hs = []
        for t in range(L):
            h = Lam_bar[None, :] * h + Bu[:, t, :]
            hs.append(h)
        hseq = torch.stack(hs, 1)
        y = 2.0 * torch.einsum("blp,dp->bld", hseq, Cmat).real + x * Dskip[None, None, :]
        return y

    def _B_ref(x, w_gate, w_up, w_down):
        g = _silu(x @ w_gate)
        u = x @ w_up
        return (g * u) @ w_down

    x = A_x
    g = _sigmoid((x * gate_w).sum(-1, keepdims=True))
    a = _A_ref(x, A_Lambda_re, A_Lambda_im, A_B_re, A_B_im, A_C_re, A_C_im, A_log_dt, A_Dskip)
    b = _B_ref(x, B_w_gate, B_w_up, B_w_down)
    return g * a + (1 - g) * b
```

```asm
; @launch grid=(256,1,1) block=(512,1,1) lds=163840
.amdgcn_target "amdgcn-amd-amdhsa--gfx950"
.text
.globl gated_mix__ssm_conv_s5__swiglu_ffn__prompt_kernel
.p2align 8
.type gated_mix__ssm_conv_s5__swiglu_ffn__prompt_kernel,@function
gated_mix__ssm_conv_s5__swiglu_ffn__prompt_kernel:
    s_cmp_ge_u32 s2, 256
    s_cbranch_scc1 L_exit
    s_load_dwordx16 s[16:31], s[0:1], 0
    s_load_dwordx16 s[32:47], s[0:1], 64
    s_load_dwordx2 s[48:49], s[0:1], 128
    s_getpc_b64 s[4:5]
L_pc:
    s_lshr_b32 s6, s2, 3
    s_lshl_b32 s6, s6, 4
    v_and_b32 v2, 15, v0
    v_add_u32 v2, s6, v2
    v_lshlrev_b32 v2, 7, v2
    v_min_u32 v2, L_code_end-L_pc-4, v2
    v_cmp_gt_u32 vcc, 16, v0
    s_and_saveexec_b64 s[8:9], vcc
    s_cbranch_execz L_nopf
    global_load_dword v223, v2, s[4:5]
L_nopf:
    s_mov_b64 exec, s[8:9]
    v_lshrrev_b32 v1, 6, v0
    v_and_b32 v0, 63, v0
    v_readfirstlane_b32 s3, v1
    s_and_b32 s12, s2, 7
    s_lshr_b32 s13, s2, 3
    s_lshr_b32 s7, s12, 1
    s_and_b32 s14, s12, 1
    s_lshl_b32 s15, s14, 3
    s_and_b32 s6, s13, 7
    s_add_u32 s6, s6, s15
    s_lshr_b32 s8, s13, 3
    s_and_b32 s4, s3, 3
    s_lshr_b32 s5, s3, 2
    s_lshl_b32 s50, s7, 3
    s_and_b32 s15, s13, 7
    s_add_u32 s50, s50, s15
    s_lshl_b32 s51, s14, 2
    s_add_u32 s51, s51, s8
    s_mul_i32 s9, s7, 7
    s_lshl_b32 s14, s8, 1
    s_add_u32 s9, s9, s14
    s_add_u32 s10, s9, 1
    s_cmp_eq_u32 s8, 3
    s_cselect_b32 s10, s9, s10
    s_lshl_b32 s11, s7, 3
    s_add_u32 s11, s11, s8
    s_lshl_b32 s85, s7, 2
    s_add_u32 s85, s85, s8
    s_cmp_eq_u32 s8, 3
    s_cselect_b32 s12, 2, 0
    s_add_u32 s12, s12, s5
    s_cmp_eq_u32 s12, 1
    s_cbranch_scc1 L_X1
    s_cmp_eq_u32 s12, 2
    s_cbranch_scc1 L_Y0
    s_cmp_eq_u32 s12, 3
    s_cbranch_scc1 L_Y1
    v_lshrrev_b32 v96, 3, v0
    v_and_b32 v97, 7, v0
    v_lshrrev_b32 v98, 4, v0
    v_lshrrev_b32 v99, 5, v0
    v_and_b32 v100, 31, v0
    v_and_b32 v101, 1, v98
    v_lshlrev_b32 v101, 1, v101
    v_xor_b32 v101, v101, v97
    v_lshlrev_b32 v101, 4, v101
    v_mul_u32_u24 v102, 3584, v96
    v_add_u32 v101, v101, v102
    v_lshlrev_b32 v23, 4, v0
    s_lshr_b32 s12, s4, 1
    s_lshl_b32 s12, s12, 2
    v_xor_b32 v110, v97, v98
    v_xor_b32 v110, s12, v110
    v_lshlrev_b32 v110, 4, v110
    v_lshl_add_u32 v110, v96, 10, v110
    s_lshl_b32 s12, s11, 14
    s_and_b32 s13, s4, 1
    s_lshl_b32 s13, s13, 13
    s_add_u32 s12, s12, s13
    v_add_u32 v1, s12, v110
    s_lshl_b32 s78, s4, 10
    s_mul_i32 s12, s4, 57344
    s_lshl_b32 s13, s9, 7
    s_add_u32 s12, s12, s13
    v_add_u32 v2, s12, v101
    v_add_u32 v3, 27648, v2
    v_xor_b32 v4, 64, v2
    v_xor_b32 v5, 64, v3
    s_lshr_b32 s79, s4, 1
    s_lshl_b32 s79, s79, 14
    s_and_b32 s12, s4, 1
    s_lshl_b32 s12, s12, 11
    s_add_u32 s79, s79, s12
    s_waitcnt lgkmcnt(0)
    s_cmp_lt_u32 s4, 2
    s_cselect_b32 s56, s22, s24
    s_cselect_b32 s57, s23, s25
    s_and_b32 s57, s57, 0xffff
    s_mov_b32 s58, 524288
    s_mov_b32 s59, 0x00020000
    s_mov_b32 s60, s36
    s_and_b32 s61, s37, 0xffff
    s_mov_b32 s62, 1835008
    s_mov_b32 s63, 0x00020000
    s_mov_b32 s64, s38
    s_and_b32 s65, s39, 0xffff
    s_mov_b32 s66, 1835008
    s_mov_b32 s67, 0x00020000
    s_lshl_b32 s1, s8, 1
    s_add_u32 s1, s1, s6
    s_and_b32 s1, s1, 7
    s_add_u32 m0, s78, 131072
    s_add_u32 s76, s1, 0
    s_and_b32 s76, s76, 7
    s_mul_i32 s76, s76, 128
    buffer_load_dwordx4 v1, s[56:59], s76 offen lds
    s_add_u32 m0, s79, 65536
    s_mul_i32 s77, s76, 1792
    buffer_load_dwordx4 v2, s[60:63], s77 offen lds
    buffer_load_dwordx4 v3, s[60:63], s77 offen offset:1024 lds
    s_add_u32 m0, s79, 98304
    s_nop 0
    buffer_load_dwordx4 v4, s[64:67], s77 offen lds
    buffer_load_dwordx4 v5, s[64:67], s77 offen offset:1024 lds
    s_branch L_body_X0
L_X1:
    s_setprio 1
    v_lshrrev_b32 v96, 3, v0
    v_and_b32 v97, 7, v0
    v_lshrrev_b32 v98, 4, v0
    v_lshrrev_b32 v99, 5, v0
    v_and_b32 v100, 31, v0
    v_and_b32 v101, 1, v98
    v_lshlrev_b32 v101, 1, v101
    v_xor_b32 v101, v101, v97
    v_lshlrev_b32 v101, 4, v101
    v_mul_u32_u24 v102, 3584, v96
    v_add_u32 v101, v101, v102
    v_lshlrev_b32 v23, 4, v0
    v_bfe_u32 v110, v0, 3, 2
    v_lshl_add_u32 v110, v99, 4, v110
    v_xor_b32 v111, v97, v98
    v_lshlrev_b32 v111, 4, v111
    v_lshl_add_u32 v110, v110, 10, v111
    s_lshl_b32 s12, s6, 17
    s_lshl_b32 s13, s4, 15
    s_add_u32 s12, s12, s13
    v_add_u32 v1, s12, v110
    v_xor_b32 v110, 64, v1
    v_add_u32 v2, 3072, v110
    v_add_u32 v3, 6144, v1
    v_add_u32 v4, 9216, v110
    s_lshl_b32 s78, s4, 14
    s_waitcnt lgkmcnt(0)
    s_mov_b32 s52, s16
    s_and_b32 s53, s17, 0xffff
    s_mov_b32 s54, 2097152
    s_mov_b32 s55, 0x00020000
    s_lshl_b32 s1, s8, 1
    s_add_u32 s1, s1, s6
    s_and_b32 s1, s1, 7
    s_add_u32 m0, s78, 0
    s_add_u32 s76, s1, 0
    s_and_b32 s76, s76, 7
    s_mul_i32 s76, s76, 128
    buffer_load_dwordx4 v1, s[52:55], s76 offen lds
    buffer_load_dwordx4 v2, s[52:55], s76 offen offset:1024 lds
    buffer_load_dwordx4 v3, s[52:55], s76 offen offset:2048 lds
    buffer_load_dwordx4 v4, s[52:55], s76 offen offset:3072 lds
    s_branch L_body_X1
L_Y0:
    v_lshrrev_b32 v96, 3, v0
    v_and_b32 v97, 7, v0
    v_lshrrev_b32 v98, 4, v0
    v_lshrrev_b32 v99, 5, v0
    v_and_b32 v100, 31, v0
    v_and_b32 v101, 1, v98
    v_lshlrev_b32 v101, 1, v101
    v_xor_b32 v101, v101, v97
    v_lshlrev_b32 v101, 4, v101
    v_mul_u32_u24 v102, 3584, v96
    v_add_u32 v101, v101, v102
    v_lshlrev_b32 v23, 4, v0
    s_lshr_b32 s12, s4, 1
    s_lshl_b32 s12, s12, 2
    v_xor_b32 v110, v97, v98
    v_xor_b32 v110, s12, v110
    v_lshlrev_b32 v110, 4, v110
    v_lshl_add_u32 v110, v96, 10, v110
    s_lshl_b32 s12, s11, 14
    s_and_b32 s13, s4, 1
    s_lshl_b32 s13, s13, 13
    s_add_u32 s12, s12, s13
    v_add_u32 v1, s12, v110
    s_lshl_b32 s78, s4, 10
    s_waitcnt lgkmcnt(0)
    s_cmp_lt_u32 s4, 2
    s_cselect_b32 s56, s22, s24
    s_cselect_b32 s57, s23, s25
    s_and_b32 s57, s57, 0xffff
    s_mov_b32 s58, 524288
    s_mov_b32 s59, 0x00020000
    s_lshl_b32 s1, s8, 1
    s_add_u32 s1, s1, s6
    s_and_b32 s1, s1, 7
    s_add_u32 m0, s78, 65536
    s_add_u32 s76, s1, 0
    s_and_b32 s76, s76, 7
    s_mul_i32 s76, s76, 128
    buffer_load_dwordx4 v1, s[56:59], s76 offen lds
    s_add_u32 m0, s78, 81920
    s_add_u32 s76, s76, 16384
    buffer_load_dwordx4 v1, s[56:59], s76 offen lds
    s_add_u32 m0, s78, 98304
    s_add_u32 s76, s76, 16384
    buffer_load_dwordx4 v1, s[56:59], s76 offen lds
    s_add_u32 m0, s78, 114688
    s_add_u32 s76, s76, 16384
    buffer_load_dwordx4 v1, s[56:59], s76 offen lds
    s_add_u32 m0, s78, 131072
    s_add_u32 s76, s76, 16384
    buffer_load_dwordx4 v1, s[56:59], s76 offen lds
    s_branch L_body_Y0
L_Y1:
    s_setprio 1
    v_lshrrev_b32 v96, 3, v0
    v_and_b32 v97, 7, v0
    v_lshrrev_b32 v98, 4, v0
    v_lshrrev_b32 v99, 5, v0
    v_and_b32 v100, 31, v0
    v_and_b32 v101, 1, v98
    v_lshlrev_b32 v101, 1, v101
    v_xor_b32 v101, v101, v97
    v_lshlrev_b32 v101, 4, v101
    v_mul_u32_u24 v102, 3584, v96
    v_add_u32 v101, v101, v102
    v_lshlrev_b32 v23, 4, v0
    v_bfe_u32 v110, v0, 3, 2
    v_lshl_add_u32 v110, v99, 4, v110
    v_xor_b32 v111, v97, v98
    v_lshlrev_b32 v111, 4, v111
    v_lshl_add_u32 v110, v110, 10, v111
    s_lshl_b32 s12, s6, 17
    s_lshl_b32 s13, s4, 15
    s_add_u32 s12, s12, s13
    v_add_u32 v1, s12, v110
    v_xor_b32 v110, 64, v1
    v_add_u32 v2, 3072, v110
    v_add_u32 v3, 6144, v1
    v_add_u32 v4, 9216, v110
    s_lshl_b32 s78, s4, 14
    s_waitcnt lgkmcnt(0)
    s_mov_b32 s52, s16
    s_and_b32 s53, s17, 0xffff
    s_mov_b32 s54, 2097152
    s_mov_b32 s55, 0x00020000
    s_lshl_b32 s1, s8, 1
    s_add_u32 s1, s1, s6
    s_and_b32 s1, s1, 7
    s_add_u32 m0, s78, 0
    s_add_u32 s76, s1, 0
    s_and_b32 s76, s76, 7
    s_mul_i32 s76, s76, 128
    buffer_load_dwordx4 v1, s[52:55], s76 offen lds
    buffer_load_dwordx4 v2, s[52:55], s76 offen offset:1024 lds
    buffer_load_dwordx4 v3, s[52:55], s76 offen offset:2048 lds
    buffer_load_dwordx4 v4, s[52:55], s76 offen offset:3072 lds
    s_branch L_body_Y1
L_body_Y1:
    s_mov_b32 s60, s36
    s_and_b32 s61, s37, 0xffff
    s_mov_b32 s62, 1835008
    s_mov_b32 s63, 0x00020000
    s_mov_b32 s64, s38
    s_and_b32 s65, s39, 0xffff
    s_mov_b32 s66, 1835008
    s_mov_b32 s67, 0x00020000
    s_mov_b32 s68, s48
    s_and_b32 s69, s49, 0xffff
    s_mov_b32 s70, 14721024
    s_mov_b32 s71, 0x00020000
    s_mov_b32 s81, 0xbfb8aa3b
    s_barrier
    s_add_u32 m0, s78, 4096
    s_add_u32 s76, s1, 1
    s_and_b32 s76, s76, 7
    s_mul_i32 s76, s76, 128
    buffer_load_dwordx4 v1, s[52:55], s76 offen lds
    buffer_load_dwordx4 v2, s[52:55], s76 offen offset:1024 lds
    buffer_load_dwordx4 v3, s[52:55], s76 offen offset:2048 lds
    buffer_load_dwordx4 v4, s[52:55], s76 offen offset:3072 lds
    s_lshl_b32 s12, s6, 7
    s_lshl_b32 s13, s85, 3
    s_add_u32 s12, s12, s13
    s_add_u32 s12, s12, s3
    s_lshl_b32 s13, s12, 10
    s_lshl_b32 s87, s12, 2
    s_add_u32 s87, s87, 14417920
    v_add_u32 v239, s13, v23
    s_add_u32 s93, s11, s4
    s_lshl_b32 s93, s93, 13
    s_add_u32 s93, s93, 14442496
    s_lshl_b32 s12, s6, 8
    s_add_u32 s93, s93, s12
    s_mul_i32 s12, s4, 57344
    s_lshl_b32 s13, s10, 7
    s_add_u32 s12, s12, s13
    v_add_u32 v6, s12, v101
    v_add_u32 v7, 27648, v6
    v_xor_b32 v8, 64, v6
    v_xor_b32 v9, 64, v7
    v_bfe_u32 v102, v0, 1, 3
    v_xor_b32 v102, v102, v99
    v_lshlrev_b32 v102, 4, v102
    v_lshl_add_u32 v102, v100, 7, v102
    s_lshl_b32 s12, s4, 14
    v_add_u32 v10, s12, v102
    v_xor_b32 v11, 32, v10
    v_xor_b32 v12, 64, v10
    v_xor_b32 v13, 96, v10
    v_bfe_u32 v103, v0, 2, 2
    v_lshl_add_u32 v104, v99, 3, v103
    v_lshlrev_b32 v104, 7, v104
    v_and_b32 v107, 3, v0
    v_lshl_add_u32 v104, v107, 3, v104
    v_and_b32 v105, 1, v98
    v_lshrrev_b32 v106, 1, v103
    v_lshl_add_u32 v106, v105, 1, v106
    v_lshl_add_u32 v104, v106, 5, v104
    v_lshl_add_u32 v106, v105, 16, v104
    v_xor_b32 v21, 64, v106
    v_xor_b32 v22, 32, v21
    v_and_b32 v108, 1, v0
    v_lshrrev_b32 v109, 1, v100
    v_lshl_add_u32 v109, v108, 4, v109
    v_bfe_u32 v110, v109, 1, 2
    v_lshl_add_u32 v110, v108, 2, v110
    v_xor_b32 v110, v110, v99
    v_lshlrev_b32 v110, 4, v110
    v_lshl_add_u32 v110, v109, 7, v110
    v_add_u32 v14, 98304, v110
    v_xor_b32 v15, 32, v14
    v_xor_b32 v16, 64, v14
    v_xor_b32 v17, 96, v14
    s_lshr_b32 s80, s3, 1
    s_lshl_b32 s80, s80, 14
    s_and_b32 s12, s3, 1
    s_lshl_b32 s12, s12, 11
    s_add_u32 s80, s80, s12
    s_lshl_b32 s94, s3, 14
    s_lshl_b32 s12, s6, 2
    s_add_u32 s12, s12, s4
    s_mul_i32 s12, s12, 180224
    s_lshl_b32 s13, s9, 12
    s_add_u32 s82, s12, s13
    s_lshl_b32 s13, s10, 12
    s_add_u32 s83, s12, s13
    s_lshl_b32 s13, s11, 11
    s_add_u32 s84, s12, s13
    s_add_u32 s84, s84, 114688
    s_mul_i32 s35, s50, 360448
    s_mul_i32 s12, s4, 28672
    s_add_u32 s35, s35, s12
    s_mul_i32 s95, s4, 458752
    s_lshl_b32 s12, s51, 7
    s_add_u32 s95, s95, s12
    s_mov_b32 s72, s40
    s_and_b32 s73, s41, 0xffff
    s_mov_b32 s74, 1835008
    s_mov_b32 s75, 0x00020000
    s_add_u32 m0, s78, 8192
    s_add_u32 s76, s1, 2
    s_and_b32 s76, s76, 7
    s_mul_i32 s76, s76, 128
    buffer_load_dwordx4 v1, s[52:55], s76 offen lds
    buffer_load_dwordx4 v2, s[52:55], s76 offen offset:1024 lds
    buffer_load_dwordx4 v3, s[52:55], s76 offen offset:2048 lds
    buffer_load_dwordx4 v4, s[52:55], s76 offen offset:3072 lds
    s_waitcnt vmcnt(8)
    s_barrier
    ds_read_b128 v[128:131], v10 offset:0
    ds_read_b128 v[24:27], v14 offset:0
    ds_read_b128 v[28:31], v14 offset:16384
    ds_read_b128 v[32:35], v14 offset:32768
    s_waitcnt lgkmcnt(2)
    v_mfma_f32_32x32x16_bf16 v[48:63], v[128:131], v[24:27], 0
    ds_read_b128 v[132:135], v11 offset:0
    ds_read_b128 v[36:39], v15 offset:0
    s_add_u32 m0, s78, 12288
    s_add_u32 s76, s1, 3
    s_and_b32 s76, s76, 7
    s_mul_i32 s76, s76, 128
    buffer_load_dwordx4 v1, s[52:55], s76 offen lds
    s_waitcnt lgkmcnt(3)
    v_mfma_f32_32x32x16_bf16 v[64:79], v[128:131], v[28:31], 0
    ds_read_b128 v[40:43], v15 offset:16384
    s_waitcnt lgkmcnt(3)
    v_mfma_f32_32x32x16_bf16 v[80:95], v[128:131], v[32:35], 0
    ds_read_b128 v[44:47], v15 offset:32768
    s_waitcnt lgkmcnt(2)
    v_mfma_f32_32x32x16_bf16 v[48:63], v[132:135], v[36:39], v[48:63]
    ds_read_b128 v[136:139], v12 offset:0
    ds_read_b128 v[24:27], v16 offset:0
    buffer_load_dwordx4 v2, s[52:55], s76 offen offset:1024 lds
    s_waitcnt lgkmcnt(3)
    v_mfma_f32_32x32x16_bf16 v[64:79], v[132:135], v[40:43], v[64:79]
    ds_read_b128 v[28:31], v16 offset:16384
    s_waitcnt lgkmcnt(3)
    v_mfma_f32_32x32x16_bf16 v[80:95], v[132:135], v[44:47], v[80:95]
    ds_read_b128 v[32:35], v16 offset:32768
    s_waitcnt lgkmcnt(2)
    v_mfma_f32_32x32x16_bf16 v[48:63], v[136:139], v[24:27], v[48:63]
    ds_read_b128 v[140:143], v13 offset:0
    ds_read_b128 v[36:39], v17 offset:0
    buffer_load_dwordx4 v3, s[52:55], s76 offen offset:2048 lds
    s_waitcnt lgkmcnt(3)
    v_mfma_f32_32x32x16_bf16 v[64:79], v[136:139], v[28:31], v[64:79]
    ds_read_b128 v[40:43], v17 offset:16384
    s_waitcnt lgkmcnt(3)
    v_mfma_f32_32x32x16_bf16 v[80:95], v[136:139], v[32:35], v[80:95]
    ds_read_b128 v[44:47], v17 offset:32768
    s_waitcnt vmcnt(7) lgkmcnt(0)
    s_barrier
    v_mfma_f32_32x32x16_bf16 v[48:63], v[140:143], v[36:39], v[48:63]
    ds_read_b128 v[144:147], v10 offset:4096
    ds_read_b128 v[24:27], v14 offset:4096
    buffer_load_dwordx4 v4, s[52:55], s76 offen offset:3072 lds
    v_mfma_f32_32x32x16_bf16 v[64:79], v[140:143], v[40:43], v[64:79]
    ds_read_b128 v[28:31], v14 offset:20480
    s_add_u32 m0, s78, 0
    s_add_u32 s76, s1, 4
    s_and_b32 s76, s76, 7
    s_mul_i32 s76, s76, 128
    buffer_load_dwordx4 v1, s[52:55], s76 offen lds
    v_mfma_f32_32x32x16_bf16 v[80:95], v[140:143], v[44:47], v[80:95]
    ds_read_b128 v[32:35], v14 offset:36864
    buffer_load_dwordx4 v2, s[52:55], s76 offen offset:1024 lds
    s_waitcnt lgkmcnt(2)
    v_mfma_f32_32x32x16_bf16 v[48:63], v[144:147], v[24:27], v[48:63]
    ds_read_b128 v[148:151], v11 offset:4096
    ds_read_b128 v[36:39], v15 offset:4096
    buffer_load_dwordx4 v3, s[52:55], s76 offen offset:2048 lds
    s_waitcnt lgkmcnt(3)
    v_mfma_f32_32x32x16_bf16 v[64:79], v[144:147], v[28:31], v[64:79]
    ds_read_b128 v[40:43], v15 offset:20480
    buffer_load_dwordx4 v4, s[52:55], s76 offen offset:3072 lds
    s_waitcnt lgkmcnt(3)
    v_mfma_f32_32x32x16_bf16 v[80:95], v[144:147], v[32:35], v[80:95]
    ds_read_b128 v[44:47], v15 offset:36864
    buffer_load_dwordx4 v[224:227], v239, s[52:55], 0 offen
    s_waitcnt lgkmcnt(2)
    v_mfma_f32_32x32x16_bf16 v[48:63], v[148:151], v[36:39], v[48:63]
    ds_read_b128 v[152:155], v12 offset:4096
    ds_read_b128 v[24:27], v16 offset:4096
    global_load_dwordx4 v[228:231], v23, s[42:43]
    s_waitcnt lgkmcnt(3)
    v_mfma_f32_32x32x16_bf16 v[64:79], v[148:151], v[40:43], v[64:79]
    ds_read_b128 v[28:31], v16 offset:20480
    s_waitcnt lgkmcnt(3)
    v_mfma_f32_32x32x16_bf16 v[80:95], v[148:151], v[44:47], v[80:95]
    ds_read_b128 v[32:35], v16 offset:36864
    s_waitcnt lgkmcnt(2)
    v_mfma_f32_32x32x16_bf16 v[48:63], v[152:155], v[24:27], v[48:63]
    ds_read_b128 v[156:159], v13 offset:4096
    ds_read_b128 v[36:39], v17 offset:4096
    s_waitcnt lgkmcnt(3)
    v_mfma_f32_32x32x16_bf16 v[64:79], v[152:155], v[28:31], v[64:79]
    ds_read_b128 v[40:43], v17 offset:20480
    s_waitcnt lgkmcnt(3)
    v_mfma_f32_32x32x16_bf16 v[80:95], v[152:155], v[32:35], v[80:95]
    ds_read_b128 v[44:47], v17 offset:36864
    s_waitcnt vmcnt(10) lgkmcnt(0)
    s_barrier
    v_mfma_f32_32x32x16_bf16 v[48:63], v[156:159], v[36:39], v[48:63]
    ds_read_b128 v[160:163], v10 offset:8192
    ds_read_b128 v[24:27], v14 offset:8192
    s_add_u32 m0, s78, 4096
    s_add_u32 s76, s1, 5
    s_and_b32 s76, s76, 7
    s_mul_i32 s76, s76, 128
    buffer_load_dwordx4 v1, s[52:55], s76 offen lds
    v_mfma_f32_32x32x16_bf16 v[64:79], v[156:159], v[40:43], v[64:79]
    ds_read_b128 v[28:31], v14 offset:24576
    v_mfma_f32_32x32x16_bf16 v[80:95], v[156:159], v[44:47], v[80:95]
    ds_read_b128 v[32:35], v14 offset:40960
    s_waitcnt lgkmcnt(2)
    v_mfma_f32_32x32x16_bf16 v[48:63], v[160:163], v[24:27], v[48:63]
    ds_read_b128 v[164:167], v11 offset:8192
    ds_read_b128 v[36:39], v15 offset:8192
    buffer_load_dwordx4 v2, s[52:55], s76 offen offset:1024 lds
    s_waitcnt lgkmcnt(3)
    v_mfma_f32_32x32x16_bf16 v[64:79], v[160:163], v[28:31], v[64:79]
    ds_read_b128 v[40:43], v15 offset:24576
    s_waitcnt lgkmcnt(3)
    v_mfma_f32_32x32x16_bf16 v[80:95], v[160:163], v[32:35], v[80:95]
    ds_read_b128 v[44:47], v15 offset:40960
    s_waitcnt lgkmcnt(2)
    v_mfma_f32_32x32x16_bf16 v[48:63], v[164:167], v[36:39], v[48:63]
    ds_read_b128 v[168:171], v12 offset:8192
    ds_read_b128 v[24:27], v16 offset:8192
    buffer_load_dwordx4 v3, s[52:55], s76 offen offset:2048 lds
    s_waitcnt lgkmcnt(3)
    v_mfma_f32_32x32x16_bf16 v[64:79], v[164:167], v[40:43], v[64:79]
    ds_read_b128 v[28:31], v16 offset:24576
    s_waitcnt lgkmcnt(3)
    v_mfma_f32_32x32x16_bf16 v[80:95], v[164:167], v[44:47], v[80:95]
    ds_read_b128 v[32:35], v16 offset:40960
    s_waitcnt lgkmcnt(2)
    v_mfma_f32_32x32x16_bf16 v[48:63], v[168:171], v[24:27], v[48:63]
    ds_read_b128 v[172:175], v13 offset:8192
    ds_read_b128 v[36:39], v17 offset:8192
    buffer_load_dwordx4 v4, s[52:55], s76 offen offset:3072 lds
    s_waitcnt vmcnt(4)
    v_lshlrev_b32 v96, 16, v224
    v_and_b32 v97, 0xffff0000, v224
    s_waitcnt lgkmcnt(3)
    v_mfma_f32_32x32x16_bf16 v[64:79], v[168:171], v[28:31], v[64:79]
    ds_read_b128 v[40:43], v17 offset:24576
    v_lshlrev_b32 v104, 16, v228
    v_and_b32 v105, 0xffff0000, v228
    s_waitcnt lgkmcnt(3)
    v_mfma_f32_32x32x16_bf16 v[80:95], v[168:171], v[32:35], v[80:95]
    ds_read_b128 v[44:47], v17 offset:40960
    v_lshlrev_b32 v98, 16, v225
    v_and_b32 v99, 0xffff0000, v225
    s_waitcnt lgkmcnt(0)
    s_barrier
    v_mfma_f32_32x32x16_bf16 v[48:63], v[172:175], v[36:39], v[48:63]
    ds_read_b128 v[176:179], v10 offset:12288
    ds_read_b128 v[24:27], v14 offset:12288
    s_add_u32 m0, s78, 8192
    s_add_u32 s76, s1, 6
    s_and_b32 s76, s76, 7
    s_mul_i32 s76, s76, 128
    buffer_load_dwordx4 v1, s[52:55], s76 offen lds
    v_lshlrev_b32 v106, 16, v229
    v_and_b32 v107, 0xffff0000, v229
    v_mfma_f32_32x32x16_bf16 v[64:79], v[172:175], v[40:43], v[64:79]
    ds_read_b128 v[28:31], v14 offset:28672
    v_lshlrev_b32 v100, 16, v226
    v_and_b32 v101, 0xffff0000, v226
    v_mfma_f32_32x32x16_bf16 v[80:95], v[172:175], v[44:47], v[80:95]
    ds_read_b128 v[32:35], v14 offset:45056
    v_lshlrev_b32 v108, 16, v230
    v_and_b32 v109, 0xffff0000, v230
    s_waitcnt lgkmcnt(2)
    v_mfma_f32_32x32x16_bf16 v[48:63], v[176:179], v[24:27], v[48:63]
    ds_read_b128 v[180:183], v11 offset:12288
    ds_read_b128 v[36:39], v15 offset:12288
    buffer_load_dwordx4 v2, s[52:55], s76 offen offset:1024 lds
    v_lshlrev_b32 v102, 16, v227
    v_and_b32 v103, 0xffff0000, v227
    s_waitcnt lgkmcnt(3)
    v_mfma_f32_32x32x16_bf16 v[64:79], v[176:179], v[28:31], v[64:79]
    ds_read_b128 v[40:43], v15 offset:28672
    v_lshlrev_b32 v110, 16, v231
    v_and_b32 v111, 0xffff0000, v231
    s_waitcnt lgkmcnt(3)
    v_mfma_f32_32x32x16_bf16 v[80:95], v[176:179], v[32:35], v[80:95]
    ds_read_b128 v[44:47], v15 offset:45056
    v_mul_f32 v96, v96, v104
    v_mul_f32 v97, v97, v105
    s_waitcnt lgkmcnt(2)
    v_mfma_f32_32x32x16_bf16 v[48:63], v[180:183], v[36:39], v[48:63]
    ds_read_b128 v[184:187], v12 offset:12288
    ds_read_b128 v[24:27], v16 offset:12288
    buffer_load_dwordx4 v3, s[52:55], s76 offen offset:2048 lds
    v_mul_f32 v98, v98, v106
    v_mul_f32 v99, v99, v107
    s_waitcnt lgkmcnt(3)
    v_mfma_f32_32x32x16_bf16 v[64:79], v[180:183], v[40:43], v[64:79]
    ds_read_b128 v[28:31], v16 offset:28672
    v_mul_f32 v100, v100, v108
    v_mul_f32 v101, v101, v109
    s_waitcnt lgkmcnt(3)
    v_mfma_f32_32x32x16_bf16 v[80:95], v[180:183], v[44:47], v[80:95]
    ds_read_b128 v[32:35], v16 offset:45056
    v_mul_f32 v102, v102, v110
    v_mul_f32 v103, v103, v111
    s_waitcnt lgkmcnt(2)
    v_mfma_f32_32x32x16_bf16 v[48:63], v[184:187], v[24:27], v[48:63]
    ds_read_b128 v[188:191], v13 offset:12288
    ds_read_b128 v[36:39], v17 offset:12288
    buffer_load_dwordx4 v4, s[52:55], s76 offen offset:3072 lds
    v_cvt_pk_bf16_f32 v104, v96, v97
    v_cvt_pk_bf16_f32 v105, v98, v99
    s_waitcnt lgkmcnt(3)
    v_mfma_f32_32x32x16_bf16 v[64:79], v[184:187], v[28:31], v[64:79]
    ds_read_b128 v[40:43], v17 offset:28672
    v_cvt_pk_bf16_f32 v106, v100, v101
    v_cvt_pk_bf16_f32 v107, v102, v103
    s_waitcnt lgkmcnt(3)
    v_mfma_f32_32x32x16_bf16 v[80:95], v[184:187], v[32:35], v[80:95]
    ds_read_b128 v[44:47], v17 offset:45056
    v_lshlrev_b32 v96, 16, v104
    v_and_b32 v97, 0xffff0000, v104
    s_waitcnt lgkmcnt(0)
    s_barrier
    v_mfma_f32_32x32x16_bf16 v[48:63], v[188:191], v[36:39], v[48:63]
    ds_read_b128 v[192:195], v10 offset:0
    ds_read_b128 v[24:27], v14 offset:0
    s_add_u32 m0, s78, 12288
    s_add_u32 s76, s1, 7
    s_and_b32 s76, s76, 7
    s_mul_i32 s76, s76, 128
    buffer_load_dwordx4 v1, s[52:55], s76 offen lds
    v_lshlrev_b32 v98, 16, v105
    v_and_b32 v99, 0xffff0000, v105
    v_mfma_f32_32x32x16_bf16 v[64:79], v[188:191], v[40:43], v[64:79]
    ds_read_b128 v[28:31], v14 offset:16384
    v_lshlrev_b32 v100, 16, v106
    v_and_b32 v101, 0xffff0000, v106
    v_mfma_f32_32x32x16_bf16 v[80:95], v[188:191], v[44:47], v[80:95]
    ds_read_b128 v[32:35], v14 offset:32768
    v_lshlrev_b32 v102, 16, v107
    v_and_b32 v103, 0xffff0000, v107
    s_waitcnt lgkmcnt(2)
    v_mfma_f32_32x32x16_bf16 v[48:63], v[192:195], v[24:27], v[48:63]
    ds_read_b128 v[196:199], v11 offset:0
    ds_read_b128 v[36:39], v15 offset:0
    buffer_load_dwordx4 v2, s[52:55], s76 offen offset:1024 lds
    v_add_f32 v96, v96, v100
    v_add_f32 v97, v97, v101
    s_waitcnt lgkmcnt(3)
    v_mfma_f32_32x32x16_bf16 v[64:79], v[192:195], v[28:31], v[64:79]
    ds_read_b128 v[40:43], v15 offset:16384
    v_add_f32 v98, v98, v102
    v_add_f32 v99, v99, v103
    s_waitcnt lgkmcnt(3)
    v_mfma_f32_32x32x16_bf16 v[80:95], v[192:195], v[32:35], v[80:95]
    ds_read_b128 v[44:47], v15 offset:32768
    v_add_f32 v96, v96, v98
    v_add_f32 v97, v97, v99
    s_waitcnt lgkmcnt(2)
    v_mfma_f32_32x32x16_bf16 v[48:63], v[196:199], v[36:39], v[48:63]
    ds_read_b128 v[200:203], v12 offset:0
    ds_read_b128 v[24:27], v16 offset:0
    buffer_load_dwordx4 v3, s[52:55], s76 offen offset:2048 lds
    v_add_f32 v96, v96, v97
    s_nop 1
    v_add_f32_dpp v97, v96, v96 quad_perm:[1,0,3,2] row_mask:0xf bank_mask:0xf
    s_waitcnt lgkmcnt(3)
    v_mfma_f32_32x32x16_bf16 v[64:79], v[196:199], v[40:43], v[64:79]
    ds_read_b128 v[28:31], v16 offset:16384
    s_nop 1
    v_add_f32_dpp v96, v97, v97 quad_perm:[2,3,0,1] row_mask:0xf bank_mask:0xf
    s_nop 1
    v_add_f32_dpp v97, v96, v96 row_half_mirror row_mask:0xf bank_mask:0xf
    s_waitcnt lgkmcnt(3)
    v_mfma_f32_32x32x16_bf16 v[80:95], v[196:199], v[44:47], v[80:95]
    ds_read_b128 v[32:35], v16 offset:32768
    s_nop 1
    v_add_f32_dpp v96, v97, v97 row_mirror row_mask:0xf bank_mask:0xf
    s_nop 0
    v_readlane_b32 s12, v96, 16
    v_readlane_b32 s13, v96, 32
    v_readlane_b32 s14, v96, 48
    s_nop 1
    v_add_f32 v96, s12, v96
    v_mov_b32 v97, s13
    v_add_f32 v97, s14, v97
    s_waitcnt lgkmcnt(2)
    v_mfma_f32_32x32x16_bf16 v[48:63], v[200:203], v[24:27], v[48:63]
    ds_read_b128 v[204:207], v13 offset:0
    ds_read_b128 v[36:39], v17 offset:0
    buffer_load_dwordx4 v4, s[52:55], s76 offen offset:3072 lds
    v_add_f32 v96, v96, v97
    v_cvt_pk_bf16_f32 v96, v96, v96
    s_waitcnt lgkmcnt(3)
    v_mfma_f32_32x32x16_bf16 v[64:79], v[200:203], v[28:31], v[64:79]
    ds_read_b128 v[40:43], v17 offset:16384
    v_lshlrev_b32 v96, 16, v96
    v_mul_f32 v96, s81, v96
    s_waitcnt lgkmcnt(3)
    v_mfma_f32_32x32x16_bf16 v[80:95], v[200:203], v[32:35], v[80:95]
    ds_read_b128 v[44:47], v17 offset:32768
    v_exp_f32 v96, v96
    s_lshl_b32 s12, s3, 2
    s_add_u32 s12, s12, 161856
    v_mov_b32 v97, s12
    s_waitcnt vmcnt(8) lgkmcnt(0)
    s_barrier
    v_mfma_f32_32x32x16_bf16 v[48:63], v[204:207], v[36:39], v[48:63]
    ds_read_b128 v[208:211], v10 offset:4096
    ds_read_b128 v[24:27], v14 offset:4096
    s_add_u32 m0, s80, 0
    s_add_u32 s77, s1, 1
    s_and_b32 s77, s77, 7
    s_mul_i32 s77, s77, 229376
    buffer_load_dwordx4 v6, s[60:63], s77 offen lds
    v_add_f32 v96, 1.0, v96
    v_rcp_f32 v96, v96
    v_mfma_f32_32x32x16_bf16 v[64:79], v[204:207], v[40:43], v[64:79]
    ds_read_b128 v[28:31], v14 offset:20480
    s_nop 0
    v_cvt_pk_bf16_f32 v96, v96, v96
    v_lshlrev_b32 v96, 16, v96
    v_mfma_f32_32x32x16_bf16 v[80:95], v[204:207], v[44:47], v[80:95]
    ds_read_b128 v[32:35], v14 offset:36864
    s_mov_b64 exec, 1
    ds_write_b32 v97, v96
    s_mov_b64 exec, -1
    s_waitcnt lgkmcnt(3)
    v_mfma_f32_32x32x16_bf16 v[48:63], v[208:211], v[24:27], v[48:63]
    ds_read_b128 v[212:215], v11 offset:4096
    ds_read_b128 v[36:39], v15 offset:4096
    buffer_load_dwordx4 v7, s[60:63], s77 offen offset:1024 lds
    s_waitcnt lgkmcnt(4)
    v_mfma_f32_32x32x16_bf16 v[64:79], v[208:211], v[28:31], v[64:79]
    ds_read_b128 v[40:43], v15 offset:20480
    s_waitcnt lgkmcnt(4)
    v_mfma_f32_32x32x16_bf16 v[80:95], v[208:211], v[32:35], v[80:95]
    ds_read_b128 v[44:47], v15 offset:36864
    v_mov_b32 v240, 161792
    ds_read_b32 v240, v240
    s_waitcnt lgkmcnt(3)
    v_mfma_f32_32x32x16_bf16 v[48:63], v[212:215], v[36:39], v[48:63]
    ds_read_b128 v[216:219], v12 offset:4096
    ds_read_b128 v[24:27], v16 offset:4096
    s_add_u32 m0, s80, 65536
    s_nop 0
    buffer_load_dwordx4 v8, s[64:67], s77 offen lds
    s_waitcnt lgkmcnt(4)
    v_mfma_f32_32x32x16_bf16 v[64:79], v[212:215], v[40:43], v[64:79]
    ds_read_b128 v[28:31], v16 offset:20480
    s_waitcnt lgkmcnt(4)
    v_mfma_f32_32x32x16_bf16 v[80:95], v[212:215], v[44:47], v[80:95]
    ds_read_b128 v[32:35], v16 offset:36864
    s_waitcnt lgkmcnt(4)
    v_readfirstlane_b32 s34, v240
    s_waitcnt lgkmcnt(2)
    v_mfma_f32_32x32x16_bf16 v[48:63], v[216:219], v[24:27], v[48:63]
    ds_read_b128 v[220:223], v13 offset:4096
    ds_read_b128 v[36:39], v17 offset:4096
    buffer_load_dwordx4 v9, s[64:67], s77 offen offset:1024 lds
    s_waitcnt lgkmcnt(3)
    v_mfma_f32_32x32x16_bf16 v[64:79], v[216:219], v[28:31], v[64:79]
    ds_read_b128 v[40:43], v17 offset:20480
    s_waitcnt lgkmcnt(3)
    v_mfma_f32_32x32x16_bf16 v[80:95], v[216:219], v[32:35], v[80:95]
    ds_read_b128 v[44:47], v17 offset:36864
    s_waitcnt vmcnt(8) lgkmcnt(0)
    s_barrier
    v_mfma_f32_32x32x16_bf16 v[48:63], v[220:223], v[36:39], v[48:63]
    ds_read_b128 v[224:227], v10 offset:8192
    ds_read_b128 v[24:27], v14 offset:8192
    s_add_u32 m0, s80, 4096
    s_add_u32 s77, s1, 3
    s_and_b32 s77, s77, 7
    s_mul_i32 s77, s77, 229376
    buffer_load_dwordx4 v6, s[60:63], s77 offen lds
    v_mfma_f32_32x32x16_bf16 v[64:79], v[220:223], v[40:43], v[64:79]
    ds_read_b128 v[28:31], v14 offset:24576
    v_mfma_f32_32x32x16_bf16 v[80:95], v[220:223], v[44:47], v[80:95]
    ds_read_b128 v[32:35], v14 offset:40960
    s_waitcnt lgkmcnt(2)
    v_mfma_f32_32x32x16_bf16 v[48:63], v[224:227], v[24:27], v[48:63]
    ds_read_b128 v[228:231], v11 offset:8192
    ds_read_b128 v[36:39], v15 offset:8192
    buffer_load_dwordx4 v7, s[60:63], s77 offen offset:1024 lds
    s_waitcnt lgkmcnt(3)
    v_mfma_f32_32x32x16_bf16 v[64:79], v[224:227], v[28:31], v[64:79]
    ds_read_b128 v[40:43], v15 offset:24576
    s_waitcnt lgkmcnt(3)
    v_mfma_f32_32x32x16_bf16 v[80:95], v[224:227], v[32:35], v[80:95]
    ds_read_b128 v[44:47], v15 offset:40960
    s_waitcnt lgkmcnt(2)
    v_mfma_f32_32x32x16_bf16 v[48:63], v[228:231], v[36:39], v[48:63]
    ds_read_b128 v[232:235], v12 offset:8192
    ds_read_b128 v[24:27], v16 offset:8192
    s_add_u32 m0, s80, 69632
    s_nop 0
    buffer_load_dwordx4 v8, s[64:67], s77 offen lds
    s_waitcnt lgkmcnt(3)
    v_mfma_f32_32x32x16_bf16 v[64:79], v[228:231], v[40:43], v[64:79]
    ds_read_b128 v[28:31], v16 offset:24576
    s_waitcnt lgkmcnt(3)
    v_mfma_f32_32x32x16_bf16 v[80:95], v[228:231], v[44:47], v[80:95]
    ds_read_b128 v[32:35], v16 offset:40960
    s_waitcnt lgkmcnt(2)
    v_mfma_f32_32x32x16_bf16 v[48:63], v[232:235], v[24:27], v[48:63]
    ds_read_b128 v[236:239], v13 offset:8192
    ds_read_b128 v[36:39], v17 offset:8192
    buffer_load_dwordx4 v9, s[64:67], s77 offen offset:1024 lds
    s_waitcnt lgkmcnt(3)
    v_mfma_f32_32x32x16_bf16 v[64:79], v[232:235], v[28:31], v[64:79]
    ds_read_b128 v[40:43], v17 offset:24576
    s_waitcnt lgkmcnt(3)
    v_mfma_f32_32x32x16_bf16 v[80:95], v[232:235], v[32:35], v[80:95]
    ds_read_b128 v[44:47], v17 offset:40960
    s_waitcnt vmcnt(8) lgkmcnt(0)
    s_barrier
    v_mfma_f32_32x32x16_bf16 v[48:63], v[236:239], v[36:39], v[48:63]
    ds_read_b128 v[240:243], v10 offset:12288
    ds_read_b128 v[24:27], v14 offset:12288
    s_add_u32 m0, s80, 8192
    s_add_u32 s77, s1, 5
    s_and_b32 s77, s77, 7
    s_mul_i32 s77, s77, 229376
    buffer_load_dwordx4 v6, s[60:63], s77 offen lds
    v_mfma_f32_32x32x16_bf16 v[64:79], v[236:239], v[40:43], v[64:79]
    ds_read_b128 v[28:31], v14 offset:28672
    v_mfma_f32_32x32x16_bf16 v[80:95], v[236:239], v[44:47], v[80:95]
    ds_read_b128 v[32:35], v14 offset:45056
    s_waitcnt lgkmcnt(2)
    v_mfma_f32_32x32x16_bf16 v[48:63], v[240:243], v[24:27], v[48:63]
    ds_read_b128 v[244:247], v11 offset:12288
    ds_read_b128 v[36:39], v15 offset:12288
    buffer_load_dwordx4 v7, s[60:63], s77 offen offset:1024 lds
    s_waitcnt lgkmcnt(3)
    v_mfma_f32_32x32x16_bf16 v[64:79], v[240:243], v[28:31], v[64:79]
    ds_read_b128 v[40:43], v15 offset:28672
    s_waitcnt lgkmcnt(3)
    v_mfma_f32_32x32x16_bf16 v[80:95], v[240:243], v[32:35], v[80:95]
    ds_read_b128 v[44:47], v15 offset:45056
    s_waitcnt lgkmcnt(2)
    v_mfma_f32_32x32x16_bf16 v[48:63], v[244:247], v[36:39], v[48:63]
    ds_read_b128 v[248:251], v12 offset:12288
    ds_read_b128 v[24:27], v16 offset:12288
    s_add_u32 m0, s80, 73728
    s_nop 0
    buffer_load_dwordx4 v8, s[64:67], s77 offen lds
    s_waitcnt lgkmcnt(3)
    v_mfma_f32_32x32x16_bf16 v[64:79], v[244:247], v[40:43], v[64:79]
    ds_read_b128 v[28:31], v16 offset:28672
    s_waitcnt lgkmcnt(3)
    v_mfma_f32_32x32x16_bf16 v[80:95], v[244:247], v[44:47], v[80:95]
    ds_read_b128 v[32:35], v16 offset:45056
    s_waitcnt lgkmcnt(2)
    v_mfma_f32_32x32x16_bf16 v[48:63], v[248:251], v[24:27], v[48:63]
    ds_read_b128 v[252:255], v13 offset:12288
    ds_read_b128 v[36:39], v17 offset:12288
    buffer_load_dwordx4 v9, s[64:67], s77 offen offset:1024 lds
    s_waitcnt lgkmcnt(3)
    v_mfma_f32_32x32x16_bf16 v[64:79], v[248:251], v[28:31], v[64:79]
    ds_read_b128 v[40:43], v17 offset:28672
    s_waitcnt lgkmcnt(3)
    v_mfma_f32_32x32x16_bf16 v[80:95], v[248:251], v[32:35], v[80:95]
    ds_read_b128 v[44:47], v17 offset:45056
    s_waitcnt vmcnt(8) lgkmcnt(0)
    s_barrier
    v_mfma_f32_32x32x16_bf16 v[48:63], v[252:255], v[36:39], v[48:63]
    ds_read_b64_tr_b16 v[24:25], v21 offset:0
    ds_read_b64_tr_b16 v[26:27], v21 offset:512
    s_add_u32 m0, s80, 12288
    s_add_u32 s77, s1, 7
    s_and_b32 s77, s77, 7
    s_mul_i32 s77, s77, 229376
    buffer_load_dwordx4 v6, s[60:63], s77 offen lds
    v_mfma_f32_32x32x16_bf16 v[64:79], v[252:255], v[40:43], v[64:79]
    ds_read_b64_tr_b16 v[28:29], v22 offset:0
    ds_read_b64_tr_b16 v[30:31], v22 offset:512
    v_mfma_f32_32x32x16_bf16 v[80:95], v[252:255], v[44:47], v[80:95]
    s_waitcnt lgkmcnt(2)
    v_mfma_f32_32x32x16_bf16 v[96:111], v[24:27], v[128:131], 0
    ds_read_b64_tr_b16 v[32:33], v21 offset:2048
    ds_read_b64_tr_b16 v[34:35], v21 offset:2560
    buffer_load_dwordx4 v7, s[60:63], s77 offen offset:1024 lds
    s_waitcnt lgkmcnt(2)
    v_mfma_f32_32x32x16_bf16 v[112:127], v[28:31], v[128:131], 0
    ds_read_b64_tr_b16 v[36:37], v22 offset:2048
    ds_read_b64_tr_b16 v[38:39], v22 offset:2560
    s_waitcnt lgkmcnt(2)
    v_mfma_f32_32x32x16_bf16 v[96:111], v[32:35], v[132:135], v[96:111]
    ds_read_b64_tr_b16 v[24:25], v21 offset:16384
    ds_read_b64_tr_b16 v[26:27], v21 offset:16896
    s_add_u32 m0, s80, 77824
    s_nop 0
    buffer_load_dwordx4 v8, s[64:67], s77 offen lds
    v_and_b32 v20, 31, v0
    v_mul_u32_u24 v20, 48, v20
    v_add_u32 v20, 147456, v20
    ds_read_b64 v[40:41], v20 offset:3072
    ds_read_b64 v[42:43], v20 offset:4608
    ds_read_b64 v[44:45], v20 offset:6144
    s_waitcnt lgkmcnt(5)
    v_mfma_f32_32x32x16_bf16 v[112:127], v[36:39], v[132:135], v[112:127]
    ds_read_b64_tr_b16 v[28:29], v22 offset:16384
    ds_read_b64_tr_b16 v[30:31], v22 offset:16896
    v_lshlrev_b32 v1, 2, v0
    s_lshl_b32 s12, s4, 8
    s_add_u32 s12, s12, 131072
    v_add_u32 v1, s12, v1
    v_mov_b32 v2, 0
    ds_write_b32 v1, v2 offset:4096
    ds_write_b32 v1, v2 offset:6144
    ds_write_b32 v1, v2 offset:8192
    s_nop 3
    s_waitcnt lgkmcnt(5)
    v_fma_f32 v11, v40, v48, v49
    v_fma_f32 v13, v42, v64, v65
    v_fma_f32 v15, v44, v80, v81
    v_fmac_f32_dpp v11, v48, v41 quad_perm:[1,0,3,2] row_mask:0xf bank_mask:0xf
    v_fmac_f32_dpp v13, v64, v43 quad_perm:[1,0,3,2] row_mask:0xf bank_mask:0xf
    v_fmac_f32_dpp v15, v80, v45 quad_perm:[1,0,3,2] row_mask:0xf bank_mask:0xf
    v_fma_f32 v10, v40, v11, v50
    v_fma_f32 v12, v42, v13, v66
    v_fma_f32 v14, v44, v15, v82
    v_fmac_f32_dpp v10, v11, v41 quad_perm:[1,0,3,2] row_mask:0xf bank_mask:0xf
    v_fmac_f32_dpp v12, v13, v43 quad_perm:[1,0,3,2] row_mask:0xf bank_mask:0xf
    v_fmac_f32_dpp v14, v15, v45 quad_perm:[1,0,3,2] row_mask:0xf bank_mask:0xf
    v_fma_f32 v11, v40, v10, v51
    v_fma_f32 v13, v42, v12, v67
    v_fma_f32 v15, v44, v14, v83
    v_fmac_f32_dpp v11, v10, v41 quad_perm:[1,0,3,2] row_mask:0xf bank_mask:0xf
    v_fmac_f32_dpp v13, v12, v43 quad_perm:[1,0,3,2] row_mask:0xf bank_mask:0xf
    v_fmac_f32_dpp v15, v14, v45 quad_perm:[1,0,3,2] row_mask:0xf bank_mask:0xf
    v_fma_f32 v10, v40, v11, v52
    v_fma_f32 v12, v42, v13, v68
    v_fma_f32 v14, v44, v15, v84
    v_fmac_f32_dpp v10, v11, v41 quad_perm:[1,0,3,2] row_mask:0xf bank_mask:0xf
    v_fmac_f32_dpp v12, v13, v43 quad_perm:[1,0,3,2] row_mask:0xf bank_mask:0xf
    v_fmac_f32_dpp v14, v15, v45 quad_perm:[1,0,3,2] row_mask:0xf bank_mask:0xf
    v_fma_f32 v11, v40, v10, v53
    v_fma_f32 v13, v42, v12, v69
    v_fma_f32 v15, v44, v14, v85
    v_fmac_f32_dpp v11, v10, v41 quad_perm:[1,0,3,2] row_mask:0xf bank_mask:0xf
    v_fmac_f32_dpp v13, v12, v43 quad_perm:[1,0,3,2] row_mask:0xf bank_mask:0xf
    v_fmac_f32_dpp v15, v14, v45 quad_perm:[1,0,3,2] row_mask:0xf bank_mask:0xf
    v_fma_f32 v10, v40, v11, v54
    v_fma_f32 v12, v42, v13, v70
    v_fma_f32 v14, v44, v15, v86
    v_fmac_f32_dpp v10, v11, v41 quad_perm:[1,0,3,2] row_mask:0xf bank_mask:0xf
    v_fmac_f32_dpp v12, v13, v43 quad_perm:[1,0,3,2] row_mask:0xf bank_mask:0xf
    v_fmac_f32_dpp v14, v15, v45 quad_perm:[1,0,3,2] row_mask:0xf bank_mask:0xf
    v_fma_f32 v11, v40, v10, v55
    v_fma_f32 v13, v42, v12, v71
    v_fma_f32 v15, v44, v14, v87
    v_fmac_f32_dpp v11, v10, v41 quad_perm:[1,0,3,2] row_mask:0xf bank_mask:0xf
    v_fmac_f32_dpp v13, v12, v43 quad_perm:[1,0,3,2] row_mask:0xf bank_mask:0xf
    v_fmac_f32_dpp v15, v14, v45 quad_perm:[1,0,3,2] row_mask:0xf bank_mask:0xf
    v_fma_f32 v10, v40, v11, v56
    v_fma_f32 v12, v42, v13, v72
    v_fma_f32 v14, v44, v15, v88
    v_fmac_f32_dpp v10, v11, v41 quad_perm:[1,0,3,2] row_mask:0xf bank_mask:0xf
    v_fmac_f32_dpp v12, v13, v43 quad_perm:[1,0,3,2] row_mask:0xf bank_mask:0xf
    v_fmac_f32_dpp v14, v15, v45 quad_perm:[1,0,3,2] row_mask:0xf bank_mask:0xf
    v_fma_f32 v11, v40, v10, v57
    v_fma_f32 v13, v42, v12, v73
    v_fma_f32 v15, v44, v14, v89
    v_fmac_f32_dpp v11, v10, v41 quad_perm:[1,0,3,2] row_mask:0xf bank_mask:0xf
    v_fmac_f32_dpp v13, v12, v43 quad_perm:[1,0,3,2] row_mask:0xf bank_mask:0xf
    v_fmac_f32_dpp v15, v14, v45 quad_perm:[1,0,3,2] row_mask:0xf bank_mask:0xf
    v_fma_f32 v10, v40, v11, v58
    v_fma_f32 v12, v42, v13, v74
    v_fma_f32 v14, v44, v15, v90
    v_fmac_f32_dpp v10, v11, v41 quad_perm:[1,0,3,2] row_mask:0xf bank_mask:0xf
    v_fmac_f32_dpp v12, v13, v43 quad_perm:[1,0,3,2] row_mask:0xf bank_mask:0xf
    v_fmac_f32_dpp v14, v15, v45 quad_perm:[1,0,3,2] row_mask:0xf bank_mask:0xf
    v_fma_f32 v11, v40, v10, v59
    v_fma_f32 v13, v42, v12, v75
    v_fma_f32 v15, v44, v14, v91
    v_fmac_f32_dpp v11, v10, v41 quad_perm:[1,0,3,2] row_mask:0xf bank_mask:0xf
    v_fmac_f32_dpp v13, v12, v43 quad_perm:[1,0,3,2] row_mask:0xf bank_mask:0xf
    v_fmac_f32_dpp v15, v14, v45 quad_perm:[1,0,3,2] row_mask:0xf bank_mask:0xf
    v_fma_f32 v10, v40, v11, v60
    v_fma_f32 v12, v42, v13, v76
    v_fma_f32 v14, v44, v15, v92
    v_fmac_f32_dpp v10, v11, v41 quad_perm:[1,0,3,2] row_mask:0xf bank_mask:0xf
    v_fmac_f32_dpp v12, v13, v43 quad_perm:[1,0,3,2] row_mask:0xf bank_mask:0xf
    v_fmac_f32_dpp v14, v15, v45 quad_perm:[1,0,3,2] row_mask:0xf bank_mask:0xf
    v_fma_f32 v11, v40, v10, v61
    v_fma_f32 v13, v42, v12, v77
    v_fma_f32 v15, v44, v14, v93
    v_fmac_f32_dpp v11, v10, v41 quad_perm:[1,0,3,2] row_mask:0xf bank_mask:0xf
    v_fmac_f32_dpp v13, v12, v43 quad_perm:[1,0,3,2] row_mask:0xf bank_mask:0xf
    v_fmac_f32_dpp v15, v14, v45 quad_perm:[1,0,3,2] row_mask:0xf bank_mask:0xf
    v_fma_f32 v10, v40, v11, v62
    v_fma_f32 v12, v42, v13, v78
    v_fma_f32 v14, v44, v15, v94
    v_fmac_f32_dpp v10, v11, v41 quad_perm:[1,0,3,2] row_mask:0xf bank_mask:0xf
    v_fmac_f32_dpp v12, v13, v43 quad_perm:[1,0,3,2] row_mask:0xf bank_mask:0xf
    v_fmac_f32_dpp v14, v15, v45 quad_perm:[1,0,3,2] row_mask:0xf bank_mask:0xf
    v_fma_f32 v11, v40, v10, v63
    v_fma_f32 v13, v42, v12, v79
    v_fma_f32 v15, v44, v14, v95
    v_fmac_f32_dpp v11, v10, v41 quad_perm:[1,0,3,2] row_mask:0xf bank_mask:0xf
    v_fmac_f32_dpp v13, v12, v43 quad_perm:[1,0,3,2] row_mask:0xf bank_mask:0xf
    v_fmac_f32_dpp v15, v14, v45 quad_perm:[1,0,3,2] row_mask:0xf bank_mask:0xf
    ds_write_b32 v1, v11 offset:5120
    ds_write_b32 v1, v13 offset:7168
    ds_write_b32 v1, v15 offset:9216
    s_add_u32 s12, s4, 2
    s_mul_i32 s13, s12, 1536
    v_add_u32 v3, s13, v20
    s_lshl_b32 s13, s12, 11
    s_add_u32 s13, s13, 131072
    v_and_b32 v2, 31, v0
    v_lshlrev_b32 v4, 3, v2
    v_lshl_add_u32 v2, v2, 2, s13
    s_waitcnt lgkmcnt(0)
    s_barrier
    s_cmp_ge_u32 s4, 3
    s_cbranch_scc1 L_pub_skip_45
    ds_read_b64 v[10:11], v3 offset:8
    ds_read_b32 v12, v2 offset:1024
    ds_read_b32 v13, v2 offset:1152
    ds_read_b32 v14, v2 offset:1280
    ds_read_b32 v15, v2 offset:1408
    ds_read_b32 v16, v2 offset:1536
    ds_read_b32 v17, v2 offset:1664
    ds_read_b32 v18, v2 offset:1792
    ds_read_b32 v19, v2 offset:1920
    s_add_u32 s12, s93, 4096
    s_waitcnt lgkmcnt(0)
    v_fmac_f32 v13, v10, v12
    s_nop 0
    v_fmac_f32_dpp v13, v12, v11 quad_perm:[1,0,3,2] row_mask:0xf bank_mask:0xf
    v_fmac_f32 v14, v10, v13
    s_nop 0
    v_fmac_f32_dpp v14, v13, v11 quad_perm:[1,0,3,2] row_mask:0xf bank_mask:0xf
    v_fmac_f32 v15, v10, v14
    s_nop 0
    v_fmac_f32_dpp v15, v14, v11 quad_perm:[1,0,3,2] row_mask:0xf bank_mask:0xf
    v_fmac_f32 v16, v10, v15
    s_nop 0
    v_fmac_f32_dpp v16, v15, v11 quad_perm:[1,0,3,2] row_mask:0xf bank_mask:0xf
    v_fmac_f32 v17, v10, v16
    s_nop 0
    v_fmac_f32_dpp v17, v16, v11 quad_perm:[1,0,3,2] row_mask:0xf bank_mask:0xf
    v_fmac_f32 v18, v10, v17
    s_nop 0
    v_fmac_f32_dpp v18, v17, v11 quad_perm:[1,0,3,2] row_mask:0xf bank_mask:0xf
    v_fmac_f32 v19, v10, v18
    s_nop 0
    v_fmac_f32_dpp v19, v18, v11 quad_perm:[1,0,3,2] row_mask:0xf bank_mask:0xf
    v_mov_b32 v11, s34
    v_mov_b32 v10, v19
    s_mov_b32 exec_hi, 0
    buffer_store_dwordx2 v[10:11], v4, s[68:71], s12 offen sc1
    s_mov_b64 exec, -1
L_pub_skip_45:
    v_lshrrev_b32 v12, 5, v0
    v_sub_u32 v12, 1, v12
    v_lshl_add_u32 v4, v12, 8, v4
    v_mfma_f32_32x32x16_bf16 v[96:111], v[24:27], v[136:139], v[96:111]
    ds_read_b64_tr_b16 v[32:33], v21 offset:18432
    ds_read_b64_tr_b16 v[34:35], v21 offset:18944
    buffer_load_dwordx4 v9, s[64:67], s77 offen offset:1024 lds
    v_mfma_f32_32x32x16_bf16 v[112:127], v[28:31], v[136:139], v[112:127]
    ds_read_b64_tr_b16 v[36:37], v22 offset:18432
    ds_read_b64_tr_b16 v[38:39], v22 offset:18944
    s_waitcnt lgkmcnt(2)
    v_mfma_f32_32x32x16_bf16 v[96:111], v[32:35], v[140:143], v[96:111]
    ds_read_b64_tr_b16 v[24:25], v21 offset:32768
    ds_read_b64_tr_b16 v[26:27], v21 offset:33280
    s_waitcnt lgkmcnt(2)
    v_mfma_f32_32x32x16_bf16 v[112:127], v[36:39], v[140:143], v[112:127]
    ds_read_b64_tr_b16 v[28:29], v22 offset:32768
    ds_read_b64_tr_b16 v[30:31], v22 offset:33280
    v_lshrrev_b32 v6, 3, v0
    v_bfe_u32 v7, v0, 4, 1
    v_lshlrev_b32 v7, 2, v7
    v_and_b32 v8, 7, v0
    v_xor_b32 v7, v7, v8
    v_lshlrev_b32 v7, 4, v7
    v_lshl_add_u32 v6, v6, 10, v7
    v_add_u32 v7, 7168, v6
    v_bfe_u32 v9, v0, 2, 2
    v_lshrrev_b32 v8, 5, v0
    v_lshl_add_u32 v8, v8, 2, v9
    v_lshlrev_b32 v8, 7, v8
    v_lshrrev_b32 v9, 1, v9
    v_lshl_add_u32 v8, v9, 6, v8
    v_bfe_u32 v9, v0, 4, 1
    v_lshl_add_u32 v8, v9, 5, v8
    v_and_b32 v9, 3, v0
    v_lshl_add_u32 v8, v9, 3, v8
    v_add_u32 v8, s94, v8
    v_xor_b32 v9, 64, v8
    s_waitcnt lgkmcnt(2)
    v_mfma_f32_32x32x16_bf16 v[96:111], v[24:27], v[144:147], v[96:111]
    ds_read_b64_tr_b16 v[32:33], v21 offset:34816
    ds_read_b64_tr_b16 v[34:35], v21 offset:35328
    s_waitcnt lgkmcnt(2)
    v_mfma_f32_32x32x16_bf16 v[112:127], v[28:31], v[144:147], v[112:127]
    ds_read_b64_tr_b16 v[36:37], v22 offset:34816
    ds_read_b64_tr_b16 v[38:39], v22 offset:35328
    s_waitcnt lgkmcnt(2)
    v_mfma_f32_32x32x16_bf16 v[96:111], v[32:35], v[148:151], v[96:111]
    ds_read_b64_tr_b16 v[24:25], v21 offset:49152
    ds_read_b64_tr_b16 v[26:27], v21 offset:49664
    s_waitcnt lgkmcnt(2)
    v_mfma_f32_32x32x16_bf16 v[112:127], v[36:39], v[148:151], v[112:127]
    ds_read_b64_tr_b16 v[28:29], v22 offset:49152
    ds_read_b64_tr_b16 v[30:31], v22 offset:49664
    s_waitcnt lgkmcnt(2)
    v_mfma_f32_32x32x16_bf16 v[96:111], v[24:27], v[152:155], v[96:111]
    ds_read_b64_tr_b16 v[32:33], v21 offset:51200
    ds_read_b64_tr_b16 v[34:35], v21 offset:51712
    s_waitcnt lgkmcnt(2)
    v_mfma_f32_32x32x16_bf16 v[112:127], v[28:31], v[152:155], v[112:127]
    ds_read_b64_tr_b16 v[36:37], v22 offset:51200
    ds_read_b64_tr_b16 v[38:39], v22 offset:51712
    s_waitcnt vmcnt(8) lgkmcnt(0)
    s_barrier
    v_mfma_f32_32x32x16_bf16 v[96:111], v[32:35], v[156:159], v[96:111]
    ds_read_b64_tr_b16 v[24:25], v21 offset:4096
    ds_read_b64_tr_b16 v[26:27], v21 offset:4608
    v_mfma_f32_32x32x16_bf16 v[112:127], v[36:39], v[156:159], v[112:127]
    ds_read_b64_tr_b16 v[28:29], v22 offset:4096
    ds_read_b64_tr_b16 v[30:31], v22 offset:4608
    s_waitcnt lgkmcnt(2)
    v_mfma_f32_32x32x16_bf16 v[96:111], v[24:27], v[160:163], v[96:111]
    ds_read_b64_tr_b16 v[32:33], v21 offset:6144
    ds_read_b64_tr_b16 v[34:35], v21 offset:6656
    s_waitcnt lgkmcnt(2)
    v_mfma_f32_32x32x16_bf16 v[112:127], v[28:31], v[160:163], v[112:127]
    ds_read_b64_tr_b16 v[36:37], v22 offset:6144
    ds_read_b64_tr_b16 v[38:39], v22 offset:6656
    s_waitcnt lgkmcnt(2)
    v_mfma_f32_32x32x16_bf16 v[96:111], v[32:35], v[164:167], v[96:111]
    ds_read_b64_tr_b16 v[24:25], v21 offset:20480
    ds_read_b64_tr_b16 v[26:27], v21 offset:20992
    s_waitcnt lgkmcnt(2)
    v_mfma_f32_32x32x16_bf16 v[112:127], v[36:39], v[164:167], v[112:127]
    ds_read_b64_tr_b16 v[28:29], v22 offset:20480
    ds_read_b64_tr_b16 v[30:31], v22 offset:20992
    s_waitcnt lgkmcnt(2)
    v_mfma_f32_32x32x16_bf16 v[96:111], v[24:27], v[168:171], v[96:111]
    ds_read_b64_tr_b16 v[32:33], v21 offset:22528
    ds_read_b64_tr_b16 v[34:35], v21 offset:23040
    s_waitcnt lgkmcnt(2)
    v_mfma_f32_32x32x16_bf16 v[112:127], v[28:31], v[168:171], v[112:127]
    ds_read_b64_tr_b16 v[36:37], v22 offset:22528
    ds_read_b64_tr_b16 v[38:39], v22 offset:23040
    s_waitcnt lgkmcnt(2)
    v_mfma_f32_32x32x16_bf16 v[96:111], v[32:35], v[172:175], v[96:111]
    ds_read_b64_tr_b16 v[24:25], v21 offset:36864
    ds_read_b64_tr_b16 v[26:27], v21 offset:37376
    s_waitcnt lgkmcnt(2)
    v_mfma_f32_32x32x16_bf16 v[112:127], v[36:39], v[172:175], v[112:127]
    ds_read_b64_tr_b16 v[28:29], v22 offset:36864
    ds_read_b64_tr_b16 v[30:31], v22 offset:37376
    s_cmp_ge_u32 s4, 3
    s_cbranch_scc1 L_grl_skip_46
    s_cmp_eq_u32 s6, 0
    s_cbranch_scc1 L_grl_skip_46
    s_add_u32 s13, s6, 1
    s_lshr_b32 s13, s13, 1
    buffer_load_dwordx2 v[136:137], v4, s[68:71], s93 offen offset:3584 sc1
    s_cmp_eq_u32 s13, 1
    s_cbranch_scc1 L_grl_skip_46
    buffer_load_dwordx2 v[138:139], v4, s[68:71], s93 offen offset:3072 sc1
    s_cmp_eq_u32 s13, 2
    s_cbranch_scc1 L_grl_skip_46
    buffer_load_dwordx2 v[140:141], v4, s[68:71], s93 offen offset:2560 sc1
    s_cmp_eq_u32 s13, 3
    s_cbranch_scc1 L_grl_skip_46
    buffer_load_dwordx2 v[142:143], v4, s[68:71], s93 offen offset:2048 sc1
    s_cmp_eq_u32 s13, 4
    s_cbranch_scc1 L_grl_skip_46
    buffer_load_dwordx2 v[144:145], v4, s[68:71], s93 offen offset:1536 sc1
    s_cmp_eq_u32 s13, 5
    s_cbranch_scc1 L_grl_skip_46
    buffer_load_dwordx2 v[146:147], v4, s[68:71], s93 offen offset:1024 sc1
    s_cmp_eq_u32 s13, 6
    s_cbranch_scc1 L_grl_skip_46
    buffer_load_dwordx2 v[148:149], v4, s[68:71], s93 offen offset:512 sc1
    s_cmp_eq_u32 s13, 7
    s_cbranch_scc1 L_grl_skip_46
    buffer_load_dwordx2 v[150:151], v4, s[68:71], s93 offen offset:0 sc1
L_grl_skip_46:
    s_waitcnt lgkmcnt(2)
    v_mfma_f32_32x32x16_bf16 v[96:111], v[24:27], v[176:179], v[96:111]
    ds_read_b64_tr_b16 v[32:33], v21 offset:38912
    ds_read_b64_tr_b16 v[34:35], v21 offset:39424
    s_waitcnt lgkmcnt(2)
    v_mfma_f32_32x32x16_bf16 v[112:127], v[28:31], v[176:179], v[112:127]
    ds_read_b64_tr_b16 v[36:37], v22 offset:38912
    ds_read_b64_tr_b16 v[38:39], v22 offset:39424
    s_waitcnt lgkmcnt(2)
    v_mfma_f32_32x32x16_bf16 v[96:111], v[32:35], v[180:183], v[96:111]
    ds_read_b64_tr_b16 v[24:25], v21 offset:53248
    ds_read_b64_tr_b16 v[26:27], v21 offset:53760
    s_waitcnt lgkmcnt(2)
    v_mfma_f32_32x32x16_bf16 v[112:127], v[36:39], v[180:183], v[112:127]
    ds_read_b64_tr_b16 v[28:29], v22 offset:53248
    ds_read_b64_tr_b16 v[30:31], v22 offset:53760
    s_waitcnt lgkmcnt(2)
    v_mfma_f32_32x32x16_bf16 v[96:111], v[24:27], v[184:187], v[96:111]
    ds_read_b64_tr_b16 v[32:33], v21 offset:55296
    ds_read_b64_tr_b16 v[34:35], v21 offset:55808
    s_waitcnt lgkmcnt(2)
    v_mfma_f32_32x32x16_bf16 v[112:127], v[28:31], v[184:187], v[112:127]
    ds_read_b64_tr_b16 v[36:37], v22 offset:55296
    ds_read_b64_tr_b16 v[38:39], v22 offset:55808
    s_waitcnt vmcnt(4) lgkmcnt(0)
    s_barrier
    v_mfma_f32_32x32x16_bf16 v[96:111], v[32:35], v[188:191], v[96:111]
    ds_read_b64_tr_b16 v[24:25], v21 offset:8192
    ds_read_b64_tr_b16 v[26:27], v21 offset:8704
    v_mfma_f32_32x32x16_bf16 v[112:127], v[36:39], v[188:191], v[112:127]
    ds_read_b64_tr_b16 v[28:29], v22 offset:8192
    ds_read_b64_tr_b16 v[30:31], v22 offset:8704
    s_waitcnt lgkmcnt(2)
    v_mfma_f32_32x32x16_bf16 v[96:111], v[24:27], v[192:195], v[96:111]
    ds_read_b64_tr_b16 v[32:33], v21 offset:10240
    ds_read_b64_tr_b16 v[34:35], v21 offset:10752
    s_waitcnt lgkmcnt(2)
    v_mfma_f32_32x32x16_bf16 v[112:127], v[28:31], v[192:195], v[112:127]
    ds_read_b64_tr_b16 v[36:37], v22 offset:10240
    ds_read_b64_tr_b16 v[38:39], v22 offset:10752
    s_cmp_ge_u32 s4, 3
    s_cbranch_scc1 L_car_skip_47
    s_cmp_eq_u32 s6, 0
    s_cbranch_scc1 L_car_skip_47
    ds_read_b128 v[152:155], v3 offset:16
    s_add_u32 s13, s6, 1
    s_lshr_b32 s13, s13, 1
    s_bitcmp1_b32 s6, 0
    s_cselect_b32 s89, 0, -1
    s_mov_b32 s88, -1
    s_mov_b32 s86, 0
    s_waitcnt vmcnt(0)
L_car_poll_48:
    s_mov_b64 s[90:91], 0
    v_cmp_ne_u32 vcc, s34, v137
    s_cmp_eq_u32 s13, 1
    s_cbranch_scc1 L_car_chk_49
    s_or_b64 s[90:91], s[90:91], vcc
    v_cmp_ne_u32 vcc, s34, v139
    s_cmp_eq_u32 s13, 2
    s_cbranch_scc1 L_car_chk_49
    s_or_b64 s[90:91], s[90:91], vcc
    v_cmp_ne_u32 vcc, s34, v141
    s_cmp_eq_u32 s13, 3
    s_cbranch_scc1 L_car_chk_49
    s_or_b64 s[90:91], s[90:91], vcc
    v_cmp_ne_u32 vcc, s34, v143
    s_cmp_eq_u32 s13, 4
    s_cbranch_scc1 L_car_chk_49
    s_or_b64 s[90:91], s[90:91], vcc
    v_cmp_ne_u32 vcc, s34, v145
    s_cmp_eq_u32 s13, 5
    s_cbranch_scc1 L_car_chk_49
    s_or_b64 s[90:91], s[90:91], vcc
    v_cmp_ne_u32 vcc, s34, v147
    s_cmp_eq_u32 s13, 6
    s_cbranch_scc1 L_car_chk_49
    s_or_b64 s[90:91], s[90:91], vcc
    v_cmp_ne_u32 vcc, s34, v149
    s_cmp_eq_u32 s13, 7
    s_cbranch_scc1 L_car_chk_49
    s_or_b64 s[90:91], s[90:91], vcc
    v_cmp_ne_u32 vcc, s34, v151
L_car_chk_49:
    s_and_b64 vcc, vcc, s[88:89]
    s_or_b64 s[90:91], s[90:91], vcc
    s_cbranch_scc0 L_car_ok_50
    s_add_u32 s86, s86, 1
    s_cmp_ge_u32 s86, 0x4000
    s_cbranch_scc1 L_car_ok_50
    s_sleep 1
    buffer_load_dwordx2 v[136:137], v4, s[68:71], s93 offen offset:3584 sc1
    s_cmp_eq_u32 s13, 1
    s_cbranch_scc1 L_car_re_51
    buffer_load_dwordx2 v[138:139], v4, s[68:71], s93 offen offset:3072 sc1
    s_cmp_eq_u32 s13, 2
    s_cbranch_scc1 L_car_re_51
    buffer_load_dwordx2 v[140:141], v4, s[68:71], s93 offen offset:2560 sc1
    s_cmp_eq_u32 s13, 3
    s_cbranch_scc1 L_car_re_51
    buffer_load_dwordx2 v[142:143], v4, s[68:71], s93 offen offset:2048 sc1
    s_cmp_eq_u32 s13, 4
    s_cbranch_scc1 L_car_re_51
    buffer_load_dwordx2 v[144:145], v4, s[68:71], s93 offen offset:1536 sc1
    s_cmp_eq_u32 s13, 5
    s_cbranch_scc1 L_car_re_51
    buffer_load_dwordx2 v[146:147], v4, s[68:71], s93 offen offset:1024 sc1
    s_cmp_eq_u32 s13, 6
    s_cbranch_scc1 L_car_re_51
    buffer_load_dwordx2 v[148:149], v4, s[68:71], s93 offen offset:512 sc1
    s_cmp_eq_u32 s13, 7
    s_cbranch_scc1 L_car_re_51
    buffer_load_dwordx2 v[150:151], v4, s[68:71], s93 offen offset:0 sc1
L_car_re_51:
    s_waitcnt vmcnt(0)
    s_branch L_car_poll_48
L_car_ok_50:
    s_waitcnt lgkmcnt(0)
    v_mov_b32 v156, 0
    s_cmp_le_u32 s13, 7
    s_cbranch_scc1 L_hs_52
    s_cmp_eq_u32 s13, 8
    s_cselect_b64 vcc, s[88:89], -1
    v_cndmask_b32 v150, 0, v150, vcc
    v_fmac_f32 v150, v154, v156
    v_fmac_f32_dpp v150, v156, v155 quad_perm:[1,0,3,2] row_mask:0xf bank_mask:0xf
    v_mov_b32 v156, v150
L_hs_52:
    s_cmp_le_u32 s13, 6
    s_cbranch_scc1 L_hs_53
    s_cmp_eq_u32 s13, 7
    s_cselect_b64 vcc, s[88:89], -1
    v_cndmask_b32 v148, 0, v148, vcc
    v_fmac_f32 v148, v154, v156
    v_fmac_f32_dpp v148, v156, v155 quad_perm:[1,0,3,2] row_mask:0xf bank_mask:0xf
    v_mov_b32 v156, v148
L_hs_53:
    s_cmp_le_u32 s13, 5
    s_cbranch_scc1 L_hs_54
    s_cmp_eq_u32 s13, 6
    s_cselect_b64 vcc, s[88:89], -1
    v_cndmask_b32 v146, 0, v146, vcc
    v_fmac_f32 v146, v154, v156
    v_fmac_f32_dpp v146, v156, v155 quad_perm:[1,0,3,2] row_mask:0xf bank_mask:0xf
    v_mov_b32 v156, v146
L_hs_54:
    s_cmp_le_u32 s13, 4
    s_cbranch_scc1 L_hs_55
    s_cmp_eq_u32 s13, 5
    s_cselect_b64 vcc, s[88:89], -1
    v_cndmask_b32 v144, 0, v144, vcc
    v_fmac_f32 v144, v154, v156
    v_fmac_f32_dpp v144, v156, v155 quad_perm:[1,0,3,2] row_mask:0xf bank_mask:0xf
    v_mov_b32 v156, v144
L_hs_55:
    s_cmp_le_u32 s13, 3
    s_cbranch_scc1 L_hs_56
    s_cmp_eq_u32 s13, 4
    s_cselect_b64 vcc, s[88:89], -1
    v_cndmask_b32 v142, 0, v142, vcc
    v_fmac_f32 v142, v154, v156
    v_fmac_f32_dpp v142, v156, v155 quad_perm:[1,0,3,2] row_mask:0xf bank_mask:0xf
    v_mov_b32 v156, v142
L_hs_56:
    s_cmp_le_u32 s13, 2
    s_cbranch_scc1 L_hs_57
    s_cmp_eq_u32 s13, 3
    s_cselect_b64 vcc, s[88:89], -1
    v_cndmask_b32 v140, 0, v140, vcc
    v_fmac_f32 v140, v154, v156
    v_fmac_f32_dpp v140, v156, v155 quad_perm:[1,0,3,2] row_mask:0xf bank_mask:0xf
    v_mov_b32 v156, v140
L_hs_57:
    s_cmp_le_u32 s13, 1
    s_cbranch_scc1 L_hs_58
    s_cmp_eq_u32 s13, 2
    s_cselect_b64 vcc, s[88:89], -1
    v_cndmask_b32 v138, 0, v138, vcc
    v_fmac_f32 v138, v154, v156
    v_fmac_f32_dpp v138, v156, v155 quad_perm:[1,0,3,2] row_mask:0xf bank_mask:0xf
    v_mov_b32 v156, v138
L_hs_58:
    s_cmp_le_u32 s13, 0
    s_cbranch_scc1 L_hs_59
    s_cmp_eq_u32 s13, 1
    s_cselect_b64 vcc, s[88:89], -1
    v_cndmask_b32 v136, 0, v136, vcc
    v_fmac_f32 v136, v154, v156
    v_fmac_f32_dpp v136, v156, v155 quad_perm:[1,0,3,2] row_mask:0xf bank_mask:0xf
    v_mov_b32 v156, v136
L_hs_59:
    s_nop 0
    v_mul_f32 v157, v152, v156
    v_fmac_f32_dpp v157, v156, v153 quad_perm:[1,0,3,2] row_mask:0xf bank_mask:0xf
    v_mov_b32 v158, 0
    s_nop 0
    v_permlane32_swap_b32 v157, v158
    s_nop 0
    v_add_f32 v156, v156, v158
    s_mov_b32 exec_hi, 0
    ds_write_b32 v2, v156 offset:896
    s_mov_b64 exec, -1
    s_waitcnt lgkmcnt(0)
L_car_skip_47:
    s_waitcnt lgkmcnt(2)
    v_mfma_f32_32x32x16_bf16 v[96:111], v[32:35], v[196:199], v[96:111]
    ds_read_b64_tr_b16 v[24:25], v21 offset:24576
    ds_read_b64_tr_b16 v[26:27], v21 offset:25088
    s_waitcnt lgkmcnt(2)
    v_mfma_f32_32x32x16_bf16 v[112:127], v[36:39], v[196:199], v[112:127]
    ds_read_b64_tr_b16 v[28:29], v22 offset:24576
    ds_read_b64_tr_b16 v[30:31], v22 offset:25088
    s_add_u32 m0, s94, 0
    s_add_u32 s15, s95, 0
    buffer_load_dwordx4 v6, s[72:75], s15 offen lds
    buffer_load_dwordx4 v7, s[72:75], s15 offen offset:1024 lds
    s_waitcnt lgkmcnt(2)
    v_mfma_f32_32x32x16_bf16 v[96:111], v[24:27], v[200:203], v[96:111]
    ds_read_b64_tr_b16 v[32:33], v21 offset:26624
    ds_read_b64_tr_b16 v[34:35], v21 offset:27136
    s_waitcnt lgkmcnt(2)
    v_mfma_f32_32x32x16_bf16 v[112:127], v[28:31], v[200:203], v[112:127]
    ds_read_b64_tr_b16 v[36:37], v22 offset:26624
    ds_read_b64_tr_b16 v[38:39], v22 offset:27136
    s_add_u32 m0, s94, 2048
    s_add_u32 s15, s95, 16384
    buffer_load_dwordx4 v6, s[72:75], s15 offen lds
    buffer_load_dwordx4 v7, s[72:75], s15 offen offset:1024 lds
    s_waitcnt lgkmcnt(2)
    v_mfma_f32_32x32x16_bf16 v[96:111], v[32:35], v[204:207], v[96:111]
    ds_read_b64_tr_b16 v[24:25], v21 offset:40960
    ds_read_b64_tr_b16 v[26:27], v21 offset:41472
    s_waitcnt lgkmcnt(2)
    v_mfma_f32_32x32x16_bf16 v[112:127], v[36:39], v[204:207], v[112:127]
    ds_read_b64_tr_b16 v[28:29], v22 offset:40960
    ds_read_b64_tr_b16 v[30:31], v22 offset:41472
    s_add_u32 m0, s94, 4096
    s_add_u32 s15, s95, 32768
    buffer_load_dwordx4 v6, s[72:75], s15 offen lds
    buffer_load_dwordx4 v7, s[72:75], s15 offen offset:1024 lds
    s_barrier
    s_waitcnt lgkmcnt(2)
    v_mfma_f32_32x32x16_bf16 v[96:111], v[24:27], v[208:211], v[96:111]
    ds_read_b64_tr_b16 v[32:33], v21 offset:43008
    ds_read_b64_tr_b16 v[34:35], v21 offset:43520
    ds_read_b128 v[136:139], v20 offset:3072
    ds_read_b32 v148, v1 offset:4096
    ds_read_b32 v149, v1 offset:4224
    ds_read_b32 v150, v1 offset:4352
    ds_read_b32 v151, v1 offset:4480
    ds_read_b32 v152, v1 offset:4608
    ds_read_b32 v153, v1 offset:4736
    ds_read_b32 v154, v1 offset:4864
    ds_read_b32 v155, v1 offset:4992
    ds_read_b128 v[140:143], v20 offset:4608
    ds_read_b32 v156, v1 offset:6144
    ds_read_b32 v157, v1 offset:6272
    ds_read_b32 v158, v1 offset:6400
    ds_read_b32 v159, v1 offset:6528
    ds_read_b32 v160, v1 offset:6656
    ds_read_b32 v161, v1 offset:6784
    ds_read_b32 v162, v1 offset:6912
    ds_read_b32 v163, v1 offset:7040
    ds_read_b128 v[144:147], v20 offset:6144
    ds_read_b32 v164, v1 offset:8192
    ds_read_b32 v165, v1 offset:8320
    s_waitcnt lgkmcnt(15)
    v_mfma_f32_32x32x16_bf16 v[112:127], v[28:31], v[208:211], v[112:127]
    ds_read_b64_tr_b16 v[36:37], v22 offset:43008
    ds_read_b64_tr_b16 v[38:39], v22 offset:43520
    ds_read_b32 v166, v1 offset:8448
    ds_read_b32 v167, v1 offset:8576
    ds_read_b32 v168, v1 offset:8704
    ds_read_b32 v169, v1 offset:8832
    ds_read_b32 v170, v1 offset:8960
    ds_read_b32 v171, v1 offset:9088
    s_mul_i32 s78, s4, 1280
    s_add_u32 s78, s78, 155136
    v_and_b32 v10, 15, v0
    v_mul_u32_u24 v10, 80, v10
    v_lshrrev_b32 v11, 5, v0
    v_lshl_add_u32 v10, v11, 5, v10
    v_add_u32 v10, s78, v10
    v_bfe_u32 v12, v0, 2, 2
    v_lshl_add_u32 v11, v12, 1, v11
    v_mul_u32_u24 v11, 80, v11
    v_and_b32 v12, 1, v0
    s_add_u32 m0, s94, 6144
    s_add_u32 s15, s95, 49152
    buffer_load_dwordx4 v6, s[72:75], s15 offen lds
    buffer_load_dwordx4 v7, s[72:75], s15 offen offset:1024 lds
    v_mfma_f32_32x32x16_bf16 v[96:111], v[32:35], v[212:215], v[96:111]
    ds_read_b64_tr_b16 v[24:25], v21 offset:57344
    ds_read_b64_tr_b16 v[26:27], v21 offset:57856
    v_lshl_add_u32 v11, v12, 5, v11
    v_bfe_u32 v12, v0, 4, 1
    v_lshl_add_u32 v11, v12, 4, v11
    v_bfe_u32 v12, v0, 1, 1
    v_lshl_add_u32 v11, v12, 3, v11
    v_add_u32 v11, s78, v11
    ds_read_b64 v[12:13], v20 offset:3104
    ds_read_b64 v[14:15], v20 offset:4640
    ds_read_b64 v[16:17], v20 offset:6176
    s_waitcnt lgkmcnt(5)
    v_fmac_f32 v149, v138, v148
    v_fmac_f32 v157, v142, v156
    v_fmac_f32 v165, v146, v164
    v_mfma_f32_32x32x16_bf16 v[112:127], v[36:39], v[212:215], v[112:127]
    ds_read_b64_tr_b16 v[28:29], v22 offset:57344
    ds_read_b64_tr_b16 v[30:31], v22 offset:57856
    v_fmac_f32_dpp v149, v148, v139 quad_perm:[1,0,3,2] row_mask:0xf bank_mask:0xf
    v_fmac_f32_dpp v157, v156, v143 quad_perm:[1,0,3,2] row_mask:0xf bank_mask:0xf
    v_fmac_f32_dpp v165, v164, v147 quad_perm:[1,0,3,2] row_mask:0xf bank_mask:0xf
    v_fmac_f32 v150, v138, v149
    v_fmac_f32 v158, v142, v157
    v_fmac_f32 v166, v146, v165
    v_fmac_f32_dpp v150, v149, v139 quad_perm:[1,0,3,2] row_mask:0xf bank_mask:0xf
    v_fmac_f32_dpp v158, v157, v143 quad_perm:[1,0,3,2] row_mask:0xf bank_mask:0xf
    v_fmac_f32_dpp v166, v165, v147 quad_perm:[1,0,3,2] row_mask:0xf bank_mask:0xf
    v_fmac_f32 v151, v138, v150
    v_fmac_f32 v159, v142, v158
    v_fmac_f32 v167, v146, v166
    s_waitcnt lgkmcnt(5)
    v_mfma_f32_32x32x16_bf16 v[96:111], v[24:27], v[216:219], v[96:111]
    ds_read_b64_tr_b16 v[32:33], v21 offset:59392
    ds_read_b64_tr_b16 v[34:35], v21 offset:59904
    v_fmac_f32_dpp v151, v150, v139 quad_perm:[1,0,3,2] row_mask:0xf bank_mask:0xf
    v_fmac_f32_dpp v159, v158, v143 quad_perm:[1,0,3,2] row_mask:0xf bank_mask:0xf
    v_fmac_f32_dpp v167, v166, v147 quad_perm:[1,0,3,2] row_mask:0xf bank_mask:0xf
    v_fmac_f32 v152, v138, v151
    v_fmac_f32 v160, v142, v159
    v_fmac_f32 v168, v146, v167
    v_fmac_f32_dpp v152, v151, v139 quad_perm:[1,0,3,2] row_mask:0xf bank_mask:0xf
    v_fmac_f32_dpp v160, v159, v143 quad_perm:[1,0,3,2] row_mask:0xf bank_mask:0xf
    v_fmac_f32_dpp v168, v167, v147 quad_perm:[1,0,3,2] row_mask:0xf bank_mask:0xf
    v_fmac_f32 v153, v138, v152
    v_fmac_f32 v161, v142, v160
    v_fmac_f32 v169, v146, v168
    s_waitcnt lgkmcnt(2)
    v_mfma_f32_32x32x16_bf16 v[112:127], v[28:31], v[216:219], v[112:127]
    ds_read_b64_tr_b16 v[36:37], v22 offset:59392
    ds_read_b64_tr_b16 v[38:39], v22 offset:59904
    v_fmac_f32_dpp v153, v152, v139 quad_perm:[1,0,3,2] row_mask:0xf bank_mask:0xf
    v_fmac_f32_dpp v161, v160, v143 quad_perm:[1,0,3,2] row_mask:0xf bank_mask:0xf
    v_fmac_f32_dpp v169, v168, v147 quad_perm:[1,0,3,2] row_mask:0xf bank_mask:0xf
    v_fmac_f32 v154, v138, v153
    v_fmac_f32 v162, v142, v161
    v_fmac_f32 v170, v146, v169
    v_fmac_f32_dpp v154, v153, v139 quad_perm:[1,0,3,2] row_mask:0xf bank_mask:0xf
    v_fmac_f32_dpp v162, v161, v143 quad_perm:[1,0,3,2] row_mask:0xf bank_mask:0xf
    v_fmac_f32_dpp v170, v169, v147 quad_perm:[1,0,3,2] row_mask:0xf bank_mask:0xf
    v_fmac_f32 v155, v138, v154
    v_fmac_f32 v163, v142, v162
    v_fmac_f32 v171, v146, v170
    s_waitcnt vmcnt(8) lgkmcnt(0)
    s_barrier
    v_mfma_f32_32x32x16_bf16 v[96:111], v[32:35], v[220:223], v[96:111]
    ds_read_b64_tr_b16 v[24:25], v21 offset:12288
    ds_read_b64_tr_b16 v[26:27], v21 offset:12800
    v_fmac_f32_dpp v155, v154, v139 quad_perm:[1,0,3,2] row_mask:0xf bank_mask:0xf
    v_fmac_f32_dpp v163, v162, v143 quad_perm:[1,0,3,2] row_mask:0xf bank_mask:0xf
    v_fmac_f32_dpp v171, v170, v147 quad_perm:[1,0,3,2] row_mask:0xf bank_mask:0xf
    v_fmac_f32 v48, v136, v155
    v_fmac_f32 v64, v140, v163
    v_fmac_f32 v80, v144, v171
    v_fmac_f32_dpp v48, v155, v137 quad_perm:[1,0,3,2] row_mask:0xf bank_mask:0xf
    v_fmac_f32_dpp v64, v163, v141 quad_perm:[1,0,3,2] row_mask:0xf bank_mask:0xf
    v_fmac_f32_dpp v80, v171, v145 quad_perm:[1,0,3,2] row_mask:0xf bank_mask:0xf
    v_fmac_f32 v49, v136, v48
    v_fmac_f32 v65, v140, v64
    v_fmac_f32 v81, v144, v80
    v_mfma_f32_32x32x16_bf16 v[112:127], v[36:39], v[220:223], v[112:127]
    ds_read_b64_tr_b16 v[28:29], v22 offset:12288
    ds_read_b64_tr_b16 v[30:31], v22 offset:12800
    v_fmac_f32_dpp v49, v48, v137 quad_perm:[1,0,3,2] row_mask:0xf bank_mask:0xf
    v_fmac_f32_dpp v65, v64, v141 quad_perm:[1,0,3,2] row_mask:0xf bank_mask:0xf
    v_fmac_f32_dpp v81, v80, v145 quad_perm:[1,0,3,2] row_mask:0xf bank_mask:0xf
    v_fmac_f32 v50, v136, v49
    v_fmac_f32 v66, v140, v65
    v_fmac_f32 v82, v144, v81
    v_mul_f32 v172, v12, v48
    v_fmac_f32_dpp v172, v48, v13 quad_perm:[1,0,3,2] row_mask:0xf bank_mask:0xf
    v_mul_f32 v174, v14, v64
    v_fmac_f32_dpp v174, v64, v15 quad_perm:[1,0,3,2] row_mask:0xf bank_mask:0xf
    v_mul_f32 v176, v16, v80
    v_fmac_f32_dpp v176, v80, v17 quad_perm:[1,0,3,2] row_mask:0xf bank_mask:0xf
    v_fmac_f32_dpp v50, v49, v137 quad_perm:[1,0,3,2] row_mask:0xf bank_mask:0xf
    v_fmac_f32_dpp v66, v65, v141 quad_perm:[1,0,3,2] row_mask:0xf bank_mask:0xf
    v_fmac_f32_dpp v82, v81, v145 quad_perm:[1,0,3,2] row_mask:0xf bank_mask:0xf
    s_add_u32 m0, s94, 8192
    s_add_u32 s15, s95, 65536
    buffer_load_dwordx4 v6, s[72:75], s15 offen lds
    buffer_load_dwordx4 v7, s[72:75], s15 offen offset:1024 lds
    s_waitcnt lgkmcnt(2)
    v_mfma_f32_32x32x16_bf16 v[96:111], v[24:27], v[224:227], v[96:111]
    ds_read_b64_tr_b16 v[32:33], v21 offset:14336
    ds_read_b64_tr_b16 v[34:35], v21 offset:14848
    v_fmac_f32 v51, v136, v50
    v_fmac_f32 v67, v140, v66
    v_fmac_f32 v83, v144, v82
    v_mul_f32 v173, v12, v49
    v_fmac_f32_dpp v173, v49, v13 quad_perm:[1,0,3,2] row_mask:0xf bank_mask:0xf
    v_cvt_pk_bf16_f32 v148, v172, v173
    v_mul_f32 v175, v14, v65
    v_fmac_f32_dpp v175, v65, v15 quad_perm:[1,0,3,2] row_mask:0xf bank_mask:0xf
    v_cvt_pk_bf16_f32 v156, v174, v175
    v_mul_f32 v177, v16, v81
    v_fmac_f32_dpp v177, v81, v17 quad_perm:[1,0,3,2] row_mask:0xf bank_mask:0xf
    v_cvt_pk_bf16_f32 v164, v176, v177
    v_fmac_f32_dpp v51, v50, v137 quad_perm:[1,0,3,2] row_mask:0xf bank_mask:0xf
    v_fmac_f32_dpp v67, v66, v141 quad_perm:[1,0,3,2] row_mask:0xf bank_mask:0xf
    v_fmac_f32_dpp v83, v82, v145 quad_perm:[1,0,3,2] row_mask:0xf bank_mask:0xf
    v_fmac_f32 v52, v136, v51
    v_fmac_f32 v68, v140, v67
    v_fmac_f32 v84, v144, v83
    s_waitcnt lgkmcnt(2)
    v_mfma_f32_32x32x16_bf16 v[112:127], v[28:31], v[224:227], v[112:127]
    ds_read_b64_tr_b16 v[36:37], v22 offset:14336
    ds_read_b64_tr_b16 v[38:39], v22 offset:14848
    v_mul_f32 v172, v12, v50
    v_fmac_f32_dpp v172, v50, v13 quad_perm:[1,0,3,2] row_mask:0xf bank_mask:0xf
    v_mul_f32 v174, v14, v66
    v_fmac_f32_dpp v174, v66, v15 quad_perm:[1,0,3,2] row_mask:0xf bank_mask:0xf
    v_mul_f32 v176, v16, v82
    v_fmac_f32_dpp v176, v82, v17 quad_perm:[1,0,3,2] row_mask:0xf bank_mask:0xf
    v_fmac_f32_dpp v52, v51, v137 quad_perm:[1,0,3,2] row_mask:0xf bank_mask:0xf
    v_fmac_f32_dpp v68, v67, v141 quad_perm:[1,0,3,2] row_mask:0xf bank_mask:0xf
    v_fmac_f32_dpp v84, v83, v145 quad_perm:[1,0,3,2] row_mask:0xf bank_mask:0xf
    v_fmac_f32 v53, v136, v52
    v_fmac_f32 v69, v140, v68
    v_fmac_f32 v85, v144, v84
    v_mul_f32 v173, v12, v51
    v_fmac_f32_dpp v173, v51, v13 quad_perm:[1,0,3,2] row_mask:0xf bank_mask:0xf
    v_cvt_pk_bf16_f32 v149, v172, v173
    v_mul_f32 v175, v14, v67
    v_fmac_f32_dpp v175, v67, v15 quad_perm:[1,0,3,2] row_mask:0xf bank_mask:0xf
    v_cvt_pk_bf16_f32 v157, v174, v175
    v_mul_f32 v177, v16, v83
    v_fmac_f32_dpp v177, v83, v17 quad_perm:[1,0,3,2] row_mask:0xf bank_mask:0xf
    v_cvt_pk_bf16_f32 v165, v176, v177
    s_add_u32 m0, s94, 10240
    s_add_u32 s15, s95, 81920
    buffer_load_dwordx4 v6, s[72:75], s15 offen lds
    buffer_load_dwordx4 v7, s[72:75], s15 offen offset:1024 lds
    s_waitcnt lgkmcnt(2)
    v_mfma_f32_32x32x16_bf16 v[96:111], v[32:35], v[228:231], v[96:111]
    ds_read_b64_tr_b16 v[24:25], v21 offset:28672
    ds_read_b64_tr_b16 v[26:27], v21 offset:29184
    v_fmac_f32_dpp v53, v52, v137 quad_perm:[1,0,3,2] row_mask:0xf bank_mask:0xf
    v_fmac_f32_dpp v69, v68, v141 quad_perm:[1,0,3,2] row_mask:0xf bank_mask:0xf
    v_fmac_f32_dpp v85, v84, v145 quad_perm:[1,0,3,2] row_mask:0xf bank_mask:0xf
    v_fmac_f32 v54, v136, v53
    v_fmac_f32 v70, v140, v69
    v_fmac_f32 v86, v144, v85
    v_mul_f32 v172, v12, v52
    v_fmac_f32_dpp v172, v52, v13 quad_perm:[1,0,3,2] row_mask:0xf bank_mask:0xf
    v_mul_f32 v174, v14, v68
    v_fmac_f32_dpp v174, v68, v15 quad_perm:[1,0,3,2] row_mask:0xf bank_mask:0xf
    v_mul_f32 v176, v16, v84
    v_fmac_f32_dpp v176, v84, v17 quad_perm:[1,0,3,2] row_mask:0xf bank_mask:0xf
    v_fmac_f32_dpp v54, v53, v137 quad_perm:[1,0,3,2] row_mask:0xf bank_mask:0xf
    v_fmac_f32_dpp v70, v69, v141 quad_perm:[1,0,3,2] row_mask:0xf bank_mask:0xf
    v_fmac_f32_dpp v86, v85, v145 quad_perm:[1,0,3,2] row_mask:0xf bank_mask:0xf
    s_waitcnt lgkmcnt(2)
    v_mfma_f32_32x32x16_bf16 v[112:127], v[36:39], v[228:231], v[112:127]
    ds_read_b64_tr_b16 v[28:29], v22 offset:28672
    ds_read_b64_tr_b16 v[30:31], v22 offset:29184
    v_fmac_f32 v55, v136, v54
    v_fmac_f32 v71, v140, v70
    v_fmac_f32 v87, v144, v86
    v_mul_f32 v173, v12, v53
    v_fmac_f32_dpp v173, v53, v13 quad_perm:[1,0,3,2] row_mask:0xf bank_mask:0xf
    v_cvt_pk_bf16_f32 v150, v172, v173
    v_mul_f32 v175, v14, v69
    v_fmac_f32_dpp v175, v69, v15 quad_perm:[1,0,3,2] row_mask:0xf bank_mask:0xf
    v_cvt_pk_bf16_f32 v158, v174, v175
    v_mul_f32 v177, v16, v85
    v_fmac_f32_dpp v177, v85, v17 quad_perm:[1,0,3,2] row_mask:0xf bank_mask:0xf
    v_cvt_pk_bf16_f32 v166, v176, v177
    v_fmac_f32_dpp v55, v54, v137 quad_perm:[1,0,3,2] row_mask:0xf bank_mask:0xf
    v_fmac_f32_dpp v71, v70, v141 quad_perm:[1,0,3,2] row_mask:0xf bank_mask:0xf
    v_fmac_f32_dpp v87, v86, v145 quad_perm:[1,0,3,2] row_mask:0xf bank_mask:0xf
    v_fmac_f32 v56, v136, v55
    v_fmac_f32 v72, v140, v71
    v_fmac_f32 v88, v144, v87
    s_waitcnt lgkmcnt(2)
    v_mfma_f32_32x32x16_bf16 v[96:111], v[24:27], v[232:235], v[96:111]
    ds_read_b64_tr_b16 v[32:33], v21 offset:30720
    ds_read_b64_tr_b16 v[34:35], v21 offset:31232
    v_mul_f32 v172, v12, v54
    v_fmac_f32_dpp v172, v54, v13 quad_perm:[1,0,3,2] row_mask:0xf bank_mask:0xf
    v_mul_f32 v174, v14, v70
    v_fmac_f32_dpp v174, v70, v15 quad_perm:[1,0,3,2] row_mask:0xf bank_mask:0xf
    v_mul_f32 v176, v16, v86
    v_fmac_f32_dpp v176, v86, v17 quad_perm:[1,0,3,2] row_mask:0xf bank_mask:0xf
    v_fmac_f32_dpp v56, v55, v137 quad_perm:[1,0,3,2] row_mask:0xf bank_mask:0xf
    v_fmac_f32_dpp v72, v71, v141 quad_perm:[1,0,3,2] row_mask:0xf bank_mask:0xf
    v_fmac_f32_dpp v88, v87, v145 quad_perm:[1,0,3,2] row_mask:0xf bank_mask:0xf
    v_fmac_f32 v57, v136, v56
    v_fmac_f32 v73, v140, v72
    v_fmac_f32 v89, v144, v88
    v_mul_f32 v173, v12, v55
    v_fmac_f32_dpp v173, v55, v13 quad_perm:[1,0,3,2] row_mask:0xf bank_mask:0xf
    v_cvt_pk_bf16_f32 v151, v172, v173
    v_mul_f32 v175, v14, v71
    v_fmac_f32_dpp v175, v71, v15 quad_perm:[1,0,3,2] row_mask:0xf bank_mask:0xf
    v_cvt_pk_bf16_f32 v159, v174, v175
    v_mul_f32 v177, v16, v87
    v_fmac_f32_dpp v177, v87, v17 quad_perm:[1,0,3,2] row_mask:0xf bank_mask:0xf
    v_cvt_pk_bf16_f32 v167, v176, v177
    s_waitcnt lgkmcnt(2)
    v_mfma_f32_32x32x16_bf16 v[112:127], v[28:31], v[232:235], v[112:127]
    ds_read_b64_tr_b16 v[36:37], v22 offset:30720
    ds_read_b64_tr_b16 v[38:39], v22 offset:31232
    v_fmac_f32_dpp v57, v56, v137 quad_perm:[1,0,3,2] row_mask:0xf bank_mask:0xf
    v_fmac_f32_dpp v73, v72, v141 quad_perm:[1,0,3,2] row_mask:0xf bank_mask:0xf
    v_fmac_f32_dpp v89, v88, v145 quad_perm:[1,0,3,2] row_mask:0xf bank_mask:0xf
    v_fmac_f32 v58, v136, v57
    v_fmac_f32 v74, v140, v73
    v_fmac_f32 v90, v144, v89
    v_mul_f32 v172, v12, v56
    v_fmac_f32_dpp v172, v56, v13 quad_perm:[1,0,3,2] row_mask:0xf bank_mask:0xf
    v_mul_f32 v174, v14, v72
    v_fmac_f32_dpp v174, v72, v15 quad_perm:[1,0,3,2] row_mask:0xf bank_mask:0xf
    v_mul_f32 v176, v16, v88
    v_fmac_f32_dpp v176, v88, v17 quad_perm:[1,0,3,2] row_mask:0xf bank_mask:0xf
    v_fmac_f32_dpp v58, v57, v137 quad_perm:[1,0,3,2] row_mask:0xf bank_mask:0xf
    v_fmac_f32_dpp v74, v73, v141 quad_perm:[1,0,3,2] row_mask:0xf bank_mask:0xf
    v_fmac_f32_dpp v90, v89, v145 quad_perm:[1,0,3,2] row_mask:0xf bank_mask:0xf
    s_waitcnt lgkmcnt(2)
    v_mfma_f32_32x32x16_bf16 v[96:111], v[32:35], v[236:239], v[96:111]
    ds_read_b64_tr_b16 v[24:25], v21 offset:45056
    ds_read_b64_tr_b16 v[26:27], v21 offset:45568
    v_fmac_f32 v59, v136, v58
    v_fmac_f32 v75, v140, v74
    v_fmac_f32 v91, v144, v90
    v_mul_f32 v173, v12, v57
    v_fmac_f32_dpp v173, v57, v13 quad_perm:[1,0,3,2] row_mask:0xf bank_mask:0xf
    v_cvt_pk_bf16_f32 v152, v172, v173
    v_mul_f32 v175, v14, v73
    v_fmac_f32_dpp v175, v73, v15 quad_perm:[1,0,3,2] row_mask:0xf bank_mask:0xf
    v_cvt_pk_bf16_f32 v160, v174, v175
    v_mul_f32 v177, v16, v89
    v_fmac_f32_dpp v177, v89, v17 quad_perm:[1,0,3,2] row_mask:0xf bank_mask:0xf
    v_cvt_pk_bf16_f32 v168, v176, v177
    v_fmac_f32_dpp v59, v58, v137 quad_perm:[1,0,3,2] row_mask:0xf bank_mask:0xf
    v_fmac_f32_dpp v75, v74, v141 quad_perm:[1,0,3,2] row_mask:0xf bank_mask:0xf
    v_fmac_f32_dpp v91, v90, v145 quad_perm:[1,0,3,2] row_mask:0xf bank_mask:0xf
    v_fmac_f32 v60, v136, v59
    v_fmac_f32 v76, v140, v75
    v_fmac_f32 v92, v144, v91
    s_waitcnt lgkmcnt(2)
    v_mfma_f32_32x32x16_bf16 v[112:127], v[36:39], v[236:239], v[112:127]
    ds_read_b64_tr_b16 v[28:29], v22 offset:45056
    ds_read_b64_tr_b16 v[30:31], v22 offset:45568
    v_mul_f32 v172, v12, v58
    v_fmac_f32_dpp v172, v58, v13 quad_perm:[1,0,3,2] row_mask:0xf bank_mask:0xf
    v_mul_f32 v174, v14, v74
    v_fmac_f32_dpp v174, v74, v15 quad_perm:[1,0,3,2] row_mask:0xf bank_mask:0xf
    v_mul_f32 v176, v16, v90
    v_fmac_f32_dpp v176, v90, v17 quad_perm:[1,0,3,2] row_mask:0xf bank_mask:0xf
    v_fmac_f32_dpp v60, v59, v137 quad_perm:[1,0,3,2] row_mask:0xf bank_mask:0xf
    v_fmac_f32_dpp v76, v75, v141 quad_perm:[1,0,3,2] row_mask:0xf bank_mask:0xf
    v_fmac_f32_dpp v92, v91, v145 quad_perm:[1,0,3,2] row_mask:0xf bank_mask:0xf
    v_fmac_f32 v61, v136, v60
    v_fmac_f32 v77, v140, v76
    v_fmac_f32 v93, v144, v92
    v_mul_f32 v173, v12, v59
    v_fmac_f32_dpp v173, v59, v13 quad_perm:[1,0,3,2] row_mask:0xf bank_mask:0xf
    v_cvt_pk_bf16_f32 v153, v172, v173
    v_mul_f32 v175, v14, v75
    v_fmac_f32_dpp v175, v75, v15 quad_perm:[1,0,3,2] row_mask:0xf bank_mask:0xf
    v_cvt_pk_bf16_f32 v161, v174, v175
    v_mul_f32 v177, v16, v91
    v_fmac_f32_dpp v177, v91, v17 quad_perm:[1,0,3,2] row_mask:0xf bank_mask:0xf
    v_cvt_pk_bf16_f32 v169, v176, v177
    s_waitcnt lgkmcnt(2)
    v_mfma_f32_32x32x16_bf16 v[96:111], v[24:27], v[240:243], v[96:111]
    ds_read_b64_tr_b16 v[32:33], v21 offset:47104
    ds_read_b64_tr_b16 v[34:35], v21 offset:47616
    v_fmac_f32_dpp v61, v60, v137 quad_perm:[1,0,3,2] row_mask:0xf bank_mask:0xf
    v_fmac_f32_dpp v77, v76, v141 quad_perm:[1,0,3,2] row_mask:0xf bank_mask:0xf
    v_fmac_f32_dpp v93, v92, v145 quad_perm:[1,0,3,2] row_mask:0xf bank_mask:0xf
    v_fmac_f32 v62, v136, v61
    v_fmac_f32 v78, v140, v77
    v_fmac_f32 v94, v144, v93
    v_mul_f32 v172, v12, v60
    v_fmac_f32_dpp v172, v60, v13 quad_perm:[1,0,3,2] row_mask:0xf bank_mask:0xf
    v_mul_f32 v174, v14, v76
    v_fmac_f32_dpp v174, v76, v15 quad_perm:[1,0,3,2] row_mask:0xf bank_mask:0xf
    v_mul_f32 v176, v16, v92
    v_fmac_f32_dpp v176, v92, v17 quad_perm:[1,0,3,2] row_mask:0xf bank_mask:0xf
    v_fmac_f32_dpp v62, v61, v137 quad_perm:[1,0,3,2] row_mask:0xf bank_mask:0xf
    v_fmac_f32_dpp v78, v77, v141 quad_perm:[1,0,3,2] row_mask:0xf bank_mask:0xf
    v_fmac_f32_dpp v94, v93, v145 quad_perm:[1,0,3,2] row_mask:0xf bank_mask:0xf
    s_waitcnt lgkmcnt(2)
    v_mfma_f32_32x32x16_bf16 v[112:127], v[28:31], v[240:243], v[112:127]
    ds_read_b64_tr_b16 v[36:37], v22 offset:47104
    ds_read_b64_tr_b16 v[38:39], v22 offset:47616
    v_fmac_f32 v63, v136, v62
    v_fmac_f32 v79, v140, v78
    v_fmac_f32 v95, v144, v94
    v_mul_f32 v173, v12, v61
    v_fmac_f32_dpp v173, v61, v13 quad_perm:[1,0,3,2] row_mask:0xf bank_mask:0xf
    v_cvt_pk_bf16_f32 v154, v172, v173
    v_mul_f32 v175, v14, v77
    v_fmac_f32_dpp v175, v77, v15 quad_perm:[1,0,3,2] row_mask:0xf bank_mask:0xf
    v_cvt_pk_bf16_f32 v162, v174, v175
    v_mul_f32 v177, v16, v93
    v_fmac_f32_dpp v177, v93, v17 quad_perm:[1,0,3,2] row_mask:0xf bank_mask:0xf
    v_cvt_pk_bf16_f32 v170, v176, v177
    v_fmac_f32_dpp v63, v62, v137 quad_perm:[1,0,3,2] row_mask:0xf bank_mask:0xf
    v_fmac_f32_dpp v79, v78, v141 quad_perm:[1,0,3,2] row_mask:0xf bank_mask:0xf
    v_fmac_f32_dpp v95, v94, v145 quad_perm:[1,0,3,2] row_mask:0xf bank_mask:0xf
    v_mul_f32 v172, v12, v62
    v_fmac_f32_dpp v172, v62, v13 quad_perm:[1,0,3,2] row_mask:0xf bank_mask:0xf
    v_mul_f32 v174, v14, v78
    v_fmac_f32_dpp v174, v78, v15 quad_perm:[1,0,3,2] row_mask:0xf bank_mask:0xf
    v_mul_f32 v176, v16, v94
    v_fmac_f32_dpp v176, v94, v17 quad_perm:[1,0,3,2] row_mask:0xf bank_mask:0xf
    s_waitcnt lgkmcnt(2)
    v_mfma_f32_32x32x16_bf16 v[96:111], v[32:35], v[244:247], v[96:111]
    ds_read_b64_tr_b16 v[24:25], v21 offset:61440
    ds_read_b64_tr_b16 v[26:27], v21 offset:61952
    v_mul_f32 v173, v12, v63
    v_fmac_f32_dpp v173, v63, v13 quad_perm:[1,0,3,2] row_mask:0xf bank_mask:0xf
    v_cvt_pk_bf16_f32 v155, v172, v173
    v_mul_f32 v175, v14, v79
    v_fmac_f32_dpp v175, v79, v15 quad_perm:[1,0,3,2] row_mask:0xf bank_mask:0xf
    v_cvt_pk_bf16_f32 v163, v174, v175
    v_mul_f32 v177, v16, v95
    v_fmac_f32_dpp v177, v95, v17 quad_perm:[1,0,3,2] row_mask:0xf bank_mask:0xf
    v_cvt_pk_bf16_f32 v171, v176, v177
    s_mov_b32 exec_lo, 0x0000ffff
    s_mov_b32 exec_hi, 0x0000ffff
    ds_write_b128 v10, v[148:151]
    ds_write_b128 v10, v[152:155] offset:16
    s_mov_b64 exec, -1
    ds_read_b64_tr_b16 v[48:49], v11 offset:0
    ds_read_b64_tr_b16 v[50:51], v11 offset:640
    s_mov_b32 exec_lo, 0xffff0000
    s_mov_b32 exec_hi, 0xffff0000
    ds_write_b128 v10, v[148:151]
    ds_write_b128 v10, v[152:155] offset:16
    s_mov_b64 exec, -1
    ds_read_b64_tr_b16 v[52:53], v11 offset:0
    ds_read_b64_tr_b16 v[54:55], v11 offset:640
    s_mov_b32 exec_lo, 0x0000ffff
    s_mov_b32 exec_hi, 0x0000ffff
    ds_write_b128 v10, v[156:159]
    ds_write_b128 v10, v[160:163] offset:16
    s_mov_b64 exec, -1
    ds_read_b64_tr_b16 v[64:65], v11 offset:0
    ds_read_b64_tr_b16 v[66:67], v11 offset:640
    s_waitcnt lgkmcnt(14)
    v_mfma_f32_32x32x16_bf16 v[112:127], v[36:39], v[244:247], v[112:127]
    ds_read_b64_tr_b16 v[28:29], v22 offset:61440
    ds_read_b64_tr_b16 v[30:31], v22 offset:61952
    s_mov_b32 exec_lo, 0xffff0000
    s_mov_b32 exec_hi, 0xffff0000
    ds_write_b128 v10, v[156:159]
    ds_write_b128 v10, v[160:163] offset:16
    s_mov_b64 exec, -1
    ds_read_b64_tr_b16 v[68:69], v11 offset:0
    ds_read_b64_tr_b16 v[70:71], v11 offset:640
    s_waitcnt lgkmcnt(10)
    s_add_u32 s12, s84, 4096
    buffer_store_dwordx4 v[48:51], v23, s[68:71], s12 offen sc1
    buffer_store_dwordx4 v[52:55], v23, s[68:71], s12 offen offset:1024 sc1
    s_mov_b32 exec_lo, 0x0000ffff
    s_mov_b32 exec_hi, 0x0000ffff
    ds_write_b128 v10, v[164:167]
    ds_write_b128 v10, v[168:171] offset:16
    s_mov_b64 exec, -1
    ds_read_b64_tr_b16 v[80:81], v11 offset:0
    ds_read_b64_tr_b16 v[82:83], v11 offset:640
    s_mov_b32 exec_lo, 0xffff0000
    s_mov_b32 exec_hi, 0xffff0000
    ds_write_b128 v10, v[164:167]
    ds_write_b128 v10, v[168:171] offset:16
    s_mov_b64 exec, -1
    ds_read_b64_tr_b16 v[84:85], v11 offset:0
    ds_read_b64_tr_b16 v[86:87], v11 offset:640
    s_waitcnt lgkmcnt(8)
    s_add_u32 s12, s84, 6144
    buffer_store_dwordx4 v[64:67], v23, s[68:71], s12 offen sc1
    buffer_store_dwordx4 v[68:71], v23, s[68:71], s12 offen offset:1024 sc1
    s_waitcnt lgkmcnt(0)
    s_add_u32 s12, s84, 8192
    buffer_store_dwordx4 v[80:83], v23, s[68:71], s12 offen sc1
    buffer_store_dwordx4 v[84:87], v23, s[68:71], s12 offen offset:1024 sc1
    v_mfma_f32_32x32x16_bf16 v[96:111], v[24:27], v[248:251], v[96:111]
    ds_read_b64_tr_b16 v[32:33], v21 offset:63488
    ds_read_b64_tr_b16 v[34:35], v21 offset:64000
    v_mfma_f32_32x32x16_bf16 v[112:127], v[28:31], v[248:251], v[112:127]
    ds_read_b64_tr_b16 v[36:37], v22 offset:63488
    ds_read_b64_tr_b16 v[38:39], v22 offset:64000
    s_waitcnt lgkmcnt(2)
    v_mfma_f32_32x32x16_bf16 v[96:111], v[32:35], v[252:255], v[96:111]
    s_waitcnt lgkmcnt(0)
    v_mfma_f32_32x32x16_bf16 v[112:127], v[36:39], v[252:255], v[112:127]
    s_nop 7
    s_nop 3
    v_pk_mul_f32 v[40:41], s[80:81], v[96:97] op_sel:[1,0] op_sel_hi:[1,1]
    v_pk_mul_f32 v[42:43], s[80:81], v[98:99] op_sel:[1,0] op_sel_hi:[1,1]
    v_pk_mul_f32 v[44:45], s[80:81], v[100:101] op_sel:[1,0] op_sel_hi:[1,1]
    v_pk_mul_f32 v[46:47], s[80:81], v[102:103] op_sel:[1,0] op_sel_hi:[1,1]
    v_exp_f32 v40, v40
    v_exp_f32 v41, v41
    v_pk_mul_f32 v[104:105], v[96:97], v[104:105]
    v_exp_f32 v42, v42
    v_exp_f32 v43, v43
    v_pk_mul_f32 v[106:107], v[98:99], v[106:107]
    v_exp_f32 v44, v44
    v_exp_f32 v45, v45
    v_pk_mul_f32 v[108:109], v[100:101], v[108:109]
    v_exp_f32 v46, v46
    v_exp_f32 v47, v47
    v_pk_mul_f32 v[110:111], v[102:103], v[110:111]
    v_pk_add_f32 v[40:41], v[40:41], 1.0 op_sel_hi:[1,0]
    v_pk_add_f32 v[42:43], v[42:43], 1.0 op_sel_hi:[1,0]
    v_pk_add_f32 v[44:45], v[44:45], 1.0 op_sel_hi:[1,0]
    v_pk_add_f32 v[46:47], v[46:47], 1.0 op_sel_hi:[1,0]
    v_rcp_f32 v40, v40
    v_rcp_f32 v41, v41
    v_rcp_f32 v42, v42
    v_rcp_f32 v43, v43
    v_pk_mul_f32 v[104:105], v[104:105], v[40:41]
    v_rcp_f32 v44, v44
    v_rcp_f32 v45, v45
    v_pk_mul_f32 v[106:107], v[106:107], v[42:43]
    v_rcp_f32 v46, v46
    v_rcp_f32 v47, v47
    v_pk_mul_f32 v[108:109], v[108:109], v[44:45]
    v_pk_mul_f32 v[110:111], v[110:111], v[46:47]
    v_cvt_pk_bf16_f32 v96, v104, v105
    v_cvt_pk_bf16_f32 v97, v106, v107
    v_cvt_pk_bf16_f32 v98, v108, v109
    v_cvt_pk_bf16_f32 v99, v110, v111
    buffer_store_dwordx4 v[96:99], v23, s[68:71], s83 offen offset:2048 sc1
    v_pk_mul_f32 v[40:41], s[80:81], v[112:113] op_sel:[1,0] op_sel_hi:[1,1]
    v_pk_mul_f32 v[42:43], s[80:81], v[114:115] op_sel:[1,0] op_sel_hi:[1,1]
    v_pk_mul_f32 v[44:45], s[80:81], v[116:117] op_sel:[1,0] op_sel_hi:[1,1]
    v_pk_mul_f32 v[46:47], s[80:81], v[118:119] op_sel:[1,0] op_sel_hi:[1,1]
    v_exp_f32 v40, v40
    v_exp_f32 v41, v41
    v_pk_mul_f32 v[120:121], v[112:113], v[120:121]
    v_exp_f32 v42, v42
    v_exp_f32 v43, v43
    v_pk_mul_f32 v[122:123], v[114:115], v[122:123]
    v_exp_f32 v44, v44
    v_exp_f32 v45, v45
    v_pk_mul_f32 v[124:125], v[116:117], v[124:125]
    v_exp_f32 v46, v46
    v_exp_f32 v47, v47
    v_pk_mul_f32 v[126:127], v[118:119], v[126:127]
    v_pk_add_f32 v[40:41], v[40:41], 1.0 op_sel_hi:[1,0]
    v_pk_add_f32 v[42:43], v[42:43], 1.0 op_sel_hi:[1,0]
    v_pk_add_f32 v[44:45], v[44:45], 1.0 op_sel_hi:[1,0]
    v_pk_add_f32 v[46:47], v[46:47], 1.0 op_sel_hi:[1,0]
    v_rcp_f32 v40, v40
    v_rcp_f32 v41, v41
    v_rcp_f32 v42, v42
    v_rcp_f32 v43, v43
    v_pk_mul_f32 v[120:121], v[120:121], v[40:41]
    v_rcp_f32 v44, v44
    v_rcp_f32 v45, v45
    v_pk_mul_f32 v[122:123], v[122:123], v[42:43]
    v_rcp_f32 v46, v46
    v_rcp_f32 v47, v47
    v_pk_mul_f32 v[124:125], v[124:125], v[44:45]
    v_pk_mul_f32 v[126:127], v[126:127], v[46:47]
    v_cvt_pk_bf16_f32 v112, v120, v121
    v_cvt_pk_bf16_f32 v113, v122, v123
    v_cvt_pk_bf16_f32 v114, v124, v125
    v_cvt_pk_bf16_f32 v115, v126, v127
    buffer_store_dwordx4 v[112:115], v23, s[68:71], s83 offen offset:3072 sc1
    s_waitcnt vmcnt(0)
    s_setprio 0
    s_barrier
    s_nop 11
    s_add_u32 m0, s94, 12288
    s_add_u32 s15, s95, 98304
    buffer_load_dwordx4 v6, s[72:75], s15 offen lds
    buffer_load_dwordx4 v7, s[72:75], s15 offen offset:1024 lds
    s_add_u32 m0, s94, 14336
    s_add_u32 s15, s95, 114688
    buffer_load_dwordx4 v6, s[72:75], s15 offen lds
    buffer_load_dwordx4 v7, s[72:75], s15 offen offset:1024 lds
    s_lshl_b32 s15, s4, 13
    s_add_u32 m0, s15, 131072
    s_add_u32 s15, s95, 393216
    buffer_load_dwordx4 v6, s[72:75], s15 offen lds
    buffer_load_dwordx4 v7, s[72:75], s15 offen offset:1024 lds
    s_lshl_b32 s15, s4, 13
    s_add_u32 m0, s15, 133120
    s_add_u32 s15, s95, 409600
    buffer_load_dwordx4 v6, s[72:75], s15 offen lds
    buffer_load_dwordx4 v7, s[72:75], s15 offen offset:1024 lds
    s_lshl_b32 s15, s4, 13
    s_add_u32 m0, s15, 135168
    s_add_u32 s15, s95, 425984
    buffer_load_dwordx4 v6, s[72:75], s15 offen lds
    buffer_load_dwordx4 v7, s[72:75], s15 offen offset:1024 lds
    s_lshl_b32 s15, s4, 13
    s_add_u32 m0, s15, 137216
    s_add_u32 s15, s95, 442368
    buffer_load_dwordx4 v6, s[72:75], s15 offen lds
    buffer_load_dwordx4 v7, s[72:75], s15 offen offset:1024 lds
    ds_read_b64_tr_b16 v[128:129], v8 offset:0
    ds_read_b64_tr_b16 v[130:131], v8 offset:1024
    ds_read_b64_tr_b16 v[132:133], v9 offset:0
    ds_read_b64_tr_b16 v[134:135], v9 offset:1024
    s_waitcnt lgkmcnt(0)
    s_add_u32 m0, s94, 0
    s_add_u32 s15, s95, 131072
    buffer_load_dwordx4 v6, s[72:75], s15 offen lds
    buffer_load_dwordx4 v7, s[72:75], s15 offen offset:1024 lds
    ds_read_b64_tr_b16 v[136:137], v8 offset:2048
    ds_read_b64_tr_b16 v[138:139], v8 offset:3072
    ds_read_b64_tr_b16 v[140:141], v9 offset:2048
    ds_read_b64_tr_b16 v[142:143], v9 offset:3072
    s_waitcnt lgkmcnt(0)
    s_add_u32 m0, s94, 2048
    s_add_u32 s15, s95, 147456
    buffer_load_dwordx4 v6, s[72:75], s15 offen lds
    buffer_load_dwordx4 v7, s[72:75], s15 offen offset:1024 lds
    ds_read_b64_tr_b16 v[144:145], v8 offset:4096
    ds_read_b64_tr_b16 v[146:147], v8 offset:5120
    ds_read_b64_tr_b16 v[148:149], v9 offset:4096
    ds_read_b64_tr_b16 v[150:151], v9 offset:5120
    s_waitcnt lgkmcnt(0)
    s_add_u32 m0, s94, 4096
    s_add_u32 s15, s95, 163840
    buffer_load_dwordx4 v6, s[72:75], s15 offen lds
    buffer_load_dwordx4 v7, s[72:75], s15 offen offset:1024 lds
    ds_read_b64_tr_b16 v[152:153], v8 offset:6144
    ds_read_b64_tr_b16 v[154:155], v8 offset:7168
    ds_read_b64_tr_b16 v[156:157], v9 offset:6144
    ds_read_b64_tr_b16 v[158:159], v9 offset:7168
    s_waitcnt lgkmcnt(0)
    s_add_u32 m0, s94, 6144
    s_add_u32 s15, s95, 180224
    buffer_load_dwordx4 v6, s[72:75], s15 offen lds
    buffer_load_dwordx4 v7, s[72:75], s15 offen offset:1024 lds
    ds_read_b64_tr_b16 v[160:161], v8 offset:8192
    ds_read_b64_tr_b16 v[162:163], v8 offset:9216
    ds_read_b64_tr_b16 v[164:165], v9 offset:8192
    ds_read_b64_tr_b16 v[166:167], v9 offset:9216
    s_waitcnt lgkmcnt(0)
    s_add_u32 m0, s94, 8192
    s_add_u32 s15, s95, 196608
    buffer_load_dwordx4 v6, s[72:75], s15 offen lds
    buffer_load_dwordx4 v7, s[72:75], s15 offen offset:1024 lds
    ds_read_b64_tr_b16 v[168:169], v8 offset:10240
    ds_read_b64_tr_b16 v[170:171], v8 offset:11264
    ds_read_b64_tr_b16 v[172:173], v9 offset:10240
    ds_read_b64_tr_b16 v[174:175], v9 offset:11264
    s_waitcnt lgkmcnt(0)
    s_add_u32 m0, s94, 10240
    s_add_u32 s15, s95, 212992
    buffer_load_dwordx4 v6, s[72:75], s15 offen lds
    buffer_load_dwordx4 v7, s[72:75], s15 offen offset:1024 lds
    s_waitcnt vmcnt(22)
    ds_read_b64_tr_b16 v[176:177], v8 offset:12288
    ds_read_b64_tr_b16 v[178:179], v8 offset:13312
    ds_read_b64_tr_b16 v[180:181], v9 offset:12288
    ds_read_b64_tr_b16 v[182:183], v9 offset:13312
    s_waitcnt lgkmcnt(0)
    s_add_u32 m0, s94, 12288
    s_add_u32 s15, s95, 229376
    buffer_load_dwordx4 v6, s[72:75], s15 offen lds
    buffer_load_dwordx4 v7, s[72:75], s15 offen offset:1024 lds
    s_waitcnt vmcnt(22)
    ds_read_b64_tr_b16 v[184:185], v8 offset:14336
    ds_read_b64_tr_b16 v[186:187], v8 offset:15360
    ds_read_b64_tr_b16 v[188:189], v9 offset:14336
    ds_read_b64_tr_b16 v[190:191], v9 offset:15360
    s_waitcnt lgkmcnt(0)
    s_add_u32 m0, s94, 14336
    s_add_u32 s15, s95, 245760
    buffer_load_dwordx4 v6, s[72:75], s15 offen lds
    buffer_load_dwordx4 v7, s[72:75], s15 offen offset:1024 lds
    s_waitcnt vmcnt(14)
    ds_read_b64_tr_b16 v[192:193], v8 offset:0
    ds_read_b64_tr_b16 v[194:195], v8 offset:1024
    ds_read_b64_tr_b16 v[196:197], v9 offset:0
    ds_read_b64_tr_b16 v[198:199], v9 offset:1024
    s_waitcnt lgkmcnt(0)
    s_add_u32 m0, s94, 0
    s_add_u32 s15, s95, 262144
    buffer_load_dwordx4 v6, s[72:75], s15 offen lds
    buffer_load_dwordx4 v7, s[72:75], s15 offen offset:1024 lds
    s_waitcnt vmcnt(14)
    ds_read_b64_tr_b16 v[200:201], v8 offset:2048
    ds_read_b64_tr_b16 v[202:203], v8 offset:3072
    ds_read_b64_tr_b16 v[204:205], v9 offset:2048
    ds_read_b64_tr_b16 v[206:207], v9 offset:3072
    s_waitcnt lgkmcnt(0)
    s_add_u32 m0, s94, 2048
    s_add_u32 s15, s95, 278528
    buffer_load_dwordx4 v6, s[72:75], s15 offen lds
    buffer_load_dwordx4 v7, s[72:75], s15 offen offset:1024 lds
    s_waitcnt vmcnt(14)
    ds_read_b64_tr_b16 v[208:209], v8 offset:4096
    ds_read_b64_tr_b16 v[210:211], v8 offset:5120
    ds_read_b64_tr_b16 v[212:213], v9 offset:4096
    ds_read_b64_tr_b16 v[214:215], v9 offset:5120
    s_waitcnt lgkmcnt(0)
    s_add_u32 m0, s94, 4096
    s_add_u32 s15, s95, 294912
    buffer_load_dwordx4 v6, s[72:75], s15 offen lds
    buffer_load_dwordx4 v7, s[72:75], s15 offen offset:1024 lds
    s_waitcnt vmcnt(14)
    ds_read_b64_tr_b16 v[216:217], v8 offset:6144
    ds_read_b64_tr_b16 v[218:219], v8 offset:7168
    ds_read_b64_tr_b16 v[220:221], v9 offset:6144
    ds_read_b64_tr_b16 v[222:223], v9 offset:7168
    s_waitcnt lgkmcnt(0)
    s_add_u32 m0, s94, 6144
    s_add_u32 s15, s95, 311296
    buffer_load_dwordx4 v6, s[72:75], s15 offen lds
    buffer_load_dwordx4 v7, s[72:75], s15 offen offset:1024 lds
    s_waitcnt vmcnt(14)
    ds_read_b64_tr_b16 v[224:225], v8 offset:8192
    ds_read_b64_tr_b16 v[226:227], v8 offset:9216
    ds_read_b64_tr_b16 v[228:229], v9 offset:8192
    ds_read_b64_tr_b16 v[230:231], v9 offset:9216
    s_waitcnt lgkmcnt(0)
    s_add_u32 m0, s94, 8192
    s_add_u32 s15, s95, 327680
    buffer_load_dwordx4 v6, s[72:75], s15 offen lds
    buffer_load_dwordx4 v7, s[72:75], s15 offen offset:1024 lds
    s_waitcnt vmcnt(14)
    ds_read_b64_tr_b16 v[232:233], v8 offset:10240
    ds_read_b64_tr_b16 v[234:235], v8 offset:11264
    ds_read_b64_tr_b16 v[236:237], v9 offset:10240
    ds_read_b64_tr_b16 v[238:239], v9 offset:11264
    s_waitcnt lgkmcnt(0)
    s_add_u32 m0, s94, 10240
    s_add_u32 s15, s95, 344064
    buffer_load_dwordx4 v6, s[72:75], s15 offen lds
    buffer_load_dwordx4 v7, s[72:75], s15 offen offset:1024 lds
    s_waitcnt vmcnt(14)
    ds_read_b64_tr_b16 v[240:241], v8 offset:12288
    ds_read_b64_tr_b16 v[242:243], v8 offset:13312
    ds_read_b64_tr_b16 v[244:245], v9 offset:12288
    ds_read_b64_tr_b16 v[246:247], v9 offset:13312
    s_waitcnt lgkmcnt(0)
    s_add_u32 m0, s94, 12288
    s_add_u32 s15, s95, 360448
    buffer_load_dwordx4 v6, s[72:75], s15 offen lds
    buffer_load_dwordx4 v7, s[72:75], s15 offen offset:1024 lds
    s_waitcnt vmcnt(14)
    ds_read_b64_tr_b16 v[248:249], v8 offset:14336
    ds_read_b64_tr_b16 v[250:251], v8 offset:15360
    ds_read_b64_tr_b16 v[252:253], v9 offset:14336
    ds_read_b64_tr_b16 v[254:255], v9 offset:15360
    s_waitcnt lgkmcnt(0)
    s_add_u32 m0, s94, 14336
    s_add_u32 s15, s95, 376832
    buffer_load_dwordx4 v6, s[72:75], s15 offen lds
    buffer_load_dwordx4 v7, s[72:75], s15 offen offset:1024 lds
    s_branch L_P2_1
L_body_Y0:
    v_mov_b32 v237, 0
    s_lshl_b32 s12, s4, 3
    s_or_b32 s12, s12, s2
    s_cmp_ge_u32 s12, 8
    s_cbranch_scc1 L_ep_skip_23
    s_memrealtime s[88:89]
    s_waitcnt lgkmcnt(0)
    s_or_b32 s12, s88, 1
    v_mov_b32 v236, s12
    s_mov_b64 exec, 1
    global_atomic_cmpswap v237, v[236:237], s[46:47] sc1
    s_mov_b64 exec, -1
L_ep_skip_23:
    s_mov_b32 s52, s16
    s_and_b32 s53, s17, 0xffff
    s_mov_b32 s54, 2097152
    s_mov_b32 s55, 0x00020000
    s_mov_b32 s60, s36
    s_and_b32 s61, s37, 0xffff
    s_mov_b32 s62, 1835008
    s_mov_b32 s63, 0x00020000
    s_mov_b32 s64, s38
    s_and_b32 s65, s39, 0xffff
    s_mov_b32 s66, 1835008
    s_mov_b32 s67, 0x00020000
    s_mov_b32 s68, s48
    s_and_b32 s69, s49, 0xffff
    s_mov_b32 s70, 14721024
    s_mov_b32 s71, 0x00020000
    s_mov_b32 s81, 0xbfb8aa3b
    s_barrier
    s_lshl_b32 s12, s6, 7
    s_lshl_b32 s13, s85, 3
    s_add_u32 s12, s12, s13
    s_add_u32 s12, s12, s3
    s_lshl_b32 s13, s12, 10
    s_lshl_b32 s87, s12, 2
    s_add_u32 s87, s87, 14417920
    v_add_u32 v239, s13, v23
    s_add_u32 s93, s11, s4
    s_lshl_b32 s93, s93, 13
    s_add_u32 s93, s93, 14426112
    s_lshl_b32 s12, s6, 8
    s_add_u32 s93, s93, s12
    s_cmp_eq_u32 s4, 0
    s_cselect_b32 s13, 4, 0
    v_mul_u32_u24 v232, s13, v99
    s_add_u32 s12, s11, s4
    v_add_u32 v232, s12, v232
    v_min_u32 v232, 31, v232
    v_and_b32 v233, 30, v0
    v_lshl_add_u32 v232, v232, 5, v233
    s_mul_i32 s12, s4, 57344
    s_lshl_b32 s13, s10, 7
    s_add_u32 s12, s12, s13
    v_add_u32 v6, s12, v101
    v_add_u32 v7, 27648, v6
    v_xor_b32 v8, 64, v6
    v_xor_b32 v9, 64, v7
    v_bfe_u32 v102, v0, 1, 3
    v_xor_b32 v102, v102, v99
    v_lshlrev_b32 v102, 4, v102
    v_lshl_add_u32 v102, v100, 7, v102
    s_lshl_b32 s12, s4, 14
    v_add_u32 v10, s12, v102
    v_xor_b32 v11, 32, v10
    v_xor_b32 v12, 64, v10
    v_xor_b32 v13, 96, v10
    v_bfe_u32 v103, v0, 2, 2
    v_lshl_add_u32 v104, v99, 3, v103
    v_lshlrev_b32 v104, 7, v104
    v_and_b32 v107, 3, v0
    v_lshl_add_u32 v104, v107, 3, v104
    v_and_b32 v105, 1, v98
    v_lshrrev_b32 v106, 1, v103
    v_lshl_add_u32 v106, v105, 1, v106
    v_lshl_add_u32 v104, v106, 5, v104
    v_lshl_add_u32 v106, v105, 16, v104
    v_xor_b32 v21, 0, v106
    v_xor_b32 v22, 32, v21
    v_and_b32 v108, 1, v0
    v_lshrrev_b32 v109, 1, v100
    v_lshl_add_u32 v109, v108, 4, v109
    v_bfe_u32 v110, v109, 1, 2
    v_lshl_add_u32 v110, v108, 2, v110
    v_xor_b32 v110, v110, v99
    v_lshlrev_b32 v110, 4, v110
    v_lshl_add_u32 v110, v109, 7, v110
    v_add_u32 v14, 65536, v110
    v_xor_b32 v15, 32, v14
    v_xor_b32 v16, 64, v14
    v_xor_b32 v17, 96, v14
    s_lshr_b32 s80, s3, 1
    s_lshl_b32 s80, s80, 14
    s_and_b32 s12, s3, 1
    s_lshl_b32 s12, s12, 11
    s_add_u32 s80, s80, s12
    s_lshl_b32 s94, s3, 14
    s_lshl_b32 s12, s6, 2
    s_add_u32 s12, s12, s4
    s_mul_i32 s12, s12, 180224
    s_lshl_b32 s13, s9, 12
    s_add_u32 s82, s12, s13
    s_lshl_b32 s13, s10, 12
    s_add_u32 s83, s12, s13
    s_lshl_b32 s13, s11, 11
    s_add_u32 s84, s12, s13
    s_add_u32 s84, s84, 114688
    s_mul_i32 s35, s50, 360448
    s_lshl_b32 s12, s4, 14
    s_add_u32 s35, s35, s12
    s_add_u32 s35, s35, 114688
    s_lshl_b32 s95, s51, 16
    s_lshl_b32 s12, s4, 8
    s_add_u32 s95, s95, s12
    s_add_u32 m0, s78, 69632
    s_add_u32 s76, s1, 1
    s_and_b32 s76, s76, 7
    s_mul_i32 s76, s76, 128
    buffer_load_dwordx4 v1, s[56:59], s76 offen lds
    s_add_u32 m0, s78, 86016
    s_add_u32 s76, s76, 16384
    buffer_load_dwordx4 v1, s[56:59], s76 offen lds
    s_add_u32 m0, s78, 102400
    s_add_u32 s76, s76, 16384
    buffer_load_dwordx4 v1, s[56:59], s76 offen lds
    s_add_u32 m0, s78, 118784
    s_add_u32 s76, s76, 16384
    buffer_load_dwordx4 v1, s[56:59], s76 offen lds
    s_add_u32 m0, s78, 135168
    s_add_u32 s76, s76, 16384
    buffer_load_dwordx4 v1, s[56:59], s76 offen lds
    s_waitcnt vmcnt(5)
    s_barrier
    ds_read_b128 v[128:131], v10 offset:0
    ds_read_b128 v[24:27], v14 offset:0
    ds_read_b128 v[28:31], v14 offset:16384
    s_waitcnt lgkmcnt(1)
    v_mfma_f32_32x32x16_bf16 v[48:63], v[128:131], v[24:27], 0
    ds_read_b128 v[132:135], v11 offset:0
    ds_read_b128 v[36:39], v15 offset:0
    s_add_u32 m0, s78, 73728
    s_add_u32 s76, s1, 2
    s_and_b32 s76, s76, 7
    s_mul_i32 s76, s76, 128
    buffer_load_dwordx4 v1, s[56:59], s76 offen lds
    s_add_u32 m0, s78, 90112
    s_add_u32 s76, s76, 16384
    buffer_load_dwordx4 v1, s[56:59], s76 offen lds
    s_waitcnt lgkmcnt(2)
    v_mfma_f32_32x32x16_bf16 v[64:79], v[128:131], v[28:31], 0
    ds_read_b128 v[40:43], v15 offset:16384
    s_add_u32 m0, s78, 106496
    s_add_u32 s76, s76, 16384
    buffer_load_dwordx4 v1, s[56:59], s76 offen lds
    s_add_u32 m0, s78, 122880
    s_add_u32 s76, s76, 16384
    buffer_load_dwordx4 v1, s[56:59], s76 offen lds
    s_waitcnt lgkmcnt(1)
    v_mfma_f32_32x32x16_bf16 v[48:63], v[132:135], v[36:39], v[48:63]
    ds_read_b128 v[136:139], v12 offset:0
    ds_read_b128 v[24:27], v16 offset:0
    s_add_u32 m0, s78, 139264
    s_add_u32 s76, s76, 16384
    buffer_load_dwordx4 v1, s[56:59], s76 offen lds
    s_add_u32 m0, s78, 77824
    s_add_u32 s76, s1, 3
    s_and_b32 s76, s76, 7
    s_mul_i32 s76, s76, 128
    buffer_load_dwordx4 v1, s[56:59], s76 offen lds
    s_waitcnt lgkmcnt(2)
    v_mfma_f32_32x32x16_bf16 v[64:79], v[132:135], v[40:43], v[64:79]
    ds_read_b128 v[28:31], v16 offset:16384
    s_waitcnt lgkmcnt(1)
    v_mfma_f32_32x32x16_bf16 v[48:63], v[136:139], v[24:27], v[48:63]
    ds_read_b128 v[140:143], v13 offset:0
    ds_read_b128 v[36:39], v17 offset:0
    s_add_u32 m0, s78, 94208
    s_add_u32 s76, s76, 16384
    buffer_load_dwordx4 v1, s[56:59], s76 offen lds
    s_waitcnt lgkmcnt(2)
    v_mfma_f32_32x32x16_bf16 v[64:79], v[136:139], v[28:31], v[64:79]
    ds_read_b128 v[40:43], v17 offset:16384
    s_waitcnt vmcnt(7) lgkmcnt(0)
    s_barrier
    v_mfma_f32_32x32x16_bf16 v[48:63], v[140:143], v[36:39], v[48:63]
    ds_read_b128 v[144:147], v10 offset:4096
    ds_read_b128 v[24:27], v14 offset:4096
    s_add_u32 m0, s78, 110592
    s_add_u32 s76, s76, 16384
    buffer_load_dwordx4 v1, s[56:59], s76 offen lds
    s_add_u32 m0, s78, 126976
    s_add_u32 s76, s76, 16384
    buffer_load_dwordx4 v1, s[56:59], s76 offen lds
    v_mfma_f32_32x32x16_bf16 v[64:79], v[140:143], v[40:43], v[64:79]
    ds_read_b128 v[28:31], v14 offset:20480
    s_add_u32 m0, s78, 143360
    s_add_u32 s76, s76, 16384
    buffer_load_dwordx4 v1, s[56:59], s76 offen lds
    s_add_u32 m0, s78, 65536
    s_add_u32 s76, s1, 4
    s_and_b32 s76, s76, 7
    s_mul_i32 s76, s76, 128
    buffer_load_dwordx4 v1, s[56:59], s76 offen lds
    s_waitcnt lgkmcnt(1)
    v_mfma_f32_32x32x16_bf16 v[48:63], v[144:147], v[24:27], v[48:63]
    ds_read_b128 v[148:151], v11 offset:4096
    ds_read_b128 v[36:39], v15 offset:4096
    s_add_u32 m0, s78, 81920
    s_add_u32 s76, s76, 16384
    buffer_load_dwordx4 v1, s[56:59], s76 offen lds
    s_add_u32 m0, s78, 98304
    s_add_u32 s76, s76, 16384
    buffer_load_dwordx4 v1, s[56:59], s76 offen lds
    s_waitcnt lgkmcnt(2)
    v_mfma_f32_32x32x16_bf16 v[64:79], v[144:147], v[28:31], v[64:79]
    ds_read_b128 v[40:43], v15 offset:20480
    s_add_u32 m0, s78, 114688
    s_add_u32 s76, s76, 16384
    buffer_load_dwordx4 v1, s[56:59], s76 offen lds
    s_add_u32 m0, s78, 131072
    s_add_u32 s76, s76, 16384
    buffer_load_dwordx4 v1, s[56:59], s76 offen lds
    s_waitcnt lgkmcnt(1)
    v_mfma_f32_32x32x16_bf16 v[48:63], v[148:151], v[36:39], v[48:63]
    ds_read_b128 v[152:155], v12 offset:4096
    ds_read_b128 v[24:27], v16 offset:4096
    global_load_ushort v233, v232, s[18:19]
    global_load_ushort v234, v232, s[20:21]
    global_load_ushort v235, v232, s[30:31]
    s_waitcnt lgkmcnt(2)
    v_mfma_f32_32x32x16_bf16 v[64:79], v[148:151], v[40:43], v[64:79]
    ds_read_b128 v[28:31], v16 offset:20480
    s_waitcnt lgkmcnt(1)
    v_mfma_f32_32x32x16_bf16 v[48:63], v[152:155], v[24:27], v[48:63]
    ds_read_b128 v[156:159], v13 offset:4096
    ds_read_b128 v[36:39], v17 offset:4096
    buffer_load_dwordx4 v[224:227], v239, s[52:55], 0 offen
    s_waitcnt lgkmcnt(2)
    v_mfma_f32_32x32x16_bf16 v[64:79], v[152:155], v[28:31], v[64:79]
    ds_read_b128 v[40:43], v17 offset:20480
    s_waitcnt vmcnt(14) lgkmcnt(0)
    s_barrier
    v_mfma_f32_32x32x16_bf16 v[48:63], v[156:159], v[36:39], v[48:63]
    ds_read_b128 v[160:163], v10 offset:8192
    ds_read_b128 v[24:27], v14 offset:8192
    global_load_dwordx4 v[228:231], v23, s[42:43]
    s_add_u32 m0, s78, 69632
    s_add_u32 s76, s1, 5
    s_and_b32 s76, s76, 7
    s_mul_i32 s76, s76, 128
    buffer_load_dwordx4 v1, s[56:59], s76 offen lds
    v_mfma_f32_32x32x16_bf16 v[64:79], v[156:159], v[40:43], v[64:79]
    ds_read_b128 v[28:31], v14 offset:24576
    s_add_u32 m0, s78, 86016
    s_add_u32 s76, s76, 16384
    buffer_load_dwordx4 v1, s[56:59], s76 offen lds
    s_waitcnt lgkmcnt(1)
    v_mfma_f32_32x32x16_bf16 v[48:63], v[160:163], v[24:27], v[48:63]
    ds_read_b128 v[164:167], v11 offset:8192
    ds_read_b128 v[36:39], v15 offset:8192
    s_add_u32 m0, s78, 102400
    s_add_u32 s76, s76, 16384
    buffer_load_dwordx4 v1, s[56:59], s76 offen lds
    s_waitcnt lgkmcnt(2)
    v_mfma_f32_32x32x16_bf16 v[64:79], v[160:163], v[28:31], v[64:79]
    ds_read_b128 v[40:43], v15 offset:24576
    s_cmp_lg_u32 s4, 0
    s_cbranch_scc1 L_epl_skip_24
    global_load_dword v238, v237, s[46:47] sc1
L_epl_skip_24:
    s_waitcnt lgkmcnt(1)
    v_mfma_f32_32x32x16_bf16 v[48:63], v[164:167], v[36:39], v[48:63]
    ds_read_b128 v[168:171], v12 offset:8192
    ds_read_b128 v[24:27], v16 offset:8192
    s_add_u32 m0, s78, 118784
    s_add_u32 s76, s76, 16384
    buffer_load_dwordx4 v1, s[56:59], s76 offen lds
    s_waitcnt lgkmcnt(2)
    v_mfma_f32_32x32x16_bf16 v[64:79], v[164:167], v[40:43], v[64:79]
    ds_read_b128 v[28:31], v16 offset:24576
    s_waitcnt lgkmcnt(1)
    v_mfma_f32_32x32x16_bf16 v[48:63], v[168:171], v[24:27], v[48:63]
    ds_read_b128 v[172:175], v13 offset:8192
    ds_read_b128 v[36:39], v17 offset:8192
    s_add_u32 m0, s78, 135168
    s_add_u32 s76, s76, 16384
    buffer_load_dwordx4 v1, s[56:59], s76 offen lds
    s_waitcnt vmcnt(7)
    v_lshlrev_b32 v90, 16, v233
    v_lshlrev_b32 v91, 16, v234
    v_lshlrev_b32 v92, 16, v235
    s_waitcnt lgkmcnt(2)
    v_mfma_f32_32x32x16_bf16 v[64:79], v[168:171], v[28:31], v[64:79]
    ds_read_b128 v[40:43], v17 offset:24576
    v_mul_f32 v92, 0x3fb8aa3b, v92
    v_exp_f32 v92, v92
    v_mul_f32 v85, v90, v90
    s_waitcnt lgkmcnt(0)
    s_barrier
    v_mfma_f32_32x32x16_bf16 v[48:63], v[172:175], v[36:39], v[48:63]
    ds_read_b128 v[176:179], v10 offset:12288
    ds_read_b128 v[24:27], v14 offset:12288
    s_add_u32 m0, s78, 73728
    s_add_u32 s76, s1, 6
    s_and_b32 s76, s76, 7
    s_mul_i32 s76, s76, 128
    buffer_load_dwordx4 v1, s[56:59], s76 offen lds
    v_cvt_pk_bf16_f32 v92, v92, v92
    v_lshlrev_b32 v92, 16, v92
    v_mul_f32 v80, v92, v90
    v_mfma_f32_32x32x16_bf16 v[64:79], v[172:175], v[40:43], v[64:79]
    ds_read_b128 v[28:31], v14 offset:28672
    s_add_u32 m0, s78, 90112
    s_add_u32 s76, s76, 16384
    buffer_load_dwordx4 v1, s[56:59], s76 offen lds
    v_mul_f32 v81, v92, v91
    v_mul_f32 v80, 0x3fb8aa3b, v80
    v_exp_f32 v80, v80
    s_waitcnt lgkmcnt(1)
    v_mfma_f32_32x32x16_bf16 v[48:63], v[176:179], v[24:27], v[48:63]
    ds_read_b128 v[180:183], v11 offset:12288
    ds_read_b128 v[36:39], v15 offset:12288
    s_add_u32 m0, s78, 106496
    s_add_u32 s76, s76, 16384
    buffer_load_dwordx4 v1, s[56:59], s76 offen lds
    v_mul_f32 v81, 0x3e22f983, v81
    v_rndne_f32 v82, v81
    v_sub_f32 v81, v81, v82
    s_waitcnt lgkmcnt(2)
    v_mfma_f32_32x32x16_bf16 v[64:79], v[176:179], v[28:31], v[64:79]
    ds_read_b128 v[40:43], v15 offset:28672
    v_cos_f32 v82, v81
    v_sin_f32 v83, v81
    v_fmac_f32 v85, v91, v91
    s_waitcnt lgkmcnt(1)
    v_mfma_f32_32x32x16_bf16 v[48:63], v[180:183], v[36:39], v[48:63]
    ds_read_b128 v[184:187], v12 offset:12288
    ds_read_b128 v[24:27], v16 offset:12288
    s_add_u32 m0, s78, 122880
    s_add_u32 s76, s76, 16384
    buffer_load_dwordx4 v1, s[56:59], s76 offen lds
    v_mul_f32 v82, v80, v82
    v_mul_f32 v83, v80, v83
    v_rcp_f32 v85, v85
    s_waitcnt lgkmcnt(2)
    v_mfma_f32_32x32x16_bf16 v[64:79], v[180:183], v[40:43], v[64:79]
    ds_read_b128 v[28:31], v16 offset:28672
    v_add_f32 v84, -1.0, v82
    v_mul_f32 v86, v84, v90
    v_fmac_f32 v86, v83, v91
    s_waitcnt lgkmcnt(1)
    v_mfma_f32_32x32x16_bf16 v[48:63], v[184:187], v[24:27], v[48:63]
    ds_read_b128 v[188:191], v13 offset:12288
    ds_read_b128 v[36:39], v17 offset:12288
    s_add_u32 m0, s78, 139264
    s_add_u32 s76, s76, 16384
    buffer_load_dwordx4 v1, s[56:59], s76 offen lds
    v_mul_f32 v87, v83, v90
    v_fma_f32 v87, -v84, v91, v87
    v_add_f32 v85, v85, v85
    s_waitcnt lgkmcnt(2)
    v_mfma_f32_32x32x16_bf16 v[64:79], v[184:187], v[28:31], v[64:79]
    ds_read_b128 v[40:43], v17 offset:28672
    v_mul_f32 v86, v86, v85
    v_mul_f32 v87, v87, v85
    v_and_b32 v88, 1, v0
    s_waitcnt lgkmcnt(0)
    s_barrier
    v_mfma_f32_32x32x16_bf16 v[48:63], v[188:191], v[36:39], v[48:63]
    ds_read_b128 v[192:195], v10 offset:0
    ds_read_b128 v[24:27], v14 offset:0
    s_add_u32 m0, s78, 77824
    s_add_u32 s76, s1, 7
    s_and_b32 s76, s76, 7
    s_mul_i32 s76, s76, 128
    buffer_load_dwordx4 v1, s[56:59], s76 offen lds
    v_lshlrev_b32 v88, 31, v88
    v_xor_b32 v89, 0x80000000, v88
    v_xor_b32 v120, v88, v86
    v_mfma_f32_32x32x16_bf16 v[64:79], v[188:191], v[40:43], v[64:79]
    ds_read_b128 v[28:31], v14 offset:16384
    s_add_u32 m0, s78, 94208
    s_add_u32 s76, s76, 16384
    buffer_load_dwordx4 v1, s[56:59], s76 offen lds
    v_xor_b32 v121, 0x80000000, v87
    v_mov_b32 v112, v82
    v_xor_b32 v113, v89, v83
    s_waitcnt lgkmcnt(1)
    v_mfma_f32_32x32x16_bf16 v[48:63], v[192:195], v[24:27], v[48:63]
    ds_read_b128 v[196:199], v11 offset:0
    ds_read_b128 v[36:39], v15 offset:0
    s_add_u32 m0, s78, 110592
    s_add_u32 s76, s76, 16384
    buffer_load_dwordx4 v1, s[56:59], s76 offen lds
    v_mul_f32 v84, v83, v83
    v_mul_f32 v85, v82, v83
    v_fma_f32 v82, v82, v82, -v84
    s_waitcnt lgkmcnt(2)
    v_mfma_f32_32x32x16_bf16 v[64:79], v[192:195], v[28:31], v[64:79]
    ds_read_b128 v[40:43], v15 offset:16384
    v_add_f32 v83, v85, v85
    v_mul_f32 v84, v83, v83
    v_mul_f32 v85, v82, v83
    s_waitcnt lgkmcnt(1)
    v_mfma_f32_32x32x16_bf16 v[48:63], v[196:199], v[36:39], v[48:63]
    ds_read_b128 v[200:203], v12 offset:0
    ds_read_b128 v[24:27], v16 offset:0
    s_add_u32 m0, s78, 126976
    s_add_u32 s76, s76, 16384
    buffer_load_dwordx4 v1, s[56:59], s76 offen lds
    v_fma_f32 v82, v82, v82, -v84
    v_add_f32 v83, v85, v85
    v_mul_f32 v84, v83, v83
    s_waitcnt lgkmcnt(2)
    v_mfma_f32_32x32x16_bf16 v[64:79], v[196:199], v[40:43], v[64:79]
    ds_read_b128 v[28:31], v16 offset:16384
    v_mul_f32 v85, v82, v83
    v_fma_f32 v82, v82, v82, -v84
    v_add_f32 v83, v85, v85
    s_waitcnt lgkmcnt(1)
    v_mfma_f32_32x32x16_bf16 v[48:63], v[200:203], v[24:27], v[48:63]
    ds_read_b128 v[204:207], v13 offset:0
    ds_read_b128 v[36:39], v17 offset:0
    s_add_u32 m0, s78, 143360
    s_add_u32 s76, s76, 16384
    buffer_load_dwordx4 v1, s[56:59], s76 offen lds
    v_mul_f32 v84, v83, v83
    v_mul_f32 v85, v82, v83
    v_fma_f32 v82, v82, v82, -v84
    s_waitcnt lgkmcnt(2)
    v_mfma_f32_32x32x16_bf16 v[64:79], v[200:203], v[28:31], v[64:79]
    ds_read_b128 v[40:43], v17 offset:16384
    v_add_f32 v83, v85, v85
    v_mov_b32 v114, v82
    v_xor_b32 v115, v89, v83
    s_cmp_lg_u32 s4, 0
    s_cbranch_scc1 L_ep_skip_25
    s_mov_b32 s86, 0
    s_waitcnt vmcnt(12)
L_ep_poll_26:
    v_cmp_ne_u32 vcc, 0, v238
    s_cbranch_vccnz L_ep_ok_27
    s_sleep 2
    global_load_dword v238, v237, s[46:47] sc1
    s_waitcnt vmcnt(0)
    s_add_u32 s86, s86, 1
    s_cmp_lt_u32 s86, 0x4000
    s_cbranch_scc1 L_ep_poll_26
L_ep_ok_27:
    v_mov_b32 v236, 161792
    ds_write_b32 v236, v238
    s_waitcnt lgkmcnt(0)
L_ep_skip_25:
    s_waitcnt vmcnt(10) lgkmcnt(0)
    s_barrier
    v_mfma_f32_32x32x16_bf16 v[48:63], v[204:207], v[36:39], v[48:63]
    ds_read_b128 v[208:211], v10 offset:4096
    ds_read_b128 v[24:27], v14 offset:4096
    s_add_u32 m0, s80, 0
    s_add_u32 s77, s1, 0
    s_and_b32 s77, s77, 7
    s_mul_i32 s77, s77, 229376
    buffer_load_dwordx4 v6, s[60:63], s77 offen lds
    v_mul_f32 v84, v83, v83
    v_mul_f32 v85, v82, v83
    v_fma_f32 v82, v82, v82, -v84
    v_mfma_f32_32x32x16_bf16 v[64:79], v[204:207], v[40:43], v[64:79]
    ds_read_b128 v[28:31], v14 offset:20480
    buffer_load_dwordx4 v7, s[60:63], s77 offen offset:1024 lds
    v_add_f32 v83, v85, v85
    v_mul_f32 v84, v83, v83
    v_mul_f32 v85, v82, v83
    s_waitcnt lgkmcnt(1)
    v_mfma_f32_32x32x16_bf16 v[48:63], v[208:211], v[24:27], v[48:63]
    ds_read_b128 v[212:215], v11 offset:4096
    ds_read_b128 v[36:39], v15 offset:4096
    s_add_u32 m0, s80, 65536
    s_nop 0
    buffer_load_dwordx4 v8, s[64:67], s77 offen lds
    v_fma_f32 v82, v82, v82, -v84
    v_add_f32 v83, v85, v85
    v_mul_f32 v84, v83, v83
    s_waitcnt lgkmcnt(2)
    v_mfma_f32_32x32x16_bf16 v[64:79], v[208:211], v[28:31], v[64:79]
    ds_read_b128 v[40:43], v15 offset:20480
    v_mul_f32 v85, v82, v83
    v_fma_f32 v82, v82, v82, -v84
    v_add_f32 v83, v85, v85
    v_mov_b32 v240, 161792
    ds_read_b32 v240, v240
    s_waitcnt lgkmcnt(2)
    v_mfma_f32_32x32x16_bf16 v[48:63], v[212:215], v[36:39], v[48:63]
    ds_read_b128 v[216:219], v12 offset:4096
    ds_read_b128 v[24:27], v16 offset:4096
    buffer_load_dwordx4 v9, s[64:67], s77 offen offset:1024 lds
    v_mov_b32 v116, v82
    v_xor_b32 v117, v89, v83
    v_mul_f32 v84, v83, v83
    s_waitcnt lgkmcnt(3)
    v_mfma_f32_32x32x16_bf16 v[64:79], v[212:215], v[40:43], v[64:79]
    ds_read_b128 v[28:31], v16 offset:20480
    v_mul_f32 v85, v82, v83
    v_fma_f32 v82, v82, v82, -v84
    v_add_f32 v83, v85, v85
    s_waitcnt lgkmcnt(3)
    v_readfirstlane_b32 s34, v240
    s_waitcnt lgkmcnt(1)
    v_mfma_f32_32x32x16_bf16 v[48:63], v[216:219], v[24:27], v[48:63]
    ds_read_b128 v[220:223], v13 offset:4096
    ds_read_b128 v[36:39], v17 offset:4096
    v_mov_b32 v118, v82
    v_xor_b32 v119, v89, v83
    s_cmp_eq_u32 s4, 0
    s_cselect_b32 s13, 6144, 0
    v_lshrrev_b32 v80, 5, v0
    v_mul_u32_u24 v80, s13, v80
    s_waitcnt lgkmcnt(2)
    v_mfma_f32_32x32x16_bf16 v[64:79], v[216:219], v[28:31], v[64:79]
    ds_read_b128 v[40:43], v17 offset:20480
    v_and_b32 v81, 31, v0
    v_mul_u32_u24 v81, 48, v81
    s_mul_i32 s12, s4, 1536
    s_add_u32 s12, s12, 147456
    v_add3_u32 v80, v80, v81, s12
    ds_write_b128 v80, v[112:115]
    ds_write_b128 v80, v[116:119] offset:16
    ds_write_b64 v80, v[120:121] offset:32
    v_lshlrev_b32 v96, 16, v224
    v_and_b32 v97, 0xffff0000, v224
    v_lshlrev_b32 v104, 16, v228
    v_and_b32 v105, 0xffff0000, v228
    v_lshlrev_b32 v98, 16, v225
    v_and_b32 v99, 0xffff0000, v225
    v_lshlrev_b32 v106, 16, v229
    v_and_b32 v107, 0xffff0000, v229
    v_lshlrev_b32 v100, 16, v226
    v_and_b32 v101, 0xffff0000, v226
    v_lshlrev_b32 v108, 16, v230
    v_and_b32 v109, 0xffff0000, v230
    v_lshlrev_b32 v102, 16, v227
    v_and_b32 v103, 0xffff0000, v227
    v_lshlrev_b32 v110, 16, v231
    v_and_b32 v111, 0xffff0000, v231
    v_mul_f32 v96, v96, v104
    s_waitcnt vmcnt(9) lgkmcnt(0)
    s_barrier
    v_mfma_f32_32x32x16_bf16 v[48:63], v[220:223], v[36:39], v[48:63]
    ds_read_b128 v[224:227], v10 offset:8192
    ds_read_b128 v[24:27], v14 offset:8192
    s_add_u32 m0, s80, 4096
    s_add_u32 s77, s1, 2
    s_and_b32 s77, s77, 7
    s_mul_i32 s77, s77, 229376
    buffer_load_dwordx4 v6, s[60:63], s77 offen lds
    v_mul_f32 v97, v97, v105
    v_mul_f32 v98, v98, v106
    v_mul_f32 v99, v99, v107
    v_mfma_f32_32x32x16_bf16 v[64:79], v[220:223], v[40:43], v[64:79]
    ds_read_b128 v[28:31], v14 offset:24576
    buffer_load_dwordx4 v7, s[60:63], s77 offen offset:1024 lds
    v_mul_f32 v100, v100, v108
    v_mul_f32 v101, v101, v109
    v_mul_f32 v102, v102, v110
    s_waitcnt lgkmcnt(1)
    v_mfma_f32_32x32x16_bf16 v[48:63], v[224:227], v[24:27], v[48:63]
    ds_read_b128 v[228:231], v11 offset:8192
    ds_read_b128 v[36:39], v15 offset:8192
    s_add_u32 m0, s80, 69632
    s_nop 0
    buffer_load_dwordx4 v8, s[64:67], s77 offen lds
    v_mul_f32 v103, v103, v111
    v_cvt_pk_bf16_f32 v104, v96, v97
    v_cvt_pk_bf16_f32 v105, v98, v99
    s_waitcnt lgkmcnt(2)
    v_mfma_f32_32x32x16_bf16 v[64:79], v[224:227], v[28:31], v[64:79]
    ds_read_b128 v[40:43], v15 offset:24576
    v_cvt_pk_bf16_f32 v106, v100, v101
    v_cvt_pk_bf16_f32 v107, v102, v103
    v_lshlrev_b32 v96, 16, v104
    s_waitcnt lgkmcnt(1)
    v_mfma_f32_32x32x16_bf16 v[48:63], v[228:231], v[36:39], v[48:63]
    ds_read_b128 v[232:235], v12 offset:8192
    ds_read_b128 v[24:27], v16 offset:8192
    buffer_load_dwordx4 v9, s[64:67], s77 offen offset:1024 lds
    v_and_b32 v97, 0xffff0000, v104
    v_lshlrev_b32 v98, 16, v105
    v_and_b32 v99, 0xffff0000, v105
    s_waitcnt lgkmcnt(2)
    v_mfma_f32_32x32x16_bf16 v[64:79], v[228:231], v[40:43], v[64:79]
    ds_read_b128 v[28:31], v16 offset:24576
    v_lshlrev_b32 v100, 16, v106
    v_and_b32 v101, 0xffff0000, v106
    v_lshlrev_b32 v102, 16, v107
    s_waitcnt lgkmcnt(1)
    v_mfma_f32_32x32x16_bf16 v[48:63], v[232:235], v[24:27], v[48:63]
    ds_read_b128 v[236:239], v13 offset:8192
    ds_read_b128 v[36:39], v17 offset:8192
    v_and_b32 v103, 0xffff0000, v107
    v_add_f32 v96, v96, v100
    v_add_f32 v97, v97, v101
    s_waitcnt lgkmcnt(2)
    v_mfma_f32_32x32x16_bf16 v[64:79], v[232:235], v[28:31], v[64:79]
    ds_read_b128 v[40:43], v17 offset:24576
    v_add_f32 v98, v98, v102
    v_add_f32 v99, v99, v103
    v_add_f32 v96, v96, v98
    s_waitcnt vmcnt(8) lgkmcnt(0)
    s_barrier
    v_mfma_f32_32x32x16_bf16 v[48:63], v[236:239], v[36:39], v[48:63]
    ds_read_b128 v[240:243], v10 offset:12288
    ds_read_b128 v[24:27], v14 offset:12288
    s_add_u32 m0, s80, 8192
    s_add_u32 s77, s1, 4
    s_and_b32 s77, s77, 7
    s_mul_i32 s77, s77, 229376
    buffer_load_dwordx4 v6, s[60:63], s77 offen lds
    v_add_f32 v97, v97, v99
    v_add_f32 v96, v96, v97
    s_nop 1
    v_add_f32_dpp v97, v96, v96 quad_perm:[1,0,3,2] row_mask:0xf bank_mask:0xf
    v_mfma_f32_32x32x16_bf16 v[64:79], v[236:239], v[40:43], v[64:79]
    ds_read_b128 v[28:31], v14 offset:28672
    buffer_load_dwordx4 v7, s[60:63], s77 offen offset:1024 lds
    s_nop 1
    v_add_f32_dpp v96, v97, v97 quad_perm:[2,3,0,1] row_mask:0xf bank_mask:0xf
    s_nop 1
    v_add_f32_dpp v97, v96, v96 row_half_mirror row_mask:0xf bank_mask:0xf
    s_nop 1
    v_add_f32_dpp v96, v97, v97 row_mirror row_mask:0xf bank_mask:0xf
    s_waitcnt lgkmcnt(1)
    v_mfma_f32_32x32x16_bf16 v[48:63], v[240:243], v[24:27], v[48:63]
    ds_read_b128 v[244:247], v11 offset:12288
    ds_read_b128 v[36:39], v15 offset:12288
    s_add_u32 m0, s80, 73728
    s_nop 0
    buffer_load_dwordx4 v8, s[64:67], s77 offen lds
    s_nop 0
    v_readlane_b32 s12, v96, 16
    v_readlane_b32 s13, v96, 32
    v_readlane_b32 s14, v96, 48
    s_nop 1
    v_add_f32 v96, s12, v96
    v_mov_b32 v97, s13
    v_add_f32 v97, s14, v97
    v_add_f32 v96, v96, v97
    v_cvt_pk_bf16_f32 v96, v96, v96
    s_waitcnt lgkmcnt(2)
    v_mfma_f32_32x32x16_bf16 v[64:79], v[240:243], v[28:31], v[64:79]
    ds_read_b128 v[40:43], v15 offset:28672
    v_lshlrev_b32 v96, 16, v96
    v_mul_f32 v96, s81, v96
    v_exp_f32 v96, v96
    s_waitcnt lgkmcnt(1)
    v_mfma_f32_32x32x16_bf16 v[48:63], v[244:247], v[36:39], v[48:63]
    ds_read_b128 v[248:251], v12 offset:12288
    ds_read_b128 v[24:27], v16 offset:12288
    buffer_load_dwordx4 v9, s[64:67], s77 offen offset:1024 lds
    s_lshl_b32 s12, s3, 2
    s_add_u32 s12, s12, 161856
    v_mov_b32 v97, s12
    v_add_f32 v96, 1.0, v96
    v_rcp_f32 v96, v96
    s_waitcnt lgkmcnt(2)
    v_mfma_f32_32x32x16_bf16 v[64:79], v[244:247], v[40:43], v[64:79]
    ds_read_b128 v[28:31], v16 offset:28672
    s_nop 0
    v_cvt_pk_bf16_f32 v96, v96, v96
    v_lshlrev_b32 v96, 16, v96
    s_mov_b64 exec, 1
    ds_write_b32 v97, v96
    s_mov_b64 exec, -1
    s_waitcnt lgkmcnt(2)
    v_mfma_f32_32x32x16_bf16 v[48:63], v[248:251], v[24:27], v[48:63]
    ds_read_b128 v[252:255], v13 offset:12288
    ds_read_b128 v[36:39], v17 offset:12288
    s_waitcnt lgkmcnt(3)
    v_mfma_f32_32x32x16_bf16 v[64:79], v[248:251], v[28:31], v[64:79]
    ds_read_b128 v[40:43], v17 offset:28672
    s_waitcnt vmcnt(8) lgkmcnt(0)
    s_barrier
    v_mfma_f32_32x32x16_bf16 v[48:63], v[252:255], v[36:39], v[48:63]
    ds_read_b64_tr_b16 v[24:25], v21 offset:0
    ds_read_b64_tr_b16 v[26:27], v21 offset:512
    s_add_u32 m0, s80, 12288
    s_add_u32 s77, s1, 6
    s_and_b32 s77, s77, 7
    s_mul_i32 s77, s77, 229376
    buffer_load_dwordx4 v6, s[60:63], s77 offen lds
    v_mfma_f32_32x32x16_bf16 v[64:79], v[252:255], v[40:43], v[64:79]
    ds_read_b64_tr_b16 v[28:29], v22 offset:0
    ds_read_b64_tr_b16 v[30:31], v22 offset:512
    buffer_load_dwordx4 v7, s[60:63], s77 offen offset:1024 lds
    s_waitcnt lgkmcnt(2)
    v_mfma_f32_32x32x16_bf16 v[96:111], v[24:27], v[128:131], 0
    ds_read_b64_tr_b16 v[32:33], v21 offset:2048
    ds_read_b64_tr_b16 v[34:35], v21 offset:2560
    s_add_u32 m0, s80, 77824
    s_nop 0
    buffer_load_dwordx4 v8, s[64:67], s77 offen lds
    s_waitcnt lgkmcnt(2)
    v_mfma_f32_32x32x16_bf16 v[112:127], v[28:31], v[128:131], 0
    ds_read_b64_tr_b16 v[36:37], v22 offset:2048
    ds_read_b64_tr_b16 v[38:39], v22 offset:2560
    s_waitcnt lgkmcnt(2)
    v_mfma_f32_32x32x16_bf16 v[96:111], v[32:35], v[132:135], v[96:111]
    ds_read_b64_tr_b16 v[24:25], v21 offset:16384
    ds_read_b64_tr_b16 v[26:27], v21 offset:16896
    buffer_load_dwordx4 v9, s[64:67], s77 offen offset:1024 lds
    v_and_b32 v20, 31, v0
    v_mul_u32_u24 v20, 48, v20
    v_add_u32 v20, 147456, v20
    ds_read_b64 v[40:41], v20 offset:0
    ds_read_b64 v[42:43], v20 offset:1536
    v_lshlrev_b32 v1, 2, v0
    s_waitcnt lgkmcnt(4)
    v_mfma_f32_32x32x16_bf16 v[112:127], v[36:39], v[132:135], v[112:127]
    ds_read_b64_tr_b16 v[28:29], v22 offset:16384
    ds_read_b64_tr_b16 v[30:31], v22 offset:16896
    s_lshl_b32 s12, s4, 8
    s_add_u32 s12, s12, 131072
    v_add_u32 v1, s12, v1
    v_mov_b32 v2, 0
    ds_write_b32 v1, v2 offset:0
    ds_write_b32 v1, v2 offset:2048
    s_nop 3
    s_waitcnt lgkmcnt(4)
    v_fma_f32 v11, v40, v48, v49
    v_fma_f32 v13, v42, v64, v65
    v_fmac_f32_dpp v11, v48, v41 quad_perm:[1,0,3,2] row_mask:0xf bank_mask:0xf
    v_fmac_f32_dpp v13, v64, v43 quad_perm:[1,0,3,2] row_mask:0xf bank_mask:0xf
    v_fma_f32 v10, v40, v11, v50
    v_fma_f32 v12, v42, v13, v66
    v_fmac_f32_dpp v10, v11, v41 quad_perm:[1,0,3,2] row_mask:0xf bank_mask:0xf
    v_fmac_f32_dpp v12, v13, v43 quad_perm:[1,0,3,2] row_mask:0xf bank_mask:0xf
    v_fma_f32 v11, v40, v10, v51
    v_fma_f32 v13, v42, v12, v67
    v_fmac_f32_dpp v11, v10, v41 quad_perm:[1,0,3,2] row_mask:0xf bank_mask:0xf
    v_fmac_f32_dpp v13, v12, v43 quad_perm:[1,0,3,2] row_mask:0xf bank_mask:0xf
    v_fma_f32 v10, v40, v11, v52
    v_fma_f32 v12, v42, v13, v68
    v_fmac_f32_dpp v10, v11, v41 quad_perm:[1,0,3,2] row_mask:0xf bank_mask:0xf
    v_fmac_f32_dpp v12, v13, v43 quad_perm:[1,0,3,2] row_mask:0xf bank_mask:0xf
    v_fma_f32 v11, v40, v10, v53
    v_fma_f32 v13, v42, v12, v69
    v_fmac_f32_dpp v11, v10, v41 quad_perm:[1,0,3,2] row_mask:0xf bank_mask:0xf
    v_fmac_f32_dpp v13, v12, v43 quad_perm:[1,0,3,2] row_mask:0xf bank_mask:0xf
    v_fma_f32 v10, v40, v11, v54
    v_fma_f32 v12, v42, v13, v70
    v_fmac_f32_dpp v10, v11, v41 quad_perm:[1,0,3,2] row_mask:0xf bank_mask:0xf
    v_fmac_f32_dpp v12, v13, v43 quad_perm:[1,0,3,2] row_mask:0xf bank_mask:0xf
    v_fma_f32 v11, v40, v10, v55
    v_fma_f32 v13, v42, v12, v71
    v_fmac_f32_dpp v11, v10, v41 quad_perm:[1,0,3,2] row_mask:0xf bank_mask:0xf
    v_fmac_f32_dpp v13, v12, v43 quad_perm:[1,0,3,2] row_mask:0xf bank_mask:0xf
    v_fma_f32 v10, v40, v11, v56
    v_fma_f32 v12, v42, v13, v72
    v_fmac_f32_dpp v10, v11, v41 quad_perm:[1,0,3,2] row_mask:0xf bank_mask:0xf
    v_fmac_f32_dpp v12, v13, v43 quad_perm:[1,0,3,2] row_mask:0xf bank_mask:0xf
    v_fma_f32 v11, v40, v10, v57
    v_fma_f32 v13, v42, v12, v73
    v_fmac_f32_dpp v11, v10, v41 quad_perm:[1,0,3,2] row_mask:0xf bank_mask:0xf
    v_fmac_f32_dpp v13, v12, v43 quad_perm:[1,0,3,2] row_mask:0xf bank_mask:0xf
    v_fma_f32 v10, v40, v11, v58
    v_fma_f32 v12, v42, v13, v74
    v_fmac_f32_dpp v10, v11, v41 quad_perm:[1,0,3,2] row_mask:0xf bank_mask:0xf
    v_fmac_f32_dpp v12, v13, v43 quad_perm:[1,0,3,2] row_mask:0xf bank_mask:0xf
    v_fma_f32 v11, v40, v10, v59
    v_fma_f32 v13, v42, v12, v75
    v_fmac_f32_dpp v11, v10, v41 quad_perm:[1,0,3,2] row_mask:0xf bank_mask:0xf
    v_fmac_f32_dpp v13, v12, v43 quad_perm:[1,0,3,2] row_mask:0xf bank_mask:0xf
    v_fma_f32 v10, v40, v11, v60
    v_fma_f32 v12, v42, v13, v76
    v_fmac_f32_dpp v10, v11, v41 quad_perm:[1,0,3,2] row_mask:0xf bank_mask:0xf
    v_fmac_f32_dpp v12, v13, v43 quad_perm:[1,0,3,2] row_mask:0xf bank_mask:0xf
    v_fma_f32 v11, v40, v10, v61
    v_fma_f32 v13, v42, v12, v77
    v_fmac_f32_dpp v11, v10, v41 quad_perm:[1,0,3,2] row_mask:0xf bank_mask:0xf
    v_fmac_f32_dpp v13, v12, v43 quad_perm:[1,0,3,2] row_mask:0xf bank_mask:0xf
    v_fma_f32 v10, v40, v11, v62
    v_fma_f32 v12, v42, v13, v78
    v_fmac_f32_dpp v10, v11, v41 quad_perm:[1,0,3,2] row_mask:0xf bank_mask:0xf
    v_fmac_f32_dpp v12, v13, v43 quad_perm:[1,0,3,2] row_mask:0xf bank_mask:0xf
    v_fma_f32 v11, v40, v10, v63
    v_fma_f32 v13, v42, v12, v79
    v_fmac_f32_dpp v11, v10, v41 quad_perm:[1,0,3,2] row_mask:0xf bank_mask:0xf
    v_fmac_f32_dpp v13, v12, v43 quad_perm:[1,0,3,2] row_mask:0xf bank_mask:0xf
    ds_write_b32 v1, v11 offset:1024
    ds_write_b32 v1, v13 offset:3072
    s_add_u32 s12, s4, 0
    s_mul_i32 s13, s12, 1536
    v_add_u32 v3, s13, v20
    s_lshl_b32 s13, s12, 11
    s_add_u32 s13, s13, 131072
    v_and_b32 v2, 31, v0
    v_lshlrev_b32 v4, 3, v2
    v_lshl_add_u32 v2, v2, 2, s13
    s_waitcnt lgkmcnt(0)
    s_barrier
    s_cmp_ge_u32 s4, 2
    s_cbranch_scc1 L_pub_skip_28
    ds_read_b64 v[10:11], v3 offset:8
    ds_read_b32 v12, v2 offset:1024
    ds_read_b32 v13, v2 offset:1152
    ds_read_b32 v14, v2 offset:1280
    ds_read_b32 v15, v2 offset:1408
    ds_read_b32 v16, v2 offset:1536
    ds_read_b32 v17, v2 offset:1664
    ds_read_b32 v18, v2 offset:1792
    ds_read_b32 v19, v2 offset:1920
    s_add_u32 s12, s93, 4096
    s_waitcnt lgkmcnt(0)
    v_fmac_f32 v13, v10, v12
    s_nop 0
    v_fmac_f32_dpp v13, v12, v11 quad_perm:[1,0,3,2] row_mask:0xf bank_mask:0xf
    v_fmac_f32 v14, v10, v13
    s_nop 0
    v_fmac_f32_dpp v14, v13, v11 quad_perm:[1,0,3,2] row_mask:0xf bank_mask:0xf
    v_fmac_f32 v15, v10, v14
    s_nop 0
    v_fmac_f32_dpp v15, v14, v11 quad_perm:[1,0,3,2] row_mask:0xf bank_mask:0xf
    v_fmac_f32 v16, v10, v15
    s_nop 0
    v_fmac_f32_dpp v16, v15, v11 quad_perm:[1,0,3,2] row_mask:0xf bank_mask:0xf
    v_fmac_f32 v17, v10, v16
    s_nop 0
    v_fmac_f32_dpp v17, v16, v11 quad_perm:[1,0,3,2] row_mask:0xf bank_mask:0xf
    v_fmac_f32 v18, v10, v17
    s_nop 0
    v_fmac_f32_dpp v18, v17, v11 quad_perm:[1,0,3,2] row_mask:0xf bank_mask:0xf
    v_fmac_f32 v19, v10, v18
    s_nop 0
    v_fmac_f32_dpp v19, v18, v11 quad_perm:[1,0,3,2] row_mask:0xf bank_mask:0xf
    v_mov_b32 v11, s34
    v_mov_b32 v10, v19
    s_mov_b32 exec_hi, 0
    buffer_store_dwordx2 v[10:11], v4, s[68:71], s12 offen sc1
    s_mov_b64 exec, -1
L_pub_skip_28:
    v_lshrrev_b32 v12, 5, v0
    v_sub_u32 v12, 1, v12
    v_lshl_add_u32 v4, v12, 8, v4
    v_mfma_f32_32x32x16_bf16 v[96:111], v[24:27], v[136:139], v[96:111]
    ds_read_b64_tr_b16 v[32:33], v21 offset:18432
    ds_read_b64_tr_b16 v[34:35], v21 offset:18944
    v_mfma_f32_32x32x16_bf16 v[112:127], v[28:31], v[136:139], v[112:127]
    ds_read_b64_tr_b16 v[36:37], v22 offset:18432
    ds_read_b64_tr_b16 v[38:39], v22 offset:18944
    s_waitcnt lgkmcnt(2)
    v_mfma_f32_32x32x16_bf16 v[96:111], v[32:35], v[140:143], v[96:111]
    ds_read_b64_tr_b16 v[24:25], v21 offset:32768
    ds_read_b64_tr_b16 v[26:27], v21 offset:33280
    s_waitcnt lgkmcnt(2)
    v_mfma_f32_32x32x16_bf16 v[112:127], v[36:39], v[140:143], v[112:127]
    ds_read_b64_tr_b16 v[28:29], v22 offset:32768
    ds_read_b64_tr_b16 v[30:31], v22 offset:33280
    v_lshrrev_b32 v6, 3, v0
    v_lshrrev_b32 v7, 4, v0
    v_and_b32 v8, 7, v0
    v_xor_b32 v7, v7, v8
    v_lshlrev_b32 v7, 4, v7
    v_lshl_add_u32 v6, v6, 10, v7
    v_xor_b32 v7, 64, v6
    v_add_u32 v7, 7168, v7
    v_and_b32 v8, 31, v0
    v_lshlrev_b32 v8, 7, v8
    v_bfe_u32 v9, v0, 1, 3
    v_lshl_add_u32 v8, v9, 4, v8
    v_lshrrev_b32 v9, 5, v0
    v_lshl_add_u32 v8, v9, 12, v8
    v_add_u32 v8, s94, v8
    s_mov_b32 s72, s26
    s_and_b32 s73, s27, 0xffff
    s_mov_b32 s74, 524288
    s_mov_b32 s75, 0x00020000
    s_mov_b32 s56, s28
    s_and_b32 s57, s29, 0xffff
    s_mov_b32 s58, 524288
    s_mov_b32 s59, 0x00020000
    s_waitcnt lgkmcnt(2)
    v_mfma_f32_32x32x16_bf16 v[96:111], v[24:27], v[144:147], v[96:111]
    ds_read_b64_tr_b16 v[32:33], v21 offset:34816
    ds_read_b64_tr_b16 v[34:35], v21 offset:35328
    s_waitcnt lgkmcnt(2)
    v_mfma_f32_32x32x16_bf16 v[112:127], v[28:31], v[144:147], v[112:127]
    ds_read_b64_tr_b16 v[36:37], v22 offset:34816
    ds_read_b64_tr_b16 v[38:39], v22 offset:35328
    s_waitcnt lgkmcnt(2)
    v_mfma_f32_32x32x16_bf16 v[96:111], v[32:35], v[148:151], v[96:111]
    ds_read_b64_tr_b16 v[24:25], v21 offset:49152
    ds_read_b64_tr_b16 v[26:27], v21 offset:49664
    s_waitcnt lgkmcnt(2)
    v_mfma_f32_32x32x16_bf16 v[112:127], v[36:39], v[148:151], v[112:127]
    ds_read_b64_tr_b16 v[28:29], v22 offset:49152
    ds_read_b64_tr_b16 v[30:31], v22 offset:49664
    s_waitcnt lgkmcnt(2)
    v_mfma_f32_32x32x16_bf16 v[96:111], v[24:27], v[152:155], v[96:111]
    ds_read_b64_tr_b16 v[32:33], v21 offset:51200
    ds_read_b64_tr_b16 v[34:35], v21 offset:51712
    s_waitcnt lgkmcnt(2)
    v_mfma_f32_32x32x16_bf16 v[112:127], v[28:31], v[152:155], v[112:127]
    ds_read_b64_tr_b16 v[36:37], v22 offset:51200
    ds_read_b64_tr_b16 v[38:39], v22 offset:51712
    s_waitcnt vmcnt(8) lgkmcnt(0)
    s_barrier
    v_mfma_f32_32x32x16_bf16 v[96:111], v[32:35], v[156:159], v[96:111]
    ds_read_b64_tr_b16 v[24:25], v21 offset:4096
    ds_read_b64_tr_b16 v[26:27], v21 offset:4608
    v_mfma_f32_32x32x16_bf16 v[112:127], v[36:39], v[156:159], v[112:127]
    ds_read_b64_tr_b16 v[28:29], v22 offset:4096
    ds_read_b64_tr_b16 v[30:31], v22 offset:4608
    s_waitcnt lgkmcnt(2)
    v_mfma_f32_32x32x16_bf16 v[96:111], v[24:27], v[160:163], v[96:111]
    ds_read_b64_tr_b16 v[32:33], v21 offset:6144
    ds_read_b64_tr_b16 v[34:35], v21 offset:6656
    s_waitcnt lgkmcnt(2)
    v_mfma_f32_32x32x16_bf16 v[112:127], v[28:31], v[160:163], v[112:127]
    ds_read_b64_tr_b16 v[36:37], v22 offset:6144
    ds_read_b64_tr_b16 v[38:39], v22 offset:6656
    s_waitcnt lgkmcnt(2)
    v_mfma_f32_32x32x16_bf16 v[96:111], v[32:35], v[164:167], v[96:111]
    ds_read_b64_tr_b16 v[24:25], v21 offset:20480
    ds_read_b64_tr_b16 v[26:27], v21 offset:20992
    s_waitcnt lgkmcnt(2)
    v_mfma_f32_32x32x16_bf16 v[112:127], v[36:39], v[164:167], v[112:127]
    ds_read_b64_tr_b16 v[28:29], v22 offset:20480
    ds_read_b64_tr_b16 v[30:31], v22 offset:20992
    s_waitcnt lgkmcnt(2)
    v_mfma_f32_32x32x16_bf16 v[96:111], v[24:27], v[168:171], v[96:111]
    ds_read_b64_tr_b16 v[32:33], v21 offset:22528
    ds_read_b64_tr_b16 v[34:35], v21 offset:23040
    s_waitcnt lgkmcnt(2)
    v_mfma_f32_32x32x16_bf16 v[112:127], v[28:31], v[168:171], v[112:127]
    ds_read_b64_tr_b16 v[36:37], v22 offset:22528
    ds_read_b64_tr_b16 v[38:39], v22 offset:23040
    s_waitcnt lgkmcnt(2)
    v_mfma_f32_32x32x16_bf16 v[96:111], v[32:35], v[172:175], v[96:111]
    ds_read_b64_tr_b16 v[24:25], v21 offset:36864
    ds_read_b64_tr_b16 v[26:27], v21 offset:37376
    s_waitcnt lgkmcnt(2)
    v_mfma_f32_32x32x16_bf16 v[112:127], v[36:39], v[172:175], v[112:127]
    ds_read_b64_tr_b16 v[28:29], v22 offset:36864
    ds_read_b64_tr_b16 v[30:31], v22 offset:37376
    s_cmp_ge_u32 s4, 2
    s_cbranch_scc1 L_grl_skip_29
    s_cmp_eq_u32 s6, 0
    s_cbranch_scc1 L_grl_skip_29
    s_add_u32 s13, s6, 1
    s_lshr_b32 s13, s13, 1
    buffer_load_dwordx2 v[136:137], v4, s[68:71], s93 offen offset:3584 sc1
    s_cmp_eq_u32 s13, 1
    s_cbranch_scc1 L_grl_skip_29
    buffer_load_dwordx2 v[138:139], v4, s[68:71], s93 offen offset:3072 sc1
    s_cmp_eq_u32 s13, 2
    s_cbranch_scc1 L_grl_skip_29
    buffer_load_dwordx2 v[140:141], v4, s[68:71], s93 offen offset:2560 sc1
    s_cmp_eq_u32 s13, 3
    s_cbranch_scc1 L_grl_skip_29
    buffer_load_dwordx2 v[142:143], v4, s[68:71], s93 offen offset:2048 sc1
    s_cmp_eq_u32 s13, 4
    s_cbranch_scc1 L_grl_skip_29
    buffer_load_dwordx2 v[144:145], v4, s[68:71], s93 offen offset:1536 sc1
    s_cmp_eq_u32 s13, 5
    s_cbranch_scc1 L_grl_skip_29
    buffer_load_dwordx2 v[146:147], v4, s[68:71], s93 offen offset:1024 sc1
    s_cmp_eq_u32 s13, 6
    s_cbranch_scc1 L_grl_skip_29
    buffer_load_dwordx2 v[148:149], v4, s[68:71], s93 offen offset:512 sc1
    s_cmp_eq_u32 s13, 7
    s_cbranch_scc1 L_grl_skip_29
    buffer_load_dwordx2 v[150:151], v4, s[68:71], s93 offen offset:0 sc1
L_grl_skip_29:
    s_waitcnt lgkmcnt(2)
    v_mfma_f32_32x32x16_bf16 v[96:111], v[24:27], v[176:179], v[96:111]
    ds_read_b64_tr_b16 v[32:33], v21 offset:38912
    ds_read_b64_tr_b16 v[34:35], v21 offset:39424
    s_waitcnt lgkmcnt(2)
    v_mfma_f32_32x32x16_bf16 v[112:127], v[28:31], v[176:179], v[112:127]
    ds_read_b64_tr_b16 v[36:37], v22 offset:38912
    ds_read_b64_tr_b16 v[38:39], v22 offset:39424
    s_waitcnt lgkmcnt(2)
    v_mfma_f32_32x32x16_bf16 v[96:111], v[32:35], v[180:183], v[96:111]
    ds_read_b64_tr_b16 v[24:25], v21 offset:53248
    ds_read_b64_tr_b16 v[26:27], v21 offset:53760
    s_waitcnt lgkmcnt(2)
    v_mfma_f32_32x32x16_bf16 v[112:127], v[36:39], v[180:183], v[112:127]
    ds_read_b64_tr_b16 v[28:29], v22 offset:53248
    ds_read_b64_tr_b16 v[30:31], v22 offset:53760
    s_waitcnt lgkmcnt(2)
    v_mfma_f32_32x32x16_bf16 v[96:111], v[24:27], v[184:187], v[96:111]
    ds_read_b64_tr_b16 v[32:33], v21 offset:55296
    ds_read_b64_tr_b16 v[34:35], v21 offset:55808
    s_waitcnt lgkmcnt(2)
    v_mfma_f32_32x32x16_bf16 v[112:127], v[28:31], v[184:187], v[112:127]
    ds_read_b64_tr_b16 v[36:37], v22 offset:55296
    ds_read_b64_tr_b16 v[38:39], v22 offset:55808
    s_waitcnt vmcnt(4) lgkmcnt(0)
    s_barrier
    v_mfma_f32_32x32x16_bf16 v[96:111], v[32:35], v[188:191], v[96:111]
    ds_read_b64_tr_b16 v[24:25], v21 offset:8192
    ds_read_b64_tr_b16 v[26:27], v21 offset:8704
    v_mfma_f32_32x32x16_bf16 v[112:127], v[36:39], v[188:191], v[112:127]
    ds_read_b64_tr_b16 v[28:29], v22 offset:8192
    ds_read_b64_tr_b16 v[30:31], v22 offset:8704
    s_waitcnt lgkmcnt(2)
    v_mfma_f32_32x32x16_bf16 v[96:111], v[24:27], v[192:195], v[96:111]
    ds_read_b64_tr_b16 v[32:33], v21 offset:10240
    ds_read_b64_tr_b16 v[34:35], v21 offset:10752
    s_waitcnt lgkmcnt(2)
    v_mfma_f32_32x32x16_bf16 v[112:127], v[28:31], v[192:195], v[112:127]
    ds_read_b64_tr_b16 v[36:37], v22 offset:10240
    ds_read_b64_tr_b16 v[38:39], v22 offset:10752
    s_cmp_ge_u32 s4, 2
    s_cbranch_scc1 L_car_skip_30
    s_cmp_eq_u32 s6, 0
    s_cbranch_scc1 L_car_skip_30
    ds_read_b128 v[152:155], v3 offset:16
    s_add_u32 s13, s6, 1
    s_lshr_b32 s13, s13, 1
    s_bitcmp1_b32 s6, 0
    s_cselect_b32 s89, 0, -1
    s_mov_b32 s88, -1
    s_mov_b32 s86, 0
    s_waitcnt vmcnt(0)
L_car_poll_31:
    s_mov_b64 s[90:91], 0
    v_cmp_ne_u32 vcc, s34, v137
    s_cmp_eq_u32 s13, 1
    s_cbranch_scc1 L_car_chk_32
    s_or_b64 s[90:91], s[90:91], vcc
    v_cmp_ne_u32 vcc, s34, v139
    s_cmp_eq_u32 s13, 2
    s_cbranch_scc1 L_car_chk_32
    s_or_b64 s[90:91], s[90:91], vcc
    v_cmp_ne_u32 vcc, s34, v141
    s_cmp_eq_u32 s13, 3
    s_cbranch_scc1 L_car_chk_32
    s_or_b64 s[90:91], s[90:91], vcc
    v_cmp_ne_u32 vcc, s34, v143
    s_cmp_eq_u32 s13, 4
    s_cbranch_scc1 L_car_chk_32
    s_or_b64 s[90:91], s[90:91], vcc
    v_cmp_ne_u32 vcc, s34, v145
    s_cmp_eq_u32 s13, 5
    s_cbranch_scc1 L_car_chk_32
    s_or_b64 s[90:91], s[90:91], vcc
    v_cmp_ne_u32 vcc, s34, v147
    s_cmp_eq_u32 s13, 6
    s_cbranch_scc1 L_car_chk_32
    s_or_b64 s[90:91], s[90:91], vcc
    v_cmp_ne_u32 vcc, s34, v149
    s_cmp_eq_u32 s13, 7
    s_cbranch_scc1 L_car_chk_32
    s_or_b64 s[90:91], s[90:91], vcc
    v_cmp_ne_u32 vcc, s34, v151
L_car_chk_32:
    s_and_b64 vcc, vcc, s[88:89]
    s_or_b64 s[90:91], s[90:91], vcc
    s_cbranch_scc0 L_car_ok_33
    s_add_u32 s86, s86, 1
    s_cmp_ge_u32 s86, 0x4000
    s_cbranch_scc1 L_car_ok_33
    s_sleep 1
    buffer_load_dwordx2 v[136:137], v4, s[68:71], s93 offen offset:3584 sc1
    s_cmp_eq_u32 s13, 1
    s_cbranch_scc1 L_car_re_34
    buffer_load_dwordx2 v[138:139], v4, s[68:71], s93 offen offset:3072 sc1
    s_cmp_eq_u32 s13, 2
    s_cbranch_scc1 L_car_re_34
    buffer_load_dwordx2 v[140:141], v4, s[68:71], s93 offen offset:2560 sc1
    s_cmp_eq_u32 s13, 3
    s_cbranch_scc1 L_car_re_34
    buffer_load_dwordx2 v[142:143], v4, s[68:71], s93 offen offset:2048 sc1
    s_cmp_eq_u32 s13, 4
    s_cbranch_scc1 L_car_re_34
    buffer_load_dwordx2 v[144:145], v4, s[68:71], s93 offen offset:1536 sc1
    s_cmp_eq_u32 s13, 5
    s_cbranch_scc1 L_car_re_34
    buffer_load_dwordx2 v[146:147], v4, s[68:71], s93 offen offset:1024 sc1
    s_cmp_eq_u32 s13, 6
    s_cbranch_scc1 L_car_re_34
    buffer_load_dwordx2 v[148:149], v4, s[68:71], s93 offen offset:512 sc1
    s_cmp_eq_u32 s13, 7
    s_cbranch_scc1 L_car_re_34
    buffer_load_dwordx2 v[150:151], v4, s[68:71], s93 offen offset:0 sc1
L_car_re_34:
    s_waitcnt vmcnt(0)
    s_branch L_car_poll_31
L_car_ok_33:
    s_waitcnt lgkmcnt(0)
    v_mov_b32 v156, 0
    s_cmp_le_u32 s13, 7
    s_cbranch_scc1 L_hs_35
    s_cmp_eq_u32 s13, 8
    s_cselect_b64 vcc, s[88:89], -1
    v_cndmask_b32 v150, 0, v150, vcc
    v_fmac_f32 v150, v154, v156
    v_fmac_f32_dpp v150, v156, v155 quad_perm:[1,0,3,2] row_mask:0xf bank_mask:0xf
    v_mov_b32 v156, v150
L_hs_35:
    s_cmp_le_u32 s13, 6
    s_cbranch_scc1 L_hs_36
    s_cmp_eq_u32 s13, 7
    s_cselect_b64 vcc, s[88:89], -1
    v_cndmask_b32 v148, 0, v148, vcc
    v_fmac_f32 v148, v154, v156
    v_fmac_f32_dpp v148, v156, v155 quad_perm:[1,0,3,2] row_mask:0xf bank_mask:0xf
    v_mov_b32 v156, v148
L_hs_36:
    s_cmp_le_u32 s13, 5
    s_cbranch_scc1 L_hs_37
    s_cmp_eq_u32 s13, 6
    s_cselect_b64 vcc, s[88:89], -1
    v_cndmask_b32 v146, 0, v146, vcc
    v_fmac_f32 v146, v154, v156
    v_fmac_f32_dpp v146, v156, v155 quad_perm:[1,0,3,2] row_mask:0xf bank_mask:0xf
    v_mov_b32 v156, v146
L_hs_37:
    s_cmp_le_u32 s13, 4
    s_cbranch_scc1 L_hs_38
    s_cmp_eq_u32 s13, 5
    s_cselect_b64 vcc, s[88:89], -1
    v_cndmask_b32 v144, 0, v144, vcc
    v_fmac_f32 v144, v154, v156
    v_fmac_f32_dpp v144, v156, v155 quad_perm:[1,0,3,2] row_mask:0xf bank_mask:0xf
    v_mov_b32 v156, v144
L_hs_38:
    s_cmp_le_u32 s13, 3
    s_cbranch_scc1 L_hs_39
    s_cmp_eq_u32 s13, 4
    s_cselect_b64 vcc, s[88:89], -1
    v_cndmask_b32 v142, 0, v142, vcc
    v_fmac_f32 v142, v154, v156
    v_fmac_f32_dpp v142, v156, v155 quad_perm:[1,0,3,2] row_mask:0xf bank_mask:0xf
    v_mov_b32 v156, v142
L_hs_39:
    s_cmp_le_u32 s13, 2
    s_cbranch_scc1 L_hs_40
    s_cmp_eq_u32 s13, 3
    s_cselect_b64 vcc, s[88:89], -1
    v_cndmask_b32 v140, 0, v140, vcc
    v_fmac_f32 v140, v154, v156
    v_fmac_f32_dpp v140, v156, v155 quad_perm:[1,0,3,2] row_mask:0xf bank_mask:0xf
    v_mov_b32 v156, v140
L_hs_40:
    s_cmp_le_u32 s13, 1
    s_cbranch_scc1 L_hs_41
    s_cmp_eq_u32 s13, 2
    s_cselect_b64 vcc, s[88:89], -1
    v_cndmask_b32 v138, 0, v138, vcc
    v_fmac_f32 v138, v154, v156
    v_fmac_f32_dpp v138, v156, v155 quad_perm:[1,0,3,2] row_mask:0xf bank_mask:0xf
    v_mov_b32 v156, v138
L_hs_41:
    s_cmp_le_u32 s13, 0
    s_cbranch_scc1 L_hs_42
    s_cmp_eq_u32 s13, 1
    s_cselect_b64 vcc, s[88:89], -1
    v_cndmask_b32 v136, 0, v136, vcc
    v_fmac_f32 v136, v154, v156
    v_fmac_f32_dpp v136, v156, v155 quad_perm:[1,0,3,2] row_mask:0xf bank_mask:0xf
    v_mov_b32 v156, v136
L_hs_42:
    s_nop 0
    v_mul_f32 v157, v152, v156
    v_fmac_f32_dpp v157, v156, v153 quad_perm:[1,0,3,2] row_mask:0xf bank_mask:0xf
    v_mov_b32 v158, 0
    s_nop 0
    v_permlane32_swap_b32 v157, v158
    s_nop 0
    v_add_f32 v156, v156, v158
    s_mov_b32 exec_hi, 0
    ds_write_b32 v2, v156 offset:896
    s_mov_b64 exec, -1
    s_waitcnt lgkmcnt(0)
L_car_skip_30:
    s_waitcnt lgkmcnt(2)
    v_mfma_f32_32x32x16_bf16 v[96:111], v[32:35], v[196:199], v[96:111]
    ds_read_b64_tr_b16 v[24:25], v21 offset:24576
    ds_read_b64_tr_b16 v[26:27], v21 offset:25088
    s_waitcnt lgkmcnt(2)
    v_mfma_f32_32x32x16_bf16 v[112:127], v[36:39], v[196:199], v[112:127]
    ds_read_b64_tr_b16 v[28:29], v22 offset:24576
    ds_read_b64_tr_b16 v[30:31], v22 offset:25088
    s_add_u32 m0, s94, 0
    s_add_u32 s15, s95, 0
    buffer_load_dwordx4 v6, s[72:75], s15 offen lds
    buffer_load_dwordx4 v7, s[72:75], s15 offen offset:1024 lds
    s_add_u32 s15, s15, 14336
    buffer_load_dwordx4 v6, s[72:75], s15 offen offset:2048 lds
    buffer_load_dwordx4 v7, s[72:75], s15 offen offset:3072 lds
    s_add_u32 m0, s94, 4096
    s_add_u32 s15, s95, 0
    buffer_load_dwordx4 v6, s[56:59], s15 offen lds
    buffer_load_dwordx4 v7, s[56:59], s15 offen offset:1024 lds
    s_add_u32 s15, s15, 14336
    buffer_load_dwordx4 v6, s[56:59], s15 offen offset:2048 lds
    buffer_load_dwordx4 v7, s[56:59], s15 offen offset:3072 lds
    s_waitcnt lgkmcnt(2)
    v_mfma_f32_32x32x16_bf16 v[96:111], v[24:27], v[200:203], v[96:111]
    ds_read_b64_tr_b16 v[32:33], v21 offset:26624
    ds_read_b64_tr_b16 v[34:35], v21 offset:27136
    s_waitcnt lgkmcnt(2)
    v_mfma_f32_32x32x16_bf16 v[112:127], v[28:31], v[200:203], v[112:127]
    ds_read_b64_tr_b16 v[36:37], v22 offset:26624
    ds_read_b64_tr_b16 v[38:39], v22 offset:27136
    v_lshlrev_b32 v16, 2, v0
    v_add_u32 v17, 161856, v16
    s_cmp_lg_u32 s4, 0
    s_cbranch_scc1 L_g_skip_43
    s_mov_b64 exec, 0xff
    ds_read_b32 v17, v17
    s_waitcnt lgkmcnt(0)
    buffer_store_dword v17, v16, s[68:71], s87 offen sc1
    s_mov_b64 exec, -1
L_g_skip_43:
    s_waitcnt lgkmcnt(2)
    v_mfma_f32_32x32x16_bf16 v[96:111], v[32:35], v[204:207], v[96:111]
    ds_read_b64_tr_b16 v[24:25], v21 offset:40960
    ds_read_b64_tr_b16 v[26:27], v21 offset:41472
    s_waitcnt lgkmcnt(2)
    v_mfma_f32_32x32x16_bf16 v[112:127], v[36:39], v[204:207], v[112:127]
    ds_read_b64_tr_b16 v[28:29], v22 offset:40960
    ds_read_b64_tr_b16 v[30:31], v22 offset:41472
    s_barrier
    s_waitcnt lgkmcnt(2)
    v_mfma_f32_32x32x16_bf16 v[96:111], v[24:27], v[208:211], v[96:111]
    ds_read_b64_tr_b16 v[32:33], v21 offset:43008
    ds_read_b64_tr_b16 v[34:35], v21 offset:43520
    ds_read_b128 v[136:139], v20 offset:0
    ds_read_b32 v144, v1 offset:0
    ds_read_b32 v145, v1 offset:128
    ds_read_b32 v146, v1 offset:256
    ds_read_b32 v147, v1 offset:384
    ds_read_b32 v148, v1 offset:512
    ds_read_b32 v149, v1 offset:640
    ds_read_b32 v150, v1 offset:768
    ds_read_b32 v151, v1 offset:896
    ds_read_b128 v[140:143], v20 offset:1536
    ds_read_b32 v152, v1 offset:2048
    ds_read_b32 v153, v1 offset:2176
    ds_read_b32 v154, v1 offset:2304
    ds_read_b32 v155, v1 offset:2432
    ds_read_b32 v156, v1 offset:2560
    ds_read_b32 v157, v1 offset:2688
    ds_read_b32 v158, v1 offset:2816
    ds_read_b32 v159, v1 offset:2944
    s_mul_i32 s78, s4, 1280
    s_add_u32 s78, s78, 141312
    v_and_b32 v10, 15, v0
    v_mul_u32_u24 v10, 80, v10
    s_waitcnt lgkmcnt(15)
    v_mfma_f32_32x32x16_bf16 v[112:127], v[28:31], v[208:211], v[112:127]
    ds_read_b64_tr_b16 v[36:37], v22 offset:43008
    ds_read_b64_tr_b16 v[38:39], v22 offset:43520
    v_lshrrev_b32 v11, 5, v0
    v_lshl_add_u32 v10, v11, 5, v10
    v_add_u32 v10, s78, v10
    v_bfe_u32 v12, v0, 2, 2
    v_lshl_add_u32 v11, v12, 1, v11
    v_mul_u32_u24 v11, 80, v11
    v_and_b32 v12, 1, v0
    v_lshl_add_u32 v11, v12, 5, v11
    v_bfe_u32 v12, v0, 4, 1
    v_lshl_add_u32 v11, v12, 4, v11
    v_bfe_u32 v12, v0, 1, 1
    v_lshl_add_u32 v11, v12, 3, v11
    v_mfma_f32_32x32x16_bf16 v[96:111], v[32:35], v[212:215], v[96:111]
    ds_read_b64_tr_b16 v[24:25], v21 offset:57344
    ds_read_b64_tr_b16 v[26:27], v21 offset:57856
    v_add_u32 v11, s78, v11
    ds_read_b64 v[12:13], v20 offset:32
    ds_read_b64 v[14:15], v20 offset:1568
    s_waitcnt lgkmcnt(6)
    v_fmac_f32 v145, v138, v144
    v_fmac_f32 v153, v142, v152
    v_fmac_f32_dpp v145, v144, v139 quad_perm:[1,0,3,2] row_mask:0xf bank_mask:0xf
    v_fmac_f32_dpp v153, v152, v143 quad_perm:[1,0,3,2] row_mask:0xf bank_mask:0xf
    v_fmac_f32 v146, v138, v145
    v_fmac_f32 v154, v142, v153
    v_fmac_f32_dpp v146, v145, v139 quad_perm:[1,0,3,2] row_mask:0xf bank_mask:0xf
    v_fmac_f32_dpp v154, v153, v143 quad_perm:[1,0,3,2] row_mask:0xf bank_mask:0xf
    v_fmac_f32 v147, v138, v146
    s_waitcnt lgkmcnt(4)
    v_mfma_f32_32x32x16_bf16 v[112:127], v[36:39], v[212:215], v[112:127]
    ds_read_b64_tr_b16 v[28:29], v22 offset:57344
    ds_read_b64_tr_b16 v[30:31], v22 offset:57856
    v_fmac_f32 v155, v142, v154
    v_fmac_f32_dpp v147, v146, v139 quad_perm:[1,0,3,2] row_mask:0xf bank_mask:0xf
    v_fmac_f32_dpp v155, v154, v143 quad_perm:[1,0,3,2] row_mask:0xf bank_mask:0xf
    v_fmac_f32 v148, v138, v147
    v_fmac_f32 v156, v142, v155
    v_fmac_f32_dpp v148, v147, v139 quad_perm:[1,0,3,2] row_mask:0xf bank_mask:0xf
    v_fmac_f32_dpp v156, v155, v143 quad_perm:[1,0,3,2] row_mask:0xf bank_mask:0xf
    v_fmac_f32 v149, v138, v148
    v_fmac_f32 v157, v142, v156
    v_fmac_f32_dpp v149, v148, v139 quad_perm:[1,0,3,2] row_mask:0xf bank_mask:0xf
    v_fmac_f32_dpp v157, v156, v143 quad_perm:[1,0,3,2] row_mask:0xf bank_mask:0xf
    v_fmac_f32 v150, v138, v149
    s_waitcnt lgkmcnt(4)
    v_mfma_f32_32x32x16_bf16 v[96:111], v[24:27], v[216:219], v[96:111]
    ds_read_b64_tr_b16 v[32:33], v21 offset:59392
    ds_read_b64_tr_b16 v[34:35], v21 offset:59904
    v_fmac_f32 v158, v142, v157
    v_fmac_f32_dpp v150, v149, v139 quad_perm:[1,0,3,2] row_mask:0xf bank_mask:0xf
    v_fmac_f32_dpp v158, v157, v143 quad_perm:[1,0,3,2] row_mask:0xf bank_mask:0xf
    v_fmac_f32 v151, v138, v150
    v_fmac_f32 v159, v142, v158
    v_fmac_f32_dpp v151, v150, v139 quad_perm:[1,0,3,2] row_mask:0xf bank_mask:0xf
    v_fmac_f32_dpp v159, v158, v143 quad_perm:[1,0,3,2] row_mask:0xf bank_mask:0xf
    s_waitcnt lgkmcnt(4)
    v_fmac_f32 v48, v136, v151
    v_fmac_f32 v64, v140, v159
    v_fmac_f32_dpp v48, v151, v137 quad_perm:[1,0,3,2] row_mask:0xf bank_mask:0xf
    v_fmac_f32_dpp v64, v159, v141 quad_perm:[1,0,3,2] row_mask:0xf bank_mask:0xf
    v_fmac_f32 v49, v136, v48
    s_waitcnt lgkmcnt(2)
    v_mfma_f32_32x32x16_bf16 v[112:127], v[28:31], v[216:219], v[112:127]
    ds_read_b64_tr_b16 v[36:37], v22 offset:59392
    ds_read_b64_tr_b16 v[38:39], v22 offset:59904
    v_fmac_f32 v65, v140, v64
    v_fmac_f32_dpp v49, v48, v137 quad_perm:[1,0,3,2] row_mask:0xf bank_mask:0xf
    v_fmac_f32_dpp v65, v64, v141 quad_perm:[1,0,3,2] row_mask:0xf bank_mask:0xf
    v_fmac_f32 v50, v136, v49
    v_fmac_f32 v66, v140, v65
    v_mul_f32 v160, v12, v48
    v_fmac_f32_dpp v160, v48, v13 quad_perm:[1,0,3,2] row_mask:0xf bank_mask:0xf
    v_mul_f32 v162, v14, v64
    v_fmac_f32_dpp v162, v64, v15 quad_perm:[1,0,3,2] row_mask:0xf bank_mask:0xf
    v_fmac_f32_dpp v50, v49, v137 quad_perm:[1,0,3,2] row_mask:0xf bank_mask:0xf
    v_fmac_f32_dpp v66, v65, v141 quad_perm:[1,0,3,2] row_mask:0xf bank_mask:0xf
    v_fmac_f32 v51, v136, v50
    v_fmac_f32 v67, v140, v66
    v_mul_f32 v161, v12, v49
    v_fmac_f32_dpp v161, v49, v13 quad_perm:[1,0,3,2] row_mask:0xf bank_mask:0xf
    v_cvt_pk_bf16_f32 v144, v160, v161
    s_waitcnt vmcnt(8) lgkmcnt(0)
    s_barrier
    v_mfma_f32_32x32x16_bf16 v[96:111], v[32:35], v[220:223], v[96:111]
    ds_read_b64_tr_b16 v[24:25], v21 offset:12288
    ds_read_b64_tr_b16 v[26:27], v21 offset:12800
    v_mul_f32 v163, v14, v65
    v_fmac_f32_dpp v163, v65, v15 quad_perm:[1,0,3,2] row_mask:0xf bank_mask:0xf
    v_cvt_pk_bf16_f32 v152, v162, v163
    v_fmac_f32_dpp v51, v50, v137 quad_perm:[1,0,3,2] row_mask:0xf bank_mask:0xf
    v_fmac_f32_dpp v67, v66, v141 quad_perm:[1,0,3,2] row_mask:0xf bank_mask:0xf
    v_fmac_f32 v52, v136, v51
    v_fmac_f32 v68, v140, v67
    v_mul_f32 v160, v12, v50
    v_fmac_f32_dpp v160, v50, v13 quad_perm:[1,0,3,2] row_mask:0xf bank_mask:0xf
    v_mul_f32 v162, v14, v66
    v_fmac_f32_dpp v162, v66, v15 quad_perm:[1,0,3,2] row_mask:0xf bank_mask:0xf
    v_fmac_f32_dpp v52, v51, v137 quad_perm:[1,0,3,2] row_mask:0xf bank_mask:0xf
    v_fmac_f32_dpp v68, v67, v141 quad_perm:[1,0,3,2] row_mask:0xf bank_mask:0xf
    v_fmac_f32 v53, v136, v52
    v_fmac_f32 v69, v140, v68
    v_mul_f32 v161, v12, v51
    v_fmac_f32_dpp v161, v51, v13 quad_perm:[1,0,3,2] row_mask:0xf bank_mask:0xf
    v_cvt_pk_bf16_f32 v145, v160, v161
    v_mfma_f32_32x32x16_bf16 v[112:127], v[36:39], v[220:223], v[112:127]
    ds_read_b64_tr_b16 v[28:29], v22 offset:12288
    ds_read_b64_tr_b16 v[30:31], v22 offset:12800
    v_mul_f32 v163, v14, v67
    v_fmac_f32_dpp v163, v67, v15 quad_perm:[1,0,3,2] row_mask:0xf bank_mask:0xf
    v_cvt_pk_bf16_f32 v153, v162, v163
    v_fmac_f32_dpp v53, v52, v137 quad_perm:[1,0,3,2] row_mask:0xf bank_mask:0xf
    v_fmac_f32_dpp v69, v68, v141 quad_perm:[1,0,3,2] row_mask:0xf bank_mask:0xf
    v_fmac_f32 v54, v136, v53
    v_fmac_f32 v70, v140, v69
    v_mul_f32 v160, v12, v52
    v_fmac_f32_dpp v160, v52, v13 quad_perm:[1,0,3,2] row_mask:0xf bank_mask:0xf
    v_mul_f32 v162, v14, v68
    v_fmac_f32_dpp v162, v68, v15 quad_perm:[1,0,3,2] row_mask:0xf bank_mask:0xf
    v_fmac_f32_dpp v54, v53, v137 quad_perm:[1,0,3,2] row_mask:0xf bank_mask:0xf
    v_fmac_f32_dpp v70, v69, v141 quad_perm:[1,0,3,2] row_mask:0xf bank_mask:0xf
    v_fmac_f32 v55, v136, v54
    v_fmac_f32 v71, v140, v70
    v_mul_f32 v161, v12, v53
    v_fmac_f32_dpp v161, v53, v13 quad_perm:[1,0,3,2] row_mask:0xf bank_mask:0xf
    v_cvt_pk_bf16_f32 v146, v160, v161
    s_waitcnt lgkmcnt(2)
    v_mfma_f32_32x32x16_bf16 v[96:111], v[24:27], v[224:227], v[96:111]
    ds_read_b64_tr_b16 v[32:33], v21 offset:14336
    ds_read_b64_tr_b16 v[34:35], v21 offset:14848
    v_mul_f32 v163, v14, v69
    v_fmac_f32_dpp v163, v69, v15 quad_perm:[1,0,3,2] row_mask:0xf bank_mask:0xf
    v_cvt_pk_bf16_f32 v154, v162, v163
    v_fmac_f32_dpp v55, v54, v137 quad_perm:[1,0,3,2] row_mask:0xf bank_mask:0xf
    v_fmac_f32_dpp v71, v70, v141 quad_perm:[1,0,3,2] row_mask:0xf bank_mask:0xf
    v_fmac_f32 v56, v136, v55
    v_fmac_f32 v72, v140, v71
    v_mul_f32 v160, v12, v54
    v_fmac_f32_dpp v160, v54, v13 quad_perm:[1,0,3,2] row_mask:0xf bank_mask:0xf
    v_mul_f32 v162, v14, v70
    v_fmac_f32_dpp v162, v70, v15 quad_perm:[1,0,3,2] row_mask:0xf bank_mask:0xf
    v_fmac_f32_dpp v56, v55, v137 quad_perm:[1,0,3,2] row_mask:0xf bank_mask:0xf
    v_fmac_f32_dpp v72, v71, v141 quad_perm:[1,0,3,2] row_mask:0xf bank_mask:0xf
    v_fmac_f32 v57, v136, v56
    v_fmac_f32 v73, v140, v72
    v_mul_f32 v161, v12, v55
    v_fmac_f32_dpp v161, v55, v13 quad_perm:[1,0,3,2] row_mask:0xf bank_mask:0xf
    v_cvt_pk_bf16_f32 v147, v160, v161
    s_waitcnt lgkmcnt(2)
    v_mfma_f32_32x32x16_bf16 v[112:127], v[28:31], v[224:227], v[112:127]
    ds_read_b64_tr_b16 v[36:37], v22 offset:14336
    ds_read_b64_tr_b16 v[38:39], v22 offset:14848
    v_mul_f32 v163, v14, v71
    v_fmac_f32_dpp v163, v71, v15 quad_perm:[1,0,3,2] row_mask:0xf bank_mask:0xf
    v_cvt_pk_bf16_f32 v155, v162, v163
    v_fmac_f32_dpp v57, v56, v137 quad_perm:[1,0,3,2] row_mask:0xf bank_mask:0xf
    v_fmac_f32_dpp v73, v72, v141 quad_perm:[1,0,3,2] row_mask:0xf bank_mask:0xf
    v_fmac_f32 v58, v136, v57
    v_fmac_f32 v74, v140, v73
    v_mul_f32 v160, v12, v56
    v_fmac_f32_dpp v160, v56, v13 quad_perm:[1,0,3,2] row_mask:0xf bank_mask:0xf
    v_mul_f32 v162, v14, v72
    v_fmac_f32_dpp v162, v72, v15 quad_perm:[1,0,3,2] row_mask:0xf bank_mask:0xf
    v_fmac_f32_dpp v58, v57, v137 quad_perm:[1,0,3,2] row_mask:0xf bank_mask:0xf
    v_fmac_f32_dpp v74, v73, v141 quad_perm:[1,0,3,2] row_mask:0xf bank_mask:0xf
    v_fmac_f32 v59, v136, v58
    v_fmac_f32 v75, v140, v74
    v_mul_f32 v161, v12, v57
    v_fmac_f32_dpp v161, v57, v13 quad_perm:[1,0,3,2] row_mask:0xf bank_mask:0xf
    v_cvt_pk_bf16_f32 v148, v160, v161
    s_waitcnt lgkmcnt(2)
    v_mfma_f32_32x32x16_bf16 v[96:111], v[32:35], v[228:231], v[96:111]
    ds_read_b64_tr_b16 v[24:25], v21 offset:28672
    ds_read_b64_tr_b16 v[26:27], v21 offset:29184
    v_mul_f32 v163, v14, v73
    v_fmac_f32_dpp v163, v73, v15 quad_perm:[1,0,3,2] row_mask:0xf bank_mask:0xf
    v_cvt_pk_bf16_f32 v156, v162, v163
    v_fmac_f32_dpp v59, v58, v137 quad_perm:[1,0,3,2] row_mask:0xf bank_mask:0xf
    v_fmac_f32_dpp v75, v74, v141 quad_perm:[1,0,3,2] row_mask:0xf bank_mask:0xf
    v_fmac_f32 v60, v136, v59
    v_fmac_f32 v76, v140, v75
    v_mul_f32 v160, v12, v58
    v_fmac_f32_dpp v160, v58, v13 quad_perm:[1,0,3,2] row_mask:0xf bank_mask:0xf
    v_mul_f32 v162, v14, v74
    v_fmac_f32_dpp v162, v74, v15 quad_perm:[1,0,3,2] row_mask:0xf bank_mask:0xf
    v_fmac_f32_dpp v60, v59, v137 quad_perm:[1,0,3,2] row_mask:0xf bank_mask:0xf
    v_fmac_f32_dpp v76, v75, v141 quad_perm:[1,0,3,2] row_mask:0xf bank_mask:0xf
    v_fmac_f32 v61, v136, v60
    v_fmac_f32 v77, v140, v76
    v_mul_f32 v161, v12, v59
    v_fmac_f32_dpp v161, v59, v13 quad_perm:[1,0,3,2] row_mask:0xf bank_mask:0xf
    v_cvt_pk_bf16_f32 v149, v160, v161
    s_waitcnt lgkmcnt(2)
    v_mfma_f32_32x32x16_bf16 v[112:127], v[36:39], v[228:231], v[112:127]
    ds_read_b64_tr_b16 v[28:29], v22 offset:28672
    ds_read_b64_tr_b16 v[30:31], v22 offset:29184
    v_mul_f32 v163, v14, v75
    v_fmac_f32_dpp v163, v75, v15 quad_perm:[1,0,3,2] row_mask:0xf bank_mask:0xf
    v_cvt_pk_bf16_f32 v157, v162, v163
    v_fmac_f32_dpp v61, v60, v137 quad_perm:[1,0,3,2] row_mask:0xf bank_mask:0xf
    v_fmac_f32_dpp v77, v76, v141 quad_perm:[1,0,3,2] row_mask:0xf bank_mask:0xf
    v_fmac_f32 v62, v136, v61
    v_fmac_f32 v78, v140, v77
    v_mul_f32 v160, v12, v60
    v_fmac_f32_dpp v160, v60, v13 quad_perm:[1,0,3,2] row_mask:0xf bank_mask:0xf
    v_mul_f32 v162, v14, v76
    v_fmac_f32_dpp v162, v76, v15 quad_perm:[1,0,3,2] row_mask:0xf bank_mask:0xf
    v_fmac_f32_dpp v62, v61, v137 quad_perm:[1,0,3,2] row_mask:0xf bank_mask:0xf
    v_fmac_f32_dpp v78, v77, v141 quad_perm:[1,0,3,2] row_mask:0xf bank_mask:0xf
    v_fmac_f32 v63, v136, v62
    v_fmac_f32 v79, v140, v78
    v_mul_f32 v161, v12, v61
    v_fmac_f32_dpp v161, v61, v13 quad_perm:[1,0,3,2] row_mask:0xf bank_mask:0xf
    v_cvt_pk_bf16_f32 v150, v160, v161
    s_waitcnt lgkmcnt(2)
    v_mfma_f32_32x32x16_bf16 v[96:111], v[24:27], v[232:235], v[96:111]
    ds_read_b64_tr_b16 v[32:33], v21 offset:30720
    ds_read_b64_tr_b16 v[34:35], v21 offset:31232
    v_mul_f32 v163, v14, v77
    v_fmac_f32_dpp v163, v77, v15 quad_perm:[1,0,3,2] row_mask:0xf bank_mask:0xf
    v_cvt_pk_bf16_f32 v158, v162, v163
    v_fmac_f32_dpp v63, v62, v137 quad_perm:[1,0,3,2] row_mask:0xf bank_mask:0xf
    v_fmac_f32_dpp v79, v78, v141 quad_perm:[1,0,3,2] row_mask:0xf bank_mask:0xf
    v_mul_f32 v160, v12, v62
    v_fmac_f32_dpp v160, v62, v13 quad_perm:[1,0,3,2] row_mask:0xf bank_mask:0xf
    v_mul_f32 v162, v14, v78
    v_fmac_f32_dpp v162, v78, v15 quad_perm:[1,0,3,2] row_mask:0xf bank_mask:0xf
    v_mul_f32 v161, v12, v63
    v_fmac_f32_dpp v161, v63, v13 quad_perm:[1,0,3,2] row_mask:0xf bank_mask:0xf
    v_cvt_pk_bf16_f32 v151, v160, v161
    v_mul_f32 v163, v14, v79
    v_fmac_f32_dpp v163, v79, v15 quad_perm:[1,0,3,2] row_mask:0xf bank_mask:0xf
    v_cvt_pk_bf16_f32 v159, v162, v163
    s_mov_b32 exec_lo, 0x0000ffff
    s_mov_b32 exec_hi, 0x0000ffff
    ds_write_b128 v10, v[144:147]
    ds_write_b128 v10, v[148:151] offset:16
    s_mov_b64 exec, -1
    ds_read_b64_tr_b16 v[48:49], v11 offset:0
    ds_read_b64_tr_b16 v[50:51], v11 offset:640
    s_mov_b32 exec_lo, 0xffff0000
    s_mov_b32 exec_hi, 0xffff0000
    ds_write_b128 v10, v[144:147]
    ds_write_b128 v10, v[148:151] offset:16
    s_mov_b64 exec, -1
    ds_read_b64_tr_b16 v[52:53], v11 offset:0
    s_waitcnt lgkmcnt(9)
    v_mfma_f32_32x32x16_bf16 v[112:127], v[28:31], v[232:235], v[112:127]
    ds_read_b64_tr_b16 v[36:37], v22 offset:30720
    ds_read_b64_tr_b16 v[38:39], v22 offset:31232
    ds_read_b64_tr_b16 v[54:55], v11 offset:640
    s_mov_b32 exec_lo, 0x0000ffff
    s_mov_b32 exec_hi, 0x0000ffff
    ds_write_b128 v10, v[152:155]
    ds_write_b128 v10, v[156:159] offset:16
    s_mov_b64 exec, -1
    ds_read_b64_tr_b16 v[64:65], v11 offset:0
    ds_read_b64_tr_b16 v[66:67], v11 offset:640
    s_mov_b32 exec_lo, 0xffff0000
    s_mov_b32 exec_hi, 0xffff0000
    ds_write_b128 v10, v[152:155]
    ds_write_b128 v10, v[156:159] offset:16
    s_mov_b64 exec, -1
    ds_read_b64_tr_b16 v[68:69], v11 offset:0
    ds_read_b64_tr_b16 v[70:71], v11 offset:640
    s_waitcnt lgkmcnt(8)
    s_add_u32 s12, s84, 0
    buffer_store_dwordx4 v[48:51], v23, s[68:71], s12 offen sc1
    buffer_store_dwordx4 v[52:55], v23, s[68:71], s12 offen offset:1024 sc1
    s_waitcnt lgkmcnt(0)
    s_add_u32 s12, s84, 2048
    buffer_store_dwordx4 v[64:67], v23, s[68:71], s12 offen sc1
    buffer_store_dwordx4 v[68:71], v23, s[68:71], s12 offen offset:1024 sc1
    v_mfma_f32_32x32x16_bf16 v[96:111], v[32:35], v[236:239], v[96:111]
    ds_read_b64_tr_b16 v[24:25], v21 offset:45056
    ds_read_b64_tr_b16 v[26:27], v21 offset:45568
    v_mfma_f32_32x32x16_bf16 v[112:127], v[36:39], v[236:239], v[112:127]
    ds_read_b64_tr_b16 v[28:29], v22 offset:45056
    ds_read_b64_tr_b16 v[30:31], v22 offset:45568
    s_waitcnt lgkmcnt(2)
    v_mfma_f32_32x32x16_bf16 v[96:111], v[24:27], v[240:243], v[96:111]
    ds_read_b64_tr_b16 v[32:33], v21 offset:47104
    ds_read_b64_tr_b16 v[34:35], v21 offset:47616
    s_waitcnt lgkmcnt(2)
    v_mfma_f32_32x32x16_bf16 v[112:127], v[28:31], v[240:243], v[112:127]
    ds_read_b64_tr_b16 v[36:37], v22 offset:47104
    ds_read_b64_tr_b16 v[38:39], v22 offset:47616
    s_waitcnt lgkmcnt(2)
    v_mfma_f32_32x32x16_bf16 v[96:111], v[32:35], v[244:247], v[96:111]
    ds_read_b64_tr_b16 v[24:25], v21 offset:61440
    ds_read_b64_tr_b16 v[26:27], v21 offset:61952
    s_waitcnt lgkmcnt(2)
    v_mfma_f32_32x32x16_bf16 v[112:127], v[36:39], v[244:247], v[112:127]
    ds_read_b64_tr_b16 v[28:29], v22 offset:61440
    ds_read_b64_tr_b16 v[30:31], v22 offset:61952
    s_waitcnt lgkmcnt(2)
    v_mfma_f32_32x32x16_bf16 v[96:111], v[24:27], v[248:251], v[96:111]
    ds_read_b64_tr_b16 v[32:33], v21 offset:63488
    ds_read_b64_tr_b16 v[34:35], v21 offset:64000
    s_waitcnt lgkmcnt(2)
    v_mfma_f32_32x32x16_bf16 v[112:127], v[28:31], v[248:251], v[112:127]
    ds_read_b64_tr_b16 v[36:37], v22 offset:63488
    ds_read_b64_tr_b16 v[38:39], v22 offset:64000
    s_waitcnt lgkmcnt(2)
    v_mfma_f32_32x32x16_bf16 v[96:111], v[32:35], v[252:255], v[96:111]
    s_waitcnt lgkmcnt(0)
    v_mfma_f32_32x32x16_bf16 v[112:127], v[36:39], v[252:255], v[112:127]
    s_nop 7
    s_nop 3
    v_pk_mul_f32 v[40:41], s[80:81], v[96:97] op_sel:[1,0] op_sel_hi:[1,1]
    v_pk_mul_f32 v[42:43], s[80:81], v[98:99] op_sel:[1,0] op_sel_hi:[1,1]
    v_pk_mul_f32 v[44:45], s[80:81], v[100:101] op_sel:[1,0] op_sel_hi:[1,1]
    v_pk_mul_f32 v[46:47], s[80:81], v[102:103] op_sel:[1,0] op_sel_hi:[1,1]
    v_exp_f32 v40, v40
    v_exp_f32 v41, v41
    v_pk_mul_f32 v[104:105], v[96:97], v[104:105]
    v_exp_f32 v42, v42
    v_exp_f32 v43, v43
    v_pk_mul_f32 v[106:107], v[98:99], v[106:107]
    v_exp_f32 v44, v44
    v_exp_f32 v45, v45
    v_pk_mul_f32 v[108:109], v[100:101], v[108:109]
    v_exp_f32 v46, v46
    v_exp_f32 v47, v47
    v_pk_mul_f32 v[110:111], v[102:103], v[110:111]
    v_pk_add_f32 v[40:41], v[40:41], 1.0 op_sel_hi:[1,0]
    v_pk_add_f32 v[42:43], v[42:43], 1.0 op_sel_hi:[1,0]
    v_pk_add_f32 v[44:45], v[44:45], 1.0 op_sel_hi:[1,0]
    v_pk_add_f32 v[46:47], v[46:47], 1.0 op_sel_hi:[1,0]
    v_rcp_f32 v40, v40
    v_rcp_f32 v41, v41
    v_rcp_f32 v42, v42
    v_rcp_f32 v43, v43
    v_pk_mul_f32 v[104:105], v[104:105], v[40:41]
    v_rcp_f32 v44, v44
    v_rcp_f32 v45, v45
    v_pk_mul_f32 v[106:107], v[106:107], v[42:43]
    v_rcp_f32 v46, v46
    v_rcp_f32 v47, v47
    v_pk_mul_f32 v[108:109], v[108:109], v[44:45]
    v_pk_mul_f32 v[110:111], v[110:111], v[46:47]
    v_cvt_pk_bf16_f32 v96, v104, v105
    v_cvt_pk_bf16_f32 v97, v106, v107
    v_cvt_pk_bf16_f32 v98, v108, v109
    v_cvt_pk_bf16_f32 v99, v110, v111
    buffer_store_dwordx4 v[96:99], v23, s[68:71], s83 offen sc1
    v_pk_mul_f32 v[40:41], s[80:81], v[112:113] op_sel:[1,0] op_sel_hi:[1,1]
    v_pk_mul_f32 v[42:43], s[80:81], v[114:115] op_sel:[1,0] op_sel_hi:[1,1]
    v_pk_mul_f32 v[44:45], s[80:81], v[116:117] op_sel:[1,0] op_sel_hi:[1,1]
    v_pk_mul_f32 v[46:47], s[80:81], v[118:119] op_sel:[1,0] op_sel_hi:[1,1]
    v_exp_f32 v40, v40
    v_exp_f32 v41, v41
    v_pk_mul_f32 v[120:121], v[112:113], v[120:121]
    v_exp_f32 v42, v42
    v_exp_f32 v43, v43
    v_pk_mul_f32 v[122:123], v[114:115], v[122:123]
    v_exp_f32 v44, v44
    v_exp_f32 v45, v45
    v_pk_mul_f32 v[124:125], v[116:117], v[124:125]
    v_exp_f32 v46, v46
    v_exp_f32 v47, v47
    v_pk_mul_f32 v[126:127], v[118:119], v[126:127]
    v_pk_add_f32 v[40:41], v[40:41], 1.0 op_sel_hi:[1,0]
    v_pk_add_f32 v[42:43], v[42:43], 1.0 op_sel_hi:[1,0]
    v_pk_add_f32 v[44:45], v[44:45], 1.0 op_sel_hi:[1,0]
    v_pk_add_f32 v[46:47], v[46:47], 1.0 op_sel_hi:[1,0]
    v_rcp_f32 v40, v40
    v_rcp_f32 v41, v41
    v_rcp_f32 v42, v42
    v_rcp_f32 v43, v43
    v_pk_mul_f32 v[120:121], v[120:121], v[40:41]
    v_rcp_f32 v44, v44
    v_rcp_f32 v45, v45
    v_pk_mul_f32 v[122:123], v[122:123], v[42:43]
    v_rcp_f32 v46, v46
    v_rcp_f32 v47, v47
    v_pk_mul_f32 v[124:125], v[124:125], v[44:45]
    v_pk_mul_f32 v[126:127], v[126:127], v[46:47]
    v_cvt_pk_bf16_f32 v112, v120, v121
    v_cvt_pk_bf16_f32 v113, v122, v123
    v_cvt_pk_bf16_f32 v114, v124, v125
    v_cvt_pk_bf16_f32 v115, v126, v127
    buffer_store_dwordx4 v[112:115], v23, s[68:71], s83 offen offset:1024 sc1
    s_waitcnt vmcnt(0)
    s_setprio 0
    s_barrier
    v_mov_b32 v1, s34
    v_mov_b32 v2, 0
    s_cmp_lg_u32 s4, 0
    s_cbranch_scc1 L_done_skip_44
    s_lshl_b32 s12, s6, 11
    s_lshl_b32 s13, s85, 7
    s_add_u32 s12, s12, s13
    s_add_u32 s12, s12, 14688256
    s_mov_b64 exec, 1
    buffer_store_dword v1, v2, s[68:71], s12 offen sc1
    s_mov_b64 exec, -1
L_done_skip_44:
    s_add_u32 m0, s94, 8192
    s_add_u32 s15, s95, 32768
    buffer_load_dwordx4 v6, s[72:75], s15 offen lds
    buffer_load_dwordx4 v7, s[72:75], s15 offen offset:1024 lds
    s_add_u32 s15, s15, 14336
    buffer_load_dwordx4 v6, s[72:75], s15 offen offset:2048 lds
    buffer_load_dwordx4 v7, s[72:75], s15 offen offset:3072 lds
    s_add_u32 m0, s94, 12288
    s_add_u32 s15, s95, 32768
    buffer_load_dwordx4 v6, s[56:59], s15 offen lds
    buffer_load_dwordx4 v7, s[56:59], s15 offen offset:1024 lds
    s_add_u32 s15, s15, 14336
    buffer_load_dwordx4 v6, s[56:59], s15 offen offset:2048 lds
    buffer_load_dwordx4 v7, s[56:59], s15 offen offset:3072 lds
    ds_read_b128 v[128:131], v8 offset:0
    v_xor_b32 v9, 16, v8
    ds_read_b128 v[136:139], v9 offset:0
    v_xor_b32 v9, 32, v8
    ds_read_b128 v[144:147], v9 offset:0
    v_xor_b32 v9, 48, v8
    ds_read_b128 v[152:155], v9 offset:0
    v_xor_b32 v9, 64, v8
    ds_read_b128 v[160:163], v9 offset:0
    v_xor_b32 v9, 80, v8
    ds_read_b128 v[168:171], v9 offset:0
    v_xor_b32 v9, 96, v8
    ds_read_b128 v[176:179], v9 offset:0
    v_xor_b32 v9, 112, v8
    ds_read_b128 v[184:187], v9 offset:0
    s_waitcnt lgkmcnt(0)
    s_add_u32 m0, s94, 0
    s_add_u32 s15, s95, 128
    buffer_load_dwordx4 v6, s[72:75], s15 offen lds
    buffer_load_dwordx4 v7, s[72:75], s15 offen offset:1024 lds
    s_add_u32 s15, s15, 14336
    buffer_load_dwordx4 v6, s[72:75], s15 offen offset:2048 lds
    buffer_load_dwordx4 v7, s[72:75], s15 offen offset:3072 lds
    s_add_u32 m0, s94, 4096
    s_add_u32 s15, s95, 128
    buffer_load_dwordx4 v6, s[56:59], s15 offen lds
    buffer_load_dwordx4 v7, s[56:59], s15 offen offset:1024 lds
    s_add_u32 s15, s15, 14336
    buffer_load_dwordx4 v6, s[56:59], s15 offen offset:2048 lds
    buffer_load_dwordx4 v7, s[56:59], s15 offen offset:3072 lds
    s_waitcnt vmcnt(8)
    ds_read_b128 v[132:135], v8 offset:8192
    v_xor_b32 v9, 16, v8
    ds_read_b128 v[140:143], v9 offset:8192
    v_xor_b32 v9, 32, v8
    ds_read_b128 v[148:151], v9 offset:8192
    v_xor_b32 v9, 48, v8
    ds_read_b128 v[156:159], v9 offset:8192
    v_xor_b32 v9, 64, v8
    ds_read_b128 v[164:167], v9 offset:8192
    v_xor_b32 v9, 80, v8
    ds_read_b128 v[172:175], v9 offset:8192
    v_xor_b32 v9, 96, v8
    ds_read_b128 v[180:183], v9 offset:8192
    v_xor_b32 v9, 112, v8
    ds_read_b128 v[188:191], v9 offset:8192
    s_waitcnt lgkmcnt(0)
    s_add_u32 m0, s94, 8192
    s_add_u32 s15, s95, 32896
    buffer_load_dwordx4 v6, s[72:75], s15 offen lds
    buffer_load_dwordx4 v7, s[72:75], s15 offen offset:1024 lds
    s_add_u32 s15, s15, 14336
    buffer_load_dwordx4 v6, s[72:75], s15 offen offset:2048 lds
    buffer_load_dwordx4 v7, s[72:75], s15 offen offset:3072 lds
    s_add_u32 m0, s94, 12288
    s_add_u32 s15, s95, 32896
    buffer_load_dwordx4 v6, s[56:59], s15 offen lds
    buffer_load_dwordx4 v7, s[56:59], s15 offen offset:1024 lds
    s_add_u32 s15, s15, 14336
    buffer_load_dwordx4 v6, s[56:59], s15 offen offset:2048 lds
    buffer_load_dwordx4 v7, s[56:59], s15 offen offset:3072 lds
    s_waitcnt vmcnt(8)
    ds_read_b128 v[192:195], v8 offset:0
    v_xor_b32 v9, 16, v8
    ds_read_b128 v[200:203], v9 offset:0
    v_xor_b32 v9, 32, v8
    ds_read_b128 v[208:211], v9 offset:0
    v_xor_b32 v9, 48, v8
    ds_read_b128 v[216:219], v9 offset:0
    v_xor_b32 v9, 64, v8
    ds_read_b128 v[224:227], v9 offset:0
    v_xor_b32 v9, 80, v8
    ds_read_b128 v[232:235], v9 offset:0
    v_xor_b32 v9, 96, v8
    ds_read_b128 v[240:243], v9 offset:0
    v_xor_b32 v9, 112, v8
    ds_read_b128 v[248:251], v9 offset:0
    s_waitcnt vmcnt(0)
    ds_read_b128 v[196:199], v8 offset:8192
    v_xor_b32 v9, 16, v8
    ds_read_b128 v[204:207], v9 offset:8192
    v_xor_b32 v9, 32, v8
    ds_read_b128 v[212:215], v9 offset:8192
    v_xor_b32 v9, 48, v8
    ds_read_b128 v[220:223], v9 offset:8192
    v_xor_b32 v9, 64, v8
    ds_read_b128 v[228:231], v9 offset:8192
    v_xor_b32 v9, 80, v8
    ds_read_b128 v[236:239], v9 offset:8192
    v_xor_b32 v9, 96, v8
    ds_read_b128 v[244:247], v9 offset:8192
    v_xor_b32 v9, 112, v8
    ds_read_b128 v[252:255], v9 offset:8192
    s_branch L_P2_0
L_body_X1:
    s_mov_b32 s60, s36
    s_and_b32 s61, s37, 0xffff
    s_mov_b32 s62, 1835008
    s_mov_b32 s63, 0x00020000
    s_mov_b32 s64, s38
    s_and_b32 s65, s39, 0xffff
    s_mov_b32 s66, 1835008
    s_mov_b32 s67, 0x00020000
    s_mov_b32 s68, s48
    s_and_b32 s69, s49, 0xffff
    s_mov_b32 s70, 14721024
    s_mov_b32 s71, 0x00020000
    s_mov_b32 s81, 0xbfb8aa3b
    s_barrier
    s_add_u32 m0, s78, 4096
    s_add_u32 s76, s1, 1
    s_and_b32 s76, s76, 7
    s_mul_i32 s76, s76, 128
    buffer_load_dwordx4 v1, s[52:55], s76 offen lds
    buffer_load_dwordx4 v2, s[52:55], s76 offen offset:1024 lds
    buffer_load_dwordx4 v3, s[52:55], s76 offen offset:2048 lds
    buffer_load_dwordx4 v4, s[52:55], s76 offen offset:3072 lds
    s_lshl_b32 s12, s6, 7
    s_lshl_b32 s13, s85, 3
    s_add_u32 s12, s12, s13
    s_add_u32 s12, s12, s3
    s_lshl_b32 s13, s12, 10
    s_lshl_b32 s87, s12, 2
    s_add_u32 s87, s87, 14417920
    v_add_u32 v239, s13, v23
    s_add_u32 s93, s11, s4
    s_lshl_b32 s93, s93, 13
    s_add_u32 s93, s93, 14442496
    s_lshl_b32 s12, s6, 8
    s_add_u32 s93, s93, s12
    s_mul_i32 s12, s4, 57344
    s_lshl_b32 s13, s10, 7
    s_add_u32 s12, s12, s13
    v_add_u32 v6, s12, v101
    v_add_u32 v7, 27648, v6
    v_xor_b32 v8, 64, v6
    v_xor_b32 v9, 64, v7
    v_bfe_u32 v102, v0, 1, 3
    v_xor_b32 v102, v102, v99
    v_lshlrev_b32 v102, 4, v102
    v_lshl_add_u32 v102, v100, 7, v102
    s_lshl_b32 s12, s4, 14
    v_add_u32 v10, s12, v102
    v_xor_b32 v11, 32, v10
    v_xor_b32 v12, 64, v10
    v_xor_b32 v13, 96, v10
    v_bfe_u32 v103, v0, 2, 2
    v_lshl_add_u32 v104, v99, 3, v103
    v_lshlrev_b32 v104, 7, v104
    v_and_b32 v107, 3, v0
    v_lshl_add_u32 v104, v107, 3, v104
    v_and_b32 v105, 1, v98
    v_lshrrev_b32 v106, 1, v103
    v_lshl_add_u32 v106, v105, 1, v106
    v_lshl_add_u32 v104, v106, 5, v104
    v_lshl_add_u32 v106, v105, 16, v104
    v_xor_b32 v21, 64, v106
    v_xor_b32 v22, 32, v21
    v_lshl_add_u32 v106, v105, 15, v104
    v_add_u32 v106, 65536, v106
    v_xor_b32 v18, 32, v106
    v_xor_b32 v19, 64, v106
    v_xor_b32 v20, 96, v106
    s_lshr_b32 s80, s3, 1
    s_lshl_b32 s80, s80, 14
    s_and_b32 s12, s3, 1
    s_lshl_b32 s12, s12, 11
    s_add_u32 s80, s80, s12
    s_lshl_b32 s94, s3, 14
    s_lshl_b32 s12, s6, 2
    s_add_u32 s12, s12, s4
    s_mul_i32 s12, s12, 180224
    s_lshl_b32 s13, s9, 12
    s_add_u32 s82, s12, s13
    s_lshl_b32 s13, s10, 12
    s_add_u32 s83, s12, s13
    s_lshl_b32 s13, s11, 11
    s_add_u32 s84, s12, s13
    s_add_u32 s84, s84, 114688
    s_mul_i32 s35, s50, 360448
    s_mul_i32 s12, s4, 28672
    s_add_u32 s35, s35, s12
    s_mul_i32 s95, s4, 458752
    s_lshl_b32 s12, s51, 7
    s_add_u32 s95, s95, s12
    s_mov_b32 s72, s40
    s_and_b32 s73, s41, 0xffff
    s_mov_b32 s74, 1835008
    s_mov_b32 s75, 0x00020000
    s_add_u32 m0, s78, 8192
    s_add_u32 s76, s1, 2
    s_and_b32 s76, s76, 7
    s_mul_i32 s76, s76, 128
    buffer_load_dwordx4 v1, s[52:55], s76 offen lds
    buffer_load_dwordx4 v2, s[52:55], s76 offen offset:1024 lds
    buffer_load_dwordx4 v3, s[52:55], s76 offen offset:2048 lds
    buffer_load_dwordx4 v4, s[52:55], s76 offen offset:3072 lds
    s_waitcnt vmcnt(8)
    s_barrier
    ds_read_b128 v[128:131], v10 offset:0
    ds_read_b64_tr_b16 v[24:25], v18 offset:0
    ds_read_b64_tr_b16 v[26:27], v18 offset:512
    ds_read_b64_tr_b16 v[28:29], v19 offset:0
    ds_read_b64_tr_b16 v[30:31], v19 offset:512
    ds_read_b64_tr_b16 v[32:33], v20 offset:0
    ds_read_b64_tr_b16 v[34:35], v20 offset:512
    s_waitcnt lgkmcnt(4)
    v_mfma_f32_32x32x16_bf16 v[48:63], v[24:27], v[128:131], 0
    ds_read_b128 v[132:135], v11 offset:0
    ds_read_b64_tr_b16 v[36:37], v18 offset:2048
    ds_read_b64_tr_b16 v[38:39], v18 offset:2560
    s_add_u32 m0, s78, 12288
    s_add_u32 s76, s1, 3
    s_and_b32 s76, s76, 7
    s_mul_i32 s76, s76, 128
    buffer_load_dwordx4 v1, s[52:55], s76 offen lds
    s_waitcnt lgkmcnt(5)
    v_mfma_f32_32x32x16_bf16 v[64:79], v[28:31], v[128:131], 0
    ds_read_b64_tr_b16 v[40:41], v19 offset:2048
    ds_read_b64_tr_b16 v[42:43], v19 offset:2560
    s_waitcnt lgkmcnt(5)
    v_mfma_f32_32x32x16_bf16 v[80:95], v[32:35], v[128:131], 0
    ds_read_b64_tr_b16 v[44:45], v20 offset:2048
    ds_read_b64_tr_b16 v[46:47], v20 offset:2560
    s_waitcnt lgkmcnt(4)
    v_mfma_f32_32x32x16_bf16 v[48:63], v[36:39], v[132:135], v[48:63]
    ds_read_b128 v[136:139], v12 offset:0
    ds_read_b64_tr_b16 v[24:25], v18 offset:16384
    ds_read_b64_tr_b16 v[26:27], v18 offset:16896
    buffer_load_dwordx4 v2, s[52:55], s76 offen offset:1024 lds
    s_waitcnt lgkmcnt(5)
    v_mfma_f32_32x32x16_bf16 v[64:79], v[40:43], v[132:135], v[64:79]
    ds_read_b64_tr_b16 v[28:29], v19 offset:16384
    ds_read_b64_tr_b16 v[30:31], v19 offset:16896
    s_waitcnt lgkmcnt(5)
    v_mfma_f32_32x32x16_bf16 v[80:95], v[44:47], v[132:135], v[80:95]
    ds_read_b64_tr_b16 v[32:33], v20 offset:16384
    ds_read_b64_tr_b16 v[34:35], v20 offset:16896
    s_waitcnt lgkmcnt(4)
    v_mfma_f32_32x32x16_bf16 v[48:63], v[24:27], v[136:139], v[48:63]
    ds_read_b128 v[140:143], v13 offset:0
    ds_read_b64_tr_b16 v[36:37], v18 offset:18432
    ds_read_b64_tr_b16 v[38:39], v18 offset:18944
    buffer_load_dwordx4 v3, s[52:55], s76 offen offset:2048 lds
    s_waitcnt lgkmcnt(5)
    v_mfma_f32_32x32x16_bf16 v[64:79], v[28:31], v[136:139], v[64:79]
    ds_read_b64_tr_b16 v[40:41], v19 offset:18432
    ds_read_b64_tr_b16 v[42:43], v19 offset:18944
    s_waitcnt lgkmcnt(5)
    v_mfma_f32_32x32x16_bf16 v[80:95], v[32:35], v[136:139], v[80:95]
    ds_read_b64_tr_b16 v[44:45], v20 offset:18432
    ds_read_b64_tr_b16 v[46:47], v20 offset:18944
    s_waitcnt vmcnt(7) lgkmcnt(0)
    s_barrier
    v_mfma_f32_32x32x16_bf16 v[48:63], v[36:39], v[140:143], v[48:63]
    ds_read_b128 v[144:147], v10 offset:4096
    ds_read_b64_tr_b16 v[24:25], v18 offset:4096
    ds_read_b64_tr_b16 v[26:27], v18 offset:4608
    buffer_load_dwordx4 v4, s[52:55], s76 offen offset:3072 lds
    v_mfma_f32_32x32x16_bf16 v[64:79], v[40:43], v[140:143], v[64:79]
    ds_read_b64_tr_b16 v[28:29], v19 offset:4096
    ds_read_b64_tr_b16 v[30:31], v19 offset:4608
    s_add_u32 m0, s78, 0
    s_add_u32 s76, s1, 4
    s_and_b32 s76, s76, 7
    s_mul_i32 s76, s76, 128
    buffer_load_dwordx4 v1, s[52:55], s76 offen lds
    v_mfma_f32_32x32x16_bf16 v[80:95], v[44:47], v[140:143], v[80:95]
    ds_read_b64_tr_b16 v[32:33], v20 offset:4096
    ds_read_b64_tr_b16 v[34:35], v20 offset:4608
    buffer_load_dwordx4 v2, s[52:55], s76 offen offset:1024 lds
    s_waitcnt lgkmcnt(4)
    v_mfma_f32_32x32x16_bf16 v[48:63], v[24:27], v[144:147], v[48:63]
    ds_read_b128 v[148:151], v11 offset:4096
    ds_read_b64_tr_b16 v[36:37], v18 offset:6144
    ds_read_b64_tr_b16 v[38:39], v18 offset:6656
    buffer_load_dwordx4 v3, s[52:55], s76 offen offset:2048 lds
    s_waitcnt lgkmcnt(5)
    v_mfma_f32_32x32x16_bf16 v[64:79], v[28:31], v[144:147], v[64:79]
    ds_read_b64_tr_b16 v[40:41], v19 offset:6144
    ds_read_b64_tr_b16 v[42:43], v19 offset:6656
    buffer_load_dwordx4 v4, s[52:55], s76 offen offset:3072 lds
    s_waitcnt lgkmcnt(5)
    v_mfma_f32_32x32x16_bf16 v[80:95], v[32:35], v[144:147], v[80:95]
    ds_read_b64_tr_b16 v[44:45], v20 offset:6144
    ds_read_b64_tr_b16 v[46:47], v20 offset:6656
    buffer_load_dwordx4 v[224:227], v239, s[52:55], 0 offen
    s_waitcnt lgkmcnt(4)
    v_mfma_f32_32x32x16_bf16 v[48:63], v[36:39], v[148:151], v[48:63]
    ds_read_b128 v[152:155], v12 offset:4096
    ds_read_b64_tr_b16 v[24:25], v18 offset:20480
    ds_read_b64_tr_b16 v[26:27], v18 offset:20992
    global_load_dwordx4 v[228:231], v23, s[42:43]
    s_waitcnt lgkmcnt(5)
    v_mfma_f32_32x32x16_bf16 v[64:79], v[40:43], v[148:151], v[64:79]
    ds_read_b64_tr_b16 v[28:29], v19 offset:20480
    ds_read_b64_tr_b16 v[30:31], v19 offset:20992
    s_waitcnt lgkmcnt(5)
    v_mfma_f32_32x32x16_bf16 v[80:95], v[44:47], v[148:151], v[80:95]
    ds_read_b64_tr_b16 v[32:33], v20 offset:20480
    ds_read_b64_tr_b16 v[34:35], v20 offset:20992
    s_waitcnt lgkmcnt(4)
    v_mfma_f32_32x32x16_bf16 v[48:63], v[24:27], v[152:155], v[48:63]
    ds_read_b128 v[156:159], v13 offset:4096
    ds_read_b64_tr_b16 v[36:37], v18 offset:22528
    ds_read_b64_tr_b16 v[38:39], v18 offset:23040
    s_waitcnt lgkmcnt(5)
    v_mfma_f32_32x32x16_bf16 v[64:79], v[28:31], v[152:155], v[64:79]
    ds_read_b64_tr_b16 v[40:41], v19 offset:22528
    ds_read_b64_tr_b16 v[42:43], v19 offset:23040
    s_waitcnt lgkmcnt(5)
    v_mfma_f32_32x32x16_bf16 v[80:95], v[32:35], v[152:155], v[80:95]
    ds_read_b64_tr_b16 v[44:45], v20 offset:22528
    ds_read_b64_tr_b16 v[46:47], v20 offset:23040
    s_waitcnt vmcnt(10) lgkmcnt(0)
    s_barrier
    v_mfma_f32_32x32x16_bf16 v[48:63], v[36:39], v[156:159], v[48:63]
    ds_read_b128 v[160:163], v10 offset:8192
    ds_read_b64_tr_b16 v[24:25], v18 offset:8192
    ds_read_b64_tr_b16 v[26:27], v18 offset:8704
    s_add_u32 m0, s78, 4096
    s_add_u32 s76, s1, 5
    s_and_b32 s76, s76, 7
    s_mul_i32 s76, s76, 128
    buffer_load_dwordx4 v1, s[52:55], s76 offen lds
    v_mfma_f32_32x32x16_bf16 v[64:79], v[40:43], v[156:159], v[64:79]
    ds_read_b64_tr_b16 v[28:29], v19 offset:8192
    ds_read_b64_tr_b16 v[30:31], v19 offset:8704
    v_mfma_f32_32x32x16_bf16 v[80:95], v[44:47], v[156:159], v[80:95]
    ds_read_b64_tr_b16 v[32:33], v20 offset:8192
    ds_read_b64_tr_b16 v[34:35], v20 offset:8704
    s_waitcnt lgkmcnt(4)
    v_mfma_f32_32x32x16_bf16 v[48:63], v[24:27], v[160:163], v[48:63]
    ds_read_b128 v[164:167], v11 offset:8192
    ds_read_b64_tr_b16 v[36:37], v18 offset:10240
    ds_read_b64_tr_b16 v[38:39], v18 offset:10752
    buffer_load_dwordx4 v2, s[52:55], s76 offen offset:1024 lds
    s_waitcnt lgkmcnt(5)
    v_mfma_f32_32x32x16_bf16 v[64:79], v[28:31], v[160:163], v[64:79]
    ds_read_b64_tr_b16 v[40:41], v19 offset:10240
    ds_read_b64_tr_b16 v[42:43], v19 offset:10752
    s_waitcnt lgkmcnt(5)
    v_mfma_f32_32x32x16_bf16 v[80:95], v[32:35], v[160:163], v[80:95]
    ds_read_b64_tr_b16 v[44:45], v20 offset:10240
    ds_read_b64_tr_b16 v[46:47], v20 offset:10752
    s_waitcnt lgkmcnt(4)
    v_mfma_f32_32x32x16_bf16 v[48:63], v[36:39], v[164:167], v[48:63]
    ds_read_b128 v[168:171], v12 offset:8192
    ds_read_b64_tr_b16 v[24:25], v18 offset:24576
    ds_read_b64_tr_b16 v[26:27], v18 offset:25088
    buffer_load_dwordx4 v3, s[52:55], s76 offen offset:2048 lds
    s_waitcnt lgkmcnt(5)
    v_mfma_f32_32x32x16_bf16 v[64:79], v[40:43], v[164:167], v[64:79]
    ds_read_b64_tr_b16 v[28:29], v19 offset:24576
    ds_read_b64_tr_b16 v[30:31], v19 offset:25088
    s_waitcnt lgkmcnt(5)
    v_mfma_f32_32x32x16_bf16 v[80:95], v[44:47], v[164:167], v[80:95]
    ds_read_b64_tr_b16 v[32:33], v20 offset:24576
    ds_read_b64_tr_b16 v[34:35], v20 offset:25088
    s_waitcnt lgkmcnt(4)
    v_mfma_f32_32x32x16_bf16 v[48:63], v[24:27], v[168:171], v[48:63]
    ds_read_b128 v[172:175], v13 offset:8192
    ds_read_b64_tr_b16 v[36:37], v18 offset:26624
    ds_read_b64_tr_b16 v[38:39], v18 offset:27136
    buffer_load_dwordx4 v4, s[52:55], s76 offen offset:3072 lds
    s_waitcnt vmcnt(4)
    v_lshlrev_b32 v96, 16, v224
    v_and_b32 v97, 0xffff0000, v224
    s_waitcnt lgkmcnt(5)
    v_mfma_f32_32x32x16_bf16 v[64:79], v[28:31], v[168:171], v[64:79]
    ds_read_b64_tr_b16 v[40:41], v19 offset:26624
    ds_read_b64_tr_b16 v[42:43], v19 offset:27136
    v_lshlrev_b32 v104, 16, v228
    v_and_b32 v105, 0xffff0000, v228
    s_waitcnt lgkmcnt(5)
    v_mfma_f32_32x32x16_bf16 v[80:95], v[32:35], v[168:171], v[80:95]
    ds_read_b64_tr_b16 v[44:45], v20 offset:26624
    ds_read_b64_tr_b16 v[46:47], v20 offset:27136
    v_lshlrev_b32 v98, 16, v225
    v_and_b32 v99, 0xffff0000, v225
    s_waitcnt lgkmcnt(0)
    s_barrier
    v_mfma_f32_32x32x16_bf16 v[48:63], v[36:39], v[172:175], v[48:63]
    ds_read_b128 v[176:179], v10 offset:12288
    ds_read_b64_tr_b16 v[24:25], v18 offset:12288
    ds_read_b64_tr_b16 v[26:27], v18 offset:12800
    s_add_u32 m0, s78, 8192
    s_add_u32 s76, s1, 6
    s_and_b32 s76, s76, 7
    s_mul_i32 s76, s76, 128
    buffer_load_dwordx4 v1, s[52:55], s76 offen lds
    v_lshlrev_b32 v106, 16, v229
    v_and_b32 v107, 0xffff0000, v229
    v_mfma_f32_32x32x16_bf16 v[64:79], v[40:43], v[172:175], v[64:79]
    ds_read_b64_tr_b16 v[28:29], v19 offset:12288
    ds_read_b64_tr_b16 v[30:31], v19 offset:12800
    v_lshlrev_b32 v100, 16, v226
    v_and_b32 v101, 0xffff0000, v226
    v_mfma_f32_32x32x16_bf16 v[80:95], v[44:47], v[172:175], v[80:95]
    ds_read_b64_tr_b16 v[32:33], v20 offset:12288
    ds_read_b64_tr_b16 v[34:35], v20 offset:12800
    v_lshlrev_b32 v108, 16, v230
    v_and_b32 v109, 0xffff0000, v230
    s_waitcnt lgkmcnt(4)
    v_mfma_f32_32x32x16_bf16 v[48:63], v[24:27], v[176:179], v[48:63]
    ds_read_b128 v[180:183], v11 offset:12288
    ds_read_b64_tr_b16 v[36:37], v18 offset:14336
    ds_read_b64_tr_b16 v[38:39], v18 offset:14848
    buffer_load_dwordx4 v2, s[52:55], s76 offen offset:1024 lds
    v_lshlrev_b32 v102, 16, v227
    v_and_b32 v103, 0xffff0000, v227
    s_waitcnt lgkmcnt(5)
    v_mfma_f32_32x32x16_bf16 v[64:79], v[28:31], v[176:179], v[64:79]
    ds_read_b64_tr_b16 v[40:41], v19 offset:14336
    ds_read_b64_tr_b16 v[42:43], v19 offset:14848
    v_lshlrev_b32 v110, 16, v231
    v_and_b32 v111, 0xffff0000, v231
    s_waitcnt lgkmcnt(5)
    v_mfma_f32_32x32x16_bf16 v[80:95], v[32:35], v[176:179], v[80:95]
    ds_read_b64_tr_b16 v[44:45], v20 offset:14336
    ds_read_b64_tr_b16 v[46:47], v20 offset:14848
    v_mul_f32 v96, v96, v104
    v_mul_f32 v97, v97, v105
    s_waitcnt lgkmcnt(4)
    v_mfma_f32_32x32x16_bf16 v[48:63], v[36:39], v[180:183], v[48:63]
    ds_read_b128 v[184:187], v12 offset:12288
    ds_read_b64_tr_b16 v[24:25], v18 offset:28672
    ds_read_b64_tr_b16 v[26:27], v18 offset:29184
    buffer_load_dwordx4 v3, s[52:55], s76 offen offset:2048 lds
    v_mul_f32 v98, v98, v106
    v_mul_f32 v99, v99, v107
    s_waitcnt lgkmcnt(5)
    v_mfma_f32_32x32x16_bf16 v[64:79], v[40:43], v[180:183], v[64:79]
    ds_read_b64_tr_b16 v[28:29], v19 offset:28672
    ds_read_b64_tr_b16 v[30:31], v19 offset:29184
    v_mul_f32 v100, v100, v108
    v_mul_f32 v101, v101, v109
    s_waitcnt lgkmcnt(5)
    v_mfma_f32_32x32x16_bf16 v[80:95], v[44:47], v[180:183], v[80:95]
    ds_read_b64_tr_b16 v[32:33], v20 offset:28672
    ds_read_b64_tr_b16 v[34:35], v20 offset:29184
    v_mul_f32 v102, v102, v110
    v_mul_f32 v103, v103, v111
    s_waitcnt lgkmcnt(4)
    v_mfma_f32_32x32x16_bf16 v[48:63], v[24:27], v[184:187], v[48:63]
    ds_read_b128 v[188:191], v13 offset:12288
    ds_read_b64_tr_b16 v[36:37], v18 offset:30720
    ds_read_b64_tr_b16 v[38:39], v18 offset:31232
    buffer_load_dwordx4 v4, s[52:55], s76 offen offset:3072 lds
    v_cvt_pk_bf16_f32 v104, v96, v97
    v_cvt_pk_bf16_f32 v105, v98, v99
    s_waitcnt lgkmcnt(5)
    v_mfma_f32_32x32x16_bf16 v[64:79], v[28:31], v[184:187], v[64:79]
    ds_read_b64_tr_b16 v[40:41], v19 offset:30720
    ds_read_b64_tr_b16 v[42:43], v19 offset:31232
    v_cvt_pk_bf16_f32 v106, v100, v101
    v_cvt_pk_bf16_f32 v107, v102, v103
    s_waitcnt lgkmcnt(5)
    v_mfma_f32_32x32x16_bf16 v[80:95], v[32:35], v[184:187], v[80:95]
    ds_read_b64_tr_b16 v[44:45], v20 offset:30720
    ds_read_b64_tr_b16 v[46:47], v20 offset:31232
    v_lshlrev_b32 v96, 16, v104
    v_and_b32 v97, 0xffff0000, v104
    s_waitcnt lgkmcnt(0)
    s_barrier
    v_mfma_f32_32x32x16_bf16 v[48:63], v[36:39], v[188:191], v[48:63]
    ds_read_b128 v[192:195], v10 offset:0
    ds_read_b64_tr_b16 v[24:25], v18 offset:0
    ds_read_b64_tr_b16 v[26:27], v18 offset:512
    s_add_u32 m0, s78, 12288
    s_add_u32 s76, s1, 7
    s_and_b32 s76, s76, 7
    s_mul_i32 s76, s76, 128
    buffer_load_dwordx4 v1, s[52:55], s76 offen lds
    v_lshlrev_b32 v98, 16, v105
    v_and_b32 v99, 0xffff0000, v105
    v_mfma_f32_32x32x16_bf16 v[64:79], v[40:43], v[188:191], v[64:79]
    ds_read_b64_tr_b16 v[28:29], v19 offset:0
    ds_read_b64_tr_b16 v[30:31], v19 offset:512
    v_lshlrev_b32 v100, 16, v106
    v_and_b32 v101, 0xffff0000, v106
    v_mfma_f32_32x32x16_bf16 v[80:95], v[44:47], v[188:191], v[80:95]
    ds_read_b64_tr_b16 v[32:33], v20 offset:0
    ds_read_b64_tr_b16 v[34:35], v20 offset:512
    v_lshlrev_b32 v102, 16, v107
    v_and_b32 v103, 0xffff0000, v107
    s_waitcnt lgkmcnt(4)
    v_mfma_f32_32x32x16_bf16 v[48:63], v[24:27], v[192:195], v[48:63]
    ds_read_b128 v[196:199], v11 offset:0
    ds_read_b64_tr_b16 v[36:37], v18 offset:2048
    ds_read_b64_tr_b16 v[38:39], v18 offset:2560
    buffer_load_dwordx4 v2, s[52:55], s76 offen offset:1024 lds
    v_add_f32 v96, v96, v100
    v_add_f32 v97, v97, v101
    s_waitcnt lgkmcnt(5)
    v_mfma_f32_32x32x16_bf16 v[64:79], v[28:31], v[192:195], v[64:79]
    ds_read_b64_tr_b16 v[40:41], v19 offset:2048
    ds_read_b64_tr_b16 v[42:43], v19 offset:2560
    v_add_f32 v98, v98, v102
    v_add_f32 v99, v99, v103
    s_waitcnt lgkmcnt(5)
    v_mfma_f32_32x32x16_bf16 v[80:95], v[32:35], v[192:195], v[80:95]
    ds_read_b64_tr_b16 v[44:45], v20 offset:2048
    ds_read_b64_tr_b16 v[46:47], v20 offset:2560
    v_add_f32 v96, v96, v98
    v_add_f32 v97, v97, v99
    s_waitcnt lgkmcnt(4)
    v_mfma_f32_32x32x16_bf16 v[48:63], v[36:39], v[196:199], v[48:63]
    ds_read_b128 v[200:203], v12 offset:0
    ds_read_b64_tr_b16 v[24:25], v18 offset:16384
    ds_read_b64_tr_b16 v[26:27], v18 offset:16896
    buffer_load_dwordx4 v3, s[52:55], s76 offen offset:2048 lds
    v_add_f32 v96, v96, v97
    s_nop 1
    v_add_f32_dpp v97, v96, v96 quad_perm:[1,0,3,2] row_mask:0xf bank_mask:0xf
    s_waitcnt lgkmcnt(5)
    v_mfma_f32_32x32x16_bf16 v[64:79], v[40:43], v[196:199], v[64:79]
    ds_read_b64_tr_b16 v[28:29], v19 offset:16384
    ds_read_b64_tr_b16 v[30:31], v19 offset:16896
    s_nop 1
    v_add_f32_dpp v96, v97, v97 quad_perm:[2,3,0,1] row_mask:0xf bank_mask:0xf
    s_nop 1
    v_add_f32_dpp v97, v96, v96 row_half_mirror row_mask:0xf bank_mask:0xf
    s_waitcnt lgkmcnt(5)
    v_mfma_f32_32x32x16_bf16 v[80:95], v[44:47], v[196:199], v[80:95]
    ds_read_b64_tr_b16 v[32:33], v20 offset:16384
    ds_read_b64_tr_b16 v[34:35], v20 offset:16896
    s_nop 1
    v_add_f32_dpp v96, v97, v97 row_mirror row_mask:0xf bank_mask:0xf
    s_nop 0
    v_readlane_b32 s12, v96, 16
    v_readlane_b32 s13, v96, 32
    v_readlane_b32 s14, v96, 48
    s_nop 1
    v_add_f32 v96, s12, v96
    v_mov_b32 v97, s13
    v_add_f32 v97, s14, v97
    s_waitcnt lgkmcnt(4)
    v_mfma_f32_32x32x16_bf16 v[48:63], v[24:27], v[200:203], v[48:63]
    ds_read_b128 v[204:207], v13 offset:0
    ds_read_b64_tr_b16 v[36:37], v18 offset:18432
    ds_read_b64_tr_b16 v[38:39], v18 offset:18944
    buffer_load_dwordx4 v4, s[52:55], s76 offen offset:3072 lds
    v_add_f32 v96, v96, v97
    v_cvt_pk_bf16_f32 v96, v96, v96
    s_waitcnt lgkmcnt(5)
    v_mfma_f32_32x32x16_bf16 v[64:79], v[28:31], v[200:203], v[64:79]
    ds_read_b64_tr_b16 v[40:41], v19 offset:18432
    ds_read_b64_tr_b16 v[42:43], v19 offset:18944
    v_lshlrev_b32 v96, 16, v96
    v_mul_f32 v96, s81, v96
    s_waitcnt lgkmcnt(5)
    v_mfma_f32_32x32x16_bf16 v[80:95], v[32:35], v[200:203], v[80:95]
    ds_read_b64_tr_b16 v[44:45], v20 offset:18432
    ds_read_b64_tr_b16 v[46:47], v20 offset:18944
    v_exp_f32 v96, v96
    s_lshl_b32 s12, s3, 2
    s_add_u32 s12, s12, 161856
    v_mov_b32 v97, s12
    s_waitcnt vmcnt(8) lgkmcnt(0)
    s_barrier
    v_mfma_f32_32x32x16_bf16 v[48:63], v[36:39], v[204:207], v[48:63]
    ds_read_b128 v[208:211], v10 offset:4096
    ds_read_b64_tr_b16 v[24:25], v18 offset:4096
    ds_read_b64_tr_b16 v[26:27], v18 offset:4608
    s_add_u32 m0, s80, 0
    s_add_u32 s77, s1, 1
    s_and_b32 s77, s77, 7
    s_mul_i32 s77, s77, 229376
    buffer_load_dwordx4 v6, s[60:63], s77 offen lds
    v_add_f32 v96, 1.0, v96
    v_rcp_f32 v96, v96
    v_mfma_f32_32x32x16_bf16 v[64:79], v[40:43], v[204:207], v[64:79]
    ds_read_b64_tr_b16 v[28:29], v19 offset:4096
    ds_read_b64_tr_b16 v[30:31], v19 offset:4608
    s_nop 0
    v_cvt_pk_bf16_f32 v96, v96, v96
    v_lshlrev_b32 v96, 16, v96
    v_mfma_f32_32x32x16_bf16 v[80:95], v[44:47], v[204:207], v[80:95]
    ds_read_b64_tr_b16 v[32:33], v20 offset:4096
    ds_read_b64_tr_b16 v[34:35], v20 offset:4608
    s_mov_b64 exec, 1
    ds_write_b32 v97, v96
    s_mov_b64 exec, -1
    s_waitcnt lgkmcnt(5)
    v_mfma_f32_32x32x16_bf16 v[48:63], v[24:27], v[208:211], v[48:63]
    ds_read_b128 v[212:215], v11 offset:4096
    ds_read_b64_tr_b16 v[36:37], v18 offset:6144
    ds_read_b64_tr_b16 v[38:39], v18 offset:6656
    buffer_load_dwordx4 v7, s[60:63], s77 offen offset:1024 lds
    s_waitcnt lgkmcnt(6)
    v_mfma_f32_32x32x16_bf16 v[64:79], v[28:31], v[208:211], v[64:79]
    ds_read_b64_tr_b16 v[40:41], v19 offset:6144
    ds_read_b64_tr_b16 v[42:43], v19 offset:6656
    s_waitcnt lgkmcnt(6)
    v_mfma_f32_32x32x16_bf16 v[80:95], v[32:35], v[208:211], v[80:95]
    ds_read_b64_tr_b16 v[44:45], v20 offset:6144
    ds_read_b64_tr_b16 v[46:47], v20 offset:6656
    v_mov_b32 v240, 161792
    ds_read_b32 v240, v240
    s_waitcnt lgkmcnt(5)
    v_mfma_f32_32x32x16_bf16 v[48:63], v[36:39], v[212:215], v[48:63]
    ds_read_b128 v[216:219], v12 offset:4096
    ds_read_b64_tr_b16 v[24:25], v18 offset:20480
    ds_read_b64_tr_b16 v[26:27], v18 offset:20992
    s_add_u32 m0, s80, 65536
    s_nop 0
    buffer_load_dwordx4 v8, s[64:67], s77 offen lds
    s_waitcnt lgkmcnt(6)
    v_mfma_f32_32x32x16_bf16 v[64:79], v[40:43], v[212:215], v[64:79]
    ds_read_b64_tr_b16 v[28:29], v19 offset:20480
    ds_read_b64_tr_b16 v[30:31], v19 offset:20992
    s_waitcnt lgkmcnt(6)
    v_mfma_f32_32x32x16_bf16 v[80:95], v[44:47], v[212:215], v[80:95]
    ds_read_b64_tr_b16 v[32:33], v20 offset:20480
    ds_read_b64_tr_b16 v[34:35], v20 offset:20992
    s_waitcnt lgkmcnt(7)
    v_readfirstlane_b32 s34, v240
    s_waitcnt lgkmcnt(4)
    v_mfma_f32_32x32x16_bf16 v[48:63], v[24:27], v[216:219], v[48:63]
    ds_read_b128 v[220:223], v13 offset:4096
    ds_read_b64_tr_b16 v[36:37], v18 offset:22528
    ds_read_b64_tr_b16 v[38:39], v18 offset:23040
    buffer_load_dwordx4 v9, s[64:67], s77 offen offset:1024 lds
    s_waitcnt lgkmcnt(5)
    v_mfma_f32_32x32x16_bf16 v[64:79], v[28:31], v[216:219], v[64:79]
    ds_read_b64_tr_b16 v[40:41], v19 offset:22528
    ds_read_b64_tr_b16 v[42:43], v19 offset:23040
    s_waitcnt lgkmcnt(5)
    v_mfma_f32_32x32x16_bf16 v[80:95], v[32:35], v[216:219], v[80:95]
    ds_read_b64_tr_b16 v[44:45], v20 offset:22528
    ds_read_b64_tr_b16 v[46:47], v20 offset:23040
    s_waitcnt vmcnt(8) lgkmcnt(0)
    s_barrier
    v_mfma_f32_32x32x16_bf16 v[48:63], v[36:39], v[220:223], v[48:63]
    ds_read_b128 v[224:227], v10 offset:8192
    ds_read_b64_tr_b16 v[24:25], v18 offset:8192
    ds_read_b64_tr_b16 v[26:27], v18 offset:8704
    s_add_u32 m0, s80, 4096
    s_add_u32 s77, s1, 3
    s_and_b32 s77, s77, 7
    s_mul_i32 s77, s77, 229376
    buffer_load_dwordx4 v6, s[60:63], s77 offen lds
    v_mfma_f32_32x32x16_bf16 v[64:79], v[40:43], v[220:223], v[64:79]
    ds_read_b64_tr_b16 v[28:29], v19 offset:8192
    ds_read_b64_tr_b16 v[30:31], v19 offset:8704
    v_mfma_f32_32x32x16_bf16 v[80:95], v[44:47], v[220:223], v[80:95]
    ds_read_b64_tr_b16 v[32:33], v20 offset:8192
    ds_read_b64_tr_b16 v[34:35], v20 offset:8704
    s_waitcnt lgkmcnt(4)
    v_mfma_f32_32x32x16_bf16 v[48:63], v[24:27], v[224:227], v[48:63]
    ds_read_b128 v[228:231], v11 offset:8192
    ds_read_b64_tr_b16 v[36:37], v18 offset:10240
    ds_read_b64_tr_b16 v[38:39], v18 offset:10752
    buffer_load_dwordx4 v7, s[60:63], s77 offen offset:1024 lds
    s_waitcnt lgkmcnt(5)
    v_mfma_f32_32x32x16_bf16 v[64:79], v[28:31], v[224:227], v[64:79]
    ds_read_b64_tr_b16 v[40:41], v19 offset:10240
    ds_read_b64_tr_b16 v[42:43], v19 offset:10752
    s_waitcnt lgkmcnt(5)
    v_mfma_f32_32x32x16_bf16 v[80:95], v[32:35], v[224:227], v[80:95]
    ds_read_b64_tr_b16 v[44:45], v20 offset:10240
    ds_read_b64_tr_b16 v[46:47], v20 offset:10752
    s_waitcnt lgkmcnt(4)
    v_mfma_f32_32x32x16_bf16 v[48:63], v[36:39], v[228:231], v[48:63]
    ds_read_b128 v[232:235], v12 offset:8192
    ds_read_b64_tr_b16 v[24:25], v18 offset:24576
    ds_read_b64_tr_b16 v[26:27], v18 offset:25088
    s_add_u32 m0, s80, 69632
    s_nop 0
    buffer_load_dwordx4 v8, s[64:67], s77 offen lds
    s_waitcnt lgkmcnt(5)
    v_mfma_f32_32x32x16_bf16 v[64:79], v[40:43], v[228:231], v[64:79]
    ds_read_b64_tr_b16 v[28:29], v19 offset:24576
    ds_read_b64_tr_b16 v[30:31], v19 offset:25088
    s_waitcnt lgkmcnt(5)
    v_mfma_f32_32x32x16_bf16 v[80:95], v[44:47], v[228:231], v[80:95]
    ds_read_b64_tr_b16 v[32:33], v20 offset:24576
    ds_read_b64_tr_b16 v[34:35], v20 offset:25088
    s_waitcnt lgkmcnt(4)
    v_mfma_f32_32x32x16_bf16 v[48:63], v[24:27], v[232:235], v[48:63]
    ds_read_b128 v[236:239], v13 offset:8192
    ds_read_b64_tr_b16 v[36:37], v18 offset:26624
    ds_read_b64_tr_b16 v[38:39], v18 offset:27136
    buffer_load_dwordx4 v9, s[64:67], s77 offen offset:1024 lds
    s_waitcnt lgkmcnt(5)
    v_mfma_f32_32x32x16_bf16 v[64:79], v[28:31], v[232:235], v[64:79]
    ds_read_b64_tr_b16 v[40:41], v19 offset:26624
    ds_read_b64_tr_b16 v[42:43], v19 offset:27136
    s_waitcnt lgkmcnt(5)
    v_mfma_f32_32x32x16_bf16 v[80:95], v[32:35], v[232:235], v[80:95]
    ds_read_b64_tr_b16 v[44:45], v20 offset:26624
    ds_read_b64_tr_b16 v[46:47], v20 offset:27136
    s_waitcnt vmcnt(8) lgkmcnt(0)
    s_barrier
    v_mfma_f32_32x32x16_bf16 v[48:63], v[36:39], v[236:239], v[48:63]
    ds_read_b128 v[240:243], v10 offset:12288
    ds_read_b64_tr_b16 v[24:25], v18 offset:12288
    ds_read_b64_tr_b16 v[26:27], v18 offset:12800
    s_add_u32 m0, s80, 8192
    s_add_u32 s77, s1, 5
    s_and_b32 s77, s77, 7
    s_mul_i32 s77, s77, 229376
    buffer_load_dwordx4 v6, s[60:63], s77 offen lds
    v_mfma_f32_32x32x16_bf16 v[64:79], v[40:43], v[236:239], v[64:79]
    ds_read_b64_tr_b16 v[28:29], v19 offset:12288
    ds_read_b64_tr_b16 v[30:31], v19 offset:12800
    v_mfma_f32_32x32x16_bf16 v[80:95], v[44:47], v[236:239], v[80:95]
    ds_read_b64_tr_b16 v[32:33], v20 offset:12288
    ds_read_b64_tr_b16 v[34:35], v20 offset:12800
    s_waitcnt lgkmcnt(4)
    v_mfma_f32_32x32x16_bf16 v[48:63], v[24:27], v[240:243], v[48:63]
    ds_read_b128 v[244:247], v11 offset:12288
    ds_read_b64_tr_b16 v[36:37], v18 offset:14336
    ds_read_b64_tr_b16 v[38:39], v18 offset:14848
    buffer_load_dwordx4 v7, s[60:63], s77 offen offset:1024 lds
    s_waitcnt lgkmcnt(5)
    v_mfma_f32_32x32x16_bf16 v[64:79], v[28:31], v[240:243], v[64:79]
    ds_read_b64_tr_b16 v[40:41], v19 offset:14336
    ds_read_b64_tr_b16 v[42:43], v19 offset:14848
    s_waitcnt lgkmcnt(5)
    v_mfma_f32_32x32x16_bf16 v[80:95], v[32:35], v[240:243], v[80:95]
    ds_read_b64_tr_b16 v[44:45], v20 offset:14336
    ds_read_b64_tr_b16 v[46:47], v20 offset:14848
    s_waitcnt lgkmcnt(4)
    v_mfma_f32_32x32x16_bf16 v[48:63], v[36:39], v[244:247], v[48:63]
    ds_read_b128 v[248:251], v12 offset:12288
    ds_read_b64_tr_b16 v[24:25], v18 offset:28672
    ds_read_b64_tr_b16 v[26:27], v18 offset:29184
    s_add_u32 m0, s80, 73728
    s_nop 0
    buffer_load_dwordx4 v8, s[64:67], s77 offen lds
    s_waitcnt lgkmcnt(5)
    v_mfma_f32_32x32x16_bf16 v[64:79], v[40:43], v[244:247], v[64:79]
    ds_read_b64_tr_b16 v[28:29], v19 offset:28672
    ds_read_b64_tr_b16 v[30:31], v19 offset:29184
    s_waitcnt lgkmcnt(5)
    v_mfma_f32_32x32x16_bf16 v[80:95], v[44:47], v[244:247], v[80:95]
    ds_read_b64_tr_b16 v[32:33], v20 offset:28672
    ds_read_b64_tr_b16 v[34:35], v20 offset:29184
    s_waitcnt lgkmcnt(4)
    v_mfma_f32_32x32x16_bf16 v[48:63], v[24:27], v[248:251], v[48:63]
    ds_read_b128 v[252:255], v13 offset:12288
    ds_read_b64_tr_b16 v[36:37], v18 offset:30720
    ds_read_b64_tr_b16 v[38:39], v18 offset:31232
    buffer_load_dwordx4 v9, s[64:67], s77 offen offset:1024 lds
    s_waitcnt lgkmcnt(5)
    v_mfma_f32_32x32x16_bf16 v[64:79], v[28:31], v[248:251], v[64:79]
    ds_read_b64_tr_b16 v[40:41], v19 offset:30720
    ds_read_b64_tr_b16 v[42:43], v19 offset:31232
    s_waitcnt lgkmcnt(5)
    v_mfma_f32_32x32x16_bf16 v[80:95], v[32:35], v[248:251], v[80:95]
    ds_read_b64_tr_b16 v[44:45], v20 offset:30720
    ds_read_b64_tr_b16 v[46:47], v20 offset:31232
    s_waitcnt vmcnt(8) lgkmcnt(0)
    s_barrier
    v_mfma_f32_32x32x16_bf16 v[48:63], v[36:39], v[252:255], v[48:63]
    ds_read_b64_tr_b16 v[24:25], v21 offset:0
    ds_read_b64_tr_b16 v[26:27], v21 offset:512
    s_add_u32 m0, s80, 12288
    s_add_u32 s77, s1, 7
    s_and_b32 s77, s77, 7
    s_mul_i32 s77, s77, 229376
    buffer_load_dwordx4 v6, s[60:63], s77 offen lds
    v_mfma_f32_32x32x16_bf16 v[64:79], v[40:43], v[252:255], v[64:79]
    ds_read_b64_tr_b16 v[28:29], v22 offset:0
    ds_read_b64_tr_b16 v[30:31], v22 offset:512
    v_mfma_f32_32x32x16_bf16 v[80:95], v[44:47], v[252:255], v[80:95]
    s_setprio 0
    s_waitcnt lgkmcnt(2)
    v_mfma_f32_32x32x16_bf16 v[96:111], v[24:27], v[128:131], 0
    ds_read_b64_tr_b16 v[32:33], v21 offset:2048
    ds_read_b64_tr_b16 v[34:35], v21 offset:2560
    buffer_load_dwordx4 v7, s[60:63], s77 offen offset:1024 lds
    s_waitcnt lgkmcnt(2)
    v_mfma_f32_32x32x16_bf16 v[112:127], v[28:31], v[128:131], 0
    ds_read_b64_tr_b16 v[36:37], v22 offset:2048
    ds_read_b64_tr_b16 v[38:39], v22 offset:2560
    s_waitcnt lgkmcnt(2)
    v_mfma_f32_32x32x16_bf16 v[96:111], v[32:35], v[132:135], v[96:111]
    ds_read_b64_tr_b16 v[24:25], v21 offset:16384
    ds_read_b64_tr_b16 v[26:27], v21 offset:16896
    s_add_u32 m0, s80, 77824
    s_nop 0
    buffer_load_dwordx4 v8, s[64:67], s77 offen lds
    s_waitcnt lgkmcnt(2)
    v_mfma_f32_32x32x16_bf16 v[112:127], v[36:39], v[132:135], v[112:127]
    ds_read_b64_tr_b16 v[28:29], v22 offset:16384
    ds_read_b64_tr_b16 v[30:31], v22 offset:16896
    s_waitcnt lgkmcnt(0)
    s_barrier
    v_mfma_f32_32x32x16_bf16 v[96:111], v[24:27], v[136:139], v[96:111]
    ds_read_b64_tr_b16 v[32:33], v21 offset:18432
    ds_read_b64_tr_b16 v[34:35], v21 offset:18944
    buffer_load_dwordx4 v9, s[64:67], s77 offen offset:1024 lds
    v_pk_mul_f32 v[40:41], s[80:81], v[48:49] op_sel:[1,0] op_sel_hi:[1,1]
    v_pk_mul_f32 v[42:43], s[80:81], v[50:51] op_sel:[1,0] op_sel_hi:[1,1]
    v_pk_mul_f32 v[44:45], s[80:81], v[52:53] op_sel:[1,0] op_sel_hi:[1,1]
    v_pk_mul_f32 v[46:47], s[80:81], v[54:55] op_sel:[1,0] op_sel_hi:[1,1]
    v_exp_f32 v40, v40
    v_exp_f32 v41, v41
    v_mfma_f32_32x32x16_bf16 v[112:127], v[28:31], v[136:139], v[112:127]
    ds_read_b64_tr_b16 v[36:37], v22 offset:18432
    ds_read_b64_tr_b16 v[38:39], v22 offset:18944
    v_pk_mul_f32 v[56:57], v[48:49], v[56:57]
    v_exp_f32 v42, v42
    v_exp_f32 v43, v43
    v_pk_mul_f32 v[58:59], v[50:51], v[58:59]
    v_exp_f32 v44, v44
    v_exp_f32 v45, v45
    s_waitcnt lgkmcnt(2)
    v_mfma_f32_32x32x16_bf16 v[96:111], v[32:35], v[140:143], v[96:111]
    ds_read_b64_tr_b16 v[24:25], v21 offset:32768
    ds_read_b64_tr_b16 v[26:27], v21 offset:33280
    v_pk_mul_f32 v[60:61], v[52:53], v[60:61]
    v_exp_f32 v46, v46
    v_exp_f32 v47, v47
    v_pk_mul_f32 v[62:63], v[54:55], v[62:63]
    v_pk_add_f32 v[40:41], v[40:41], 1.0 op_sel_hi:[1,0]
    v_pk_add_f32 v[42:43], v[42:43], 1.0 op_sel_hi:[1,0]
    s_waitcnt lgkmcnt(2)
    v_mfma_f32_32x32x16_bf16 v[112:127], v[36:39], v[140:143], v[112:127]
    ds_read_b64_tr_b16 v[28:29], v22 offset:32768
    ds_read_b64_tr_b16 v[30:31], v22 offset:33280
    v_pk_add_f32 v[44:45], v[44:45], 1.0 op_sel_hi:[1,0]
    v_pk_add_f32 v[46:47], v[46:47], 1.0 op_sel_hi:[1,0]
    v_rcp_f32 v40, v40
    v_rcp_f32 v41, v41
    v_rcp_f32 v42, v42
    v_rcp_f32 v43, v43
    v_lshrrev_b32 v6, 3, v0
    v_bfe_u32 v7, v0, 4, 1
    v_lshlrev_b32 v7, 2, v7
    v_and_b32 v8, 7, v0
    v_xor_b32 v7, v7, v8
    v_lshlrev_b32 v7, 4, v7
    v_lshl_add_u32 v6, v6, 10, v7
    v_add_u32 v7, 7168, v6
    v_bfe_u32 v9, v0, 2, 2
    v_lshrrev_b32 v8, 5, v0
    v_lshl_add_u32 v8, v8, 2, v9
    v_lshlrev_b32 v8, 7, v8
    v_lshrrev_b32 v9, 1, v9
    v_lshl_add_u32 v8, v9, 6, v8
    v_bfe_u32 v9, v0, 4, 1
    v_lshl_add_u32 v8, v9, 5, v8
    v_and_b32 v9, 3, v0
    v_lshl_add_u32 v8, v9, 3, v8
    v_add_u32 v8, s94, v8
    v_xor_b32 v9, 64, v8
    s_and_b32 s15, s50, 7
    s_lshl_b32 s15, s15, 10
    s_add_u32 s15, s15, s95
    s_sub_u32 s14, 3, s8
    s_lshl_b32 s14, s14, 7
    s_add_u32 s14, s14, s15
    v_mul_u32_u24 v128, 3, v0
    v_add_u32 v128, s8, v128
    v_min_u32 v128, 55, v128
    v_lshlrev_b32 v128, 13, v128
    buffer_load_dword v129, v128, s[72:75], s14 offen
    v_min_u32 v128, 55, v0
    v_lshlrev_b32 v128, 13, v128
    buffer_load_dword v129, v128, s[72:75], s15 offen
    s_waitcnt lgkmcnt(2)
    v_mfma_f32_32x32x16_bf16 v[96:111], v[24:27], v[144:147], v[96:111]
    ds_read_b64_tr_b16 v[32:33], v21 offset:34816
    ds_read_b64_tr_b16 v[34:35], v21 offset:35328
    v_pk_mul_f32 v[56:57], v[56:57], v[40:41]
    v_rcp_f32 v44, v44
    v_rcp_f32 v45, v45
    v_pk_mul_f32 v[58:59], v[58:59], v[42:43]
    v_rcp_f32 v46, v46
    v_rcp_f32 v47, v47
    s_waitcnt lgkmcnt(2)
    v_mfma_f32_32x32x16_bf16 v[112:127], v[28:31], v[144:147], v[112:127]
    ds_read_b64_tr_b16 v[36:37], v22 offset:34816
    ds_read_b64_tr_b16 v[38:39], v22 offset:35328
    v_pk_mul_f32 v[60:61], v[60:61], v[44:45]
    v_pk_mul_f32 v[62:63], v[62:63], v[46:47]
    v_cvt_pk_bf16_f32 v48, v56, v57
    v_cvt_pk_bf16_f32 v49, v58, v59
    v_cvt_pk_bf16_f32 v50, v60, v61
    v_cvt_pk_bf16_f32 v51, v62, v63
    s_waitcnt lgkmcnt(2)
    v_mfma_f32_32x32x16_bf16 v[96:111], v[32:35], v[148:151], v[96:111]
    ds_read_b64_tr_b16 v[24:25], v21 offset:49152
    ds_read_b64_tr_b16 v[26:27], v21 offset:49664
    v_pk_mul_f32 v[40:41], s[80:81], v[64:65] op_sel:[1,0] op_sel_hi:[1,1]
    v_pk_mul_f32 v[42:43], s[80:81], v[66:67] op_sel:[1,0] op_sel_hi:[1,1]
    v_pk_mul_f32 v[44:45], s[80:81], v[68:69] op_sel:[1,0] op_sel_hi:[1,1]
    v_pk_mul_f32 v[46:47], s[80:81], v[70:71] op_sel:[1,0] op_sel_hi:[1,1]
    v_exp_f32 v40, v40
    v_exp_f32 v41, v41
    s_waitcnt lgkmcnt(2)
    v_mfma_f32_32x32x16_bf16 v[112:127], v[36:39], v[148:151], v[112:127]
    ds_read_b64_tr_b16 v[28:29], v22 offset:49152
    ds_read_b64_tr_b16 v[30:31], v22 offset:49664
    v_pk_mul_f32 v[72:73], v[64:65], v[72:73]
    v_exp_f32 v42, v42
    v_exp_f32 v43, v43
    v_pk_mul_f32 v[74:75], v[66:67], v[74:75]
    v_exp_f32 v44, v44
    v_exp_f32 v45, v45
    s_waitcnt lgkmcnt(2)
    v_mfma_f32_32x32x16_bf16 v[96:111], v[24:27], v[152:155], v[96:111]
    ds_read_b64_tr_b16 v[32:33], v21 offset:51200
    ds_read_b64_tr_b16 v[34:35], v21 offset:51712
    v_pk_mul_f32 v[76:77], v[68:69], v[76:77]
    v_exp_f32 v46, v46
    v_exp_f32 v47, v47
    v_pk_mul_f32 v[78:79], v[70:71], v[78:79]
    v_pk_add_f32 v[40:41], v[40:41], 1.0 op_sel_hi:[1,0]
    v_pk_add_f32 v[42:43], v[42:43], 1.0 op_sel_hi:[1,0]
    s_waitcnt lgkmcnt(2)
    v_mfma_f32_32x32x16_bf16 v[112:127], v[28:31], v[152:155], v[112:127]
    ds_read_b64_tr_b16 v[36:37], v22 offset:51200
    ds_read_b64_tr_b16 v[38:39], v22 offset:51712
    v_pk_add_f32 v[44:45], v[44:45], 1.0 op_sel_hi:[1,0]
    v_pk_add_f32 v[46:47], v[46:47], 1.0 op_sel_hi:[1,0]
    v_rcp_f32 v40, v40
    v_rcp_f32 v41, v41
    v_rcp_f32 v42, v42
    v_rcp_f32 v43, v43
    s_waitcnt vmcnt(10) lgkmcnt(0)
    s_barrier
    v_mfma_f32_32x32x16_bf16 v[96:111], v[32:35], v[156:159], v[96:111]
    ds_read_b64_tr_b16 v[24:25], v21 offset:4096
    ds_read_b64_tr_b16 v[26:27], v21 offset:4608
    v_pk_mul_f32 v[72:73], v[72:73], v[40:41]
    v_rcp_f32 v44, v44
    v_rcp_f32 v45, v45
    v_pk_mul_f32 v[74:75], v[74:75], v[42:43]
    v_rcp_f32 v46, v46
    v_rcp_f32 v47, v47
    v_mfma_f32_32x32x16_bf16 v[112:127], v[36:39], v[156:159], v[112:127]
    ds_read_b64_tr_b16 v[28:29], v22 offset:4096
    ds_read_b64_tr_b16 v[30:31], v22 offset:4608
    v_pk_mul_f32 v[76:77], v[76:77], v[44:45]
    v_pk_mul_f32 v[78:79], v[78:79], v[46:47]
    v_cvt_pk_bf16_f32 v64, v72, v73
    v_cvt_pk_bf16_f32 v65, v74, v75
    v_cvt_pk_bf16_f32 v66, v76, v77
    v_cvt_pk_bf16_f32 v67, v78, v79
    s_waitcnt lgkmcnt(2)
    v_mfma_f32_32x32x16_bf16 v[96:111], v[24:27], v[160:163], v[96:111]
    ds_read_b64_tr_b16 v[32:33], v21 offset:6144
    ds_read_b64_tr_b16 v[34:35], v21 offset:6656
    v_pk_mul_f32 v[40:41], s[80:81], v[80:81] op_sel:[1,0] op_sel_hi:[1,1]
    v_pk_mul_f32 v[42:43], s[80:81], v[82:83] op_sel:[1,0] op_sel_hi:[1,1]
    v_pk_mul_f32 v[44:45], s[80:81], v[84:85] op_sel:[1,0] op_sel_hi:[1,1]
    v_pk_mul_f32 v[46:47], s[80:81], v[86:87] op_sel:[1,0] op_sel_hi:[1,1]
    v_exp_f32 v40, v40
    v_exp_f32 v41, v41
    s_waitcnt lgkmcnt(2)
    v_mfma_f32_32x32x16_bf16 v[112:127], v[28:31], v[160:163], v[112:127]
    ds_read_b64_tr_b16 v[36:37], v22 offset:6144
    ds_read_b64_tr_b16 v[38:39], v22 offset:6656
    v_pk_mul_f32 v[88:89], v[80:81], v[88:89]
    v_exp_f32 v42, v42
    v_exp_f32 v43, v43
    v_pk_mul_f32 v[90:91], v[82:83], v[90:91]
    v_exp_f32 v44, v44
    v_exp_f32 v45, v45
    s_waitcnt lgkmcnt(2)
    v_mfma_f32_32x32x16_bf16 v[96:111], v[32:35], v[164:167], v[96:111]
    ds_read_b64_tr_b16 v[24:25], v21 offset:20480
    ds_read_b64_tr_b16 v[26:27], v21 offset:20992
    v_pk_mul_f32 v[92:93], v[84:85], v[92:93]
    v_exp_f32 v46, v46
    v_exp_f32 v47, v47
    v_pk_mul_f32 v[94:95], v[86:87], v[94:95]
    v_pk_add_f32 v[40:41], v[40:41], 1.0 op_sel_hi:[1,0]
    v_pk_add_f32 v[42:43], v[42:43], 1.0 op_sel_hi:[1,0]
    s_waitcnt lgkmcnt(2)
    v_mfma_f32_32x32x16_bf16 v[112:127], v[36:39], v[164:167], v[112:127]
    ds_read_b64_tr_b16 v[28:29], v22 offset:20480
    ds_read_b64_tr_b16 v[30:31], v22 offset:20992
    v_pk_add_f32 v[44:45], v[44:45], 1.0 op_sel_hi:[1,0]
    v_pk_add_f32 v[46:47], v[46:47], 1.0 op_sel_hi:[1,0]
    v_rcp_f32 v40, v40
    v_rcp_f32 v41, v41
    v_rcp_f32 v42, v42
    v_rcp_f32 v43, v43
    s_waitcnt lgkmcnt(2)
    v_mfma_f32_32x32x16_bf16 v[96:111], v[24:27], v[168:171], v[96:111]
    ds_read_b64_tr_b16 v[32:33], v21 offset:22528
    ds_read_b64_tr_b16 v[34:35], v21 offset:23040
    v_pk_mul_f32 v[88:89], v[88:89], v[40:41]
    v_rcp_f32 v44, v44
    v_rcp_f32 v45, v45
    v_pk_mul_f32 v[90:91], v[90:91], v[42:43]
    v_rcp_f32 v46, v46
    v_rcp_f32 v47, v47
    s_waitcnt lgkmcnt(2)
    v_mfma_f32_32x32x16_bf16 v[112:127], v[28:31], v[168:171], v[112:127]
    ds_read_b64_tr_b16 v[36:37], v22 offset:22528
    ds_read_b64_tr_b16 v[38:39], v22 offset:23040
    v_pk_mul_f32 v[92:93], v[92:93], v[44:45]
    v_pk_mul_f32 v[94:95], v[94:95], v[46:47]
    v_cvt_pk_bf16_f32 v80, v88, v89
    v_cvt_pk_bf16_f32 v81, v90, v91
    v_cvt_pk_bf16_f32 v82, v92, v93
    v_cvt_pk_bf16_f32 v83, v94, v95
    s_waitcnt lgkmcnt(2)
    v_mfma_f32_32x32x16_bf16 v[96:111], v[32:35], v[172:175], v[96:111]
    ds_read_b64_tr_b16 v[24:25], v21 offset:36864
    ds_read_b64_tr_b16 v[26:27], v21 offset:37376
    s_waitcnt lgkmcnt(2)
    v_mfma_f32_32x32x16_bf16 v[112:127], v[36:39], v[172:175], v[112:127]
    ds_read_b64_tr_b16 v[28:29], v22 offset:36864
    ds_read_b64_tr_b16 v[30:31], v22 offset:37376
    s_waitcnt lgkmcnt(2)
    v_mfma_f32_32x32x16_bf16 v[96:111], v[24:27], v[176:179], v[96:111]
    ds_read_b64_tr_b16 v[32:33], v21 offset:38912
    ds_read_b64_tr_b16 v[34:35], v21 offset:39424
    s_waitcnt lgkmcnt(2)
    v_mfma_f32_32x32x16_bf16 v[112:127], v[28:31], v[176:179], v[112:127]
    ds_read_b64_tr_b16 v[36:37], v22 offset:38912
    ds_read_b64_tr_b16 v[38:39], v22 offset:39424
    s_waitcnt lgkmcnt(2)
    v_mfma_f32_32x32x16_bf16 v[96:111], v[32:35], v[180:183], v[96:111]
    ds_read_b64_tr_b16 v[24:25], v21 offset:53248
    ds_read_b64_tr_b16 v[26:27], v21 offset:53760
    s_waitcnt lgkmcnt(2)
    v_mfma_f32_32x32x16_bf16 v[112:127], v[36:39], v[180:183], v[112:127]
    ds_read_b64_tr_b16 v[28:29], v22 offset:53248
    ds_read_b64_tr_b16 v[30:31], v22 offset:53760
    s_waitcnt lgkmcnt(2)
    v_mfma_f32_32x32x16_bf16 v[96:111], v[24:27], v[184:187], v[96:111]
    ds_read_b64_tr_b16 v[32:33], v21 offset:55296
    ds_read_b64_tr_b16 v[34:35], v21 offset:55808
    s_waitcnt lgkmcnt(2)
    v_mfma_f32_32x32x16_bf16 v[112:127], v[28:31], v[184:187], v[112:127]
    ds_read_b64_tr_b16 v[36:37], v22 offset:55296
    ds_read_b64_tr_b16 v[38:39], v22 offset:55808
    s_waitcnt vmcnt(6) lgkmcnt(0)
    s_barrier
    v_mfma_f32_32x32x16_bf16 v[96:111], v[32:35], v[188:191], v[96:111]
    ds_read_b64_tr_b16 v[24:25], v21 offset:8192
    ds_read_b64_tr_b16 v[26:27], v21 offset:8704
    v_mfma_f32_32x32x16_bf16 v[112:127], v[36:39], v[188:191], v[112:127]
    ds_read_b64_tr_b16 v[28:29], v22 offset:8192
    ds_read_b64_tr_b16 v[30:31], v22 offset:8704
    s_waitcnt lgkmcnt(2)
    v_mfma_f32_32x32x16_bf16 v[96:111], v[24:27], v[192:195], v[96:111]
    ds_read_b64_tr_b16 v[32:33], v21 offset:10240
    ds_read_b64_tr_b16 v[34:35], v21 offset:10752
    s_waitcnt lgkmcnt(2)
    v_mfma_f32_32x32x16_bf16 v[112:127], v[28:31], v[192:195], v[112:127]
    ds_read_b64_tr_b16 v[36:37], v22 offset:10240
    ds_read_b64_tr_b16 v[38:39], v22 offset:10752
    s_waitcnt lgkmcnt(2)
    v_mfma_f32_32x32x16_bf16 v[96:111], v[32:35], v[196:199], v[96:111]
    ds_read_b64_tr_b16 v[24:25], v21 offset:24576
    ds_read_b64_tr_b16 v[26:27], v21 offset:25088
    s_waitcnt lgkmcnt(2)
    v_mfma_f32_32x32x16_bf16 v[112:127], v[36:39], v[196:199], v[112:127]
    ds_read_b64_tr_b16 v[28:29], v22 offset:24576
    ds_read_b64_tr_b16 v[30:31], v22 offset:25088
    s_add_u32 m0, s94, 0
    s_add_u32 s15, s95, 0
    buffer_load_dwordx4 v6, s[72:75], s15 offen lds
    buffer_load_dwordx4 v7, s[72:75], s15 offen offset:1024 lds
    s_waitcnt lgkmcnt(2)
    v_mfma_f32_32x32x16_bf16 v[96:111], v[24:27], v[200:203], v[96:111]
    ds_read_b64_tr_b16 v[32:33], v21 offset:26624
    ds_read_b64_tr_b16 v[34:35], v21 offset:27136
    s_waitcnt lgkmcnt(2)
    v_mfma_f32_32x32x16_bf16 v[112:127], v[28:31], v[200:203], v[112:127]
    ds_read_b64_tr_b16 v[36:37], v22 offset:26624
    ds_read_b64_tr_b16 v[38:39], v22 offset:27136
    buffer_store_dwordx4 v[48:51], v23, s[68:71], s82 offen offset:1024 sc1
    s_add_u32 m0, s94, 2048
    s_add_u32 s15, s95, 16384
    buffer_load_dwordx4 v6, s[72:75], s15 offen lds
    buffer_load_dwordx4 v7, s[72:75], s15 offen offset:1024 lds
    s_waitcnt lgkmcnt(2)
    v_mfma_f32_32x32x16_bf16 v[96:111], v[32:35], v[204:207], v[96:111]
    ds_read_b64_tr_b16 v[24:25], v21 offset:40960
    ds_read_b64_tr_b16 v[26:27], v21 offset:41472
    s_waitcnt lgkmcnt(2)
    v_mfma_f32_32x32x16_bf16 v[112:127], v[36:39], v[204:207], v[112:127]
    ds_read_b64_tr_b16 v[28:29], v22 offset:40960
    ds_read_b64_tr_b16 v[30:31], v22 offset:41472
    buffer_store_dwordx4 v[64:67], v23, s[68:71], s82 offen offset:2048 sc1
    s_add_u32 m0, s94, 4096
    s_add_u32 s15, s95, 32768
    buffer_load_dwordx4 v6, s[72:75], s15 offen lds
    buffer_load_dwordx4 v7, s[72:75], s15 offen offset:1024 lds
    s_barrier
    s_waitcnt lgkmcnt(2)
    v_mfma_f32_32x32x16_bf16 v[96:111], v[24:27], v[208:211], v[96:111]
    ds_read_b64_tr_b16 v[32:33], v21 offset:43008
    ds_read_b64_tr_b16 v[34:35], v21 offset:43520
    s_waitcnt lgkmcnt(2)
    v_mfma_f32_32x32x16_bf16 v[112:127], v[28:31], v[208:211], v[112:127]
    ds_read_b64_tr_b16 v[36:37], v22 offset:43008
    ds_read_b64_tr_b16 v[38:39], v22 offset:43520
    buffer_store_dwordx4 v[80:83], v23, s[68:71], s82 offen offset:3072 sc1
    s_add_u32 m0, s94, 6144
    s_add_u32 s15, s95, 49152
    buffer_load_dwordx4 v6, s[72:75], s15 offen lds
    buffer_load_dwordx4 v7, s[72:75], s15 offen offset:1024 lds
    s_waitcnt lgkmcnt(2)
    v_mfma_f32_32x32x16_bf16 v[96:111], v[32:35], v[212:215], v[96:111]
    ds_read_b64_tr_b16 v[24:25], v21 offset:57344
    ds_read_b64_tr_b16 v[26:27], v21 offset:57856
    s_waitcnt lgkmcnt(2)
    v_mfma_f32_32x32x16_bf16 v[112:127], v[36:39], v[212:215], v[112:127]
    ds_read_b64_tr_b16 v[28:29], v22 offset:57344
    ds_read_b64_tr_b16 v[30:31], v22 offset:57856
    s_waitcnt lgkmcnt(2)
    v_mfma_f32_32x32x16_bf16 v[96:111], v[24:27], v[216:219], v[96:111]
    ds_read_b64_tr_b16 v[32:33], v21 offset:59392
    ds_read_b64_tr_b16 v[34:35], v21 offset:59904
    s_waitcnt lgkmcnt(2)
    v_mfma_f32_32x32x16_bf16 v[112:127], v[28:31], v[216:219], v[112:127]
    ds_read_b64_tr_b16 v[36:37], v22 offset:59392
    ds_read_b64_tr_b16 v[38:39], v22 offset:59904
    s_waitcnt vmcnt(13) lgkmcnt(0)
    s_barrier
    v_mfma_f32_32x32x16_bf16 v[96:111], v[32:35], v[220:223], v[96:111]
    ds_read_b64_tr_b16 v[24:25], v21 offset:12288
    ds_read_b64_tr_b16 v[26:27], v21 offset:12800
    v_mfma_f32_32x32x16_bf16 v[112:127], v[36:39], v[220:223], v[112:127]
    ds_read_b64_tr_b16 v[28:29], v22 offset:12288
    ds_read_b64_tr_b16 v[30:31], v22 offset:12800
    s_add_u32 m0, s94, 8192
    s_add_u32 s15, s95, 65536
    buffer_load_dwordx4 v6, s[72:75], s15 offen lds
    buffer_load_dwordx4 v7, s[72:75], s15 offen offset:1024 lds
    s_waitcnt lgkmcnt(2)
    v_mfma_f32_32x32x16_bf16 v[96:111], v[24:27], v[224:227], v[96:111]
    ds_read_b64_tr_b16 v[32:33], v21 offset:14336
    ds_read_b64_tr_b16 v[34:35], v21 offset:14848
    s_waitcnt lgkmcnt(2)
    v_mfma_f32_32x32x16_bf16 v[112:127], v[28:31], v[224:227], v[112:127]
    ds_read_b64_tr_b16 v[36:37], v22 offset:14336
    ds_read_b64_tr_b16 v[38:39], v22 offset:14848
    s_add_u32 m0, s94, 10240
    s_add_u32 s15, s95, 81920
    buffer_load_dwordx4 v6, s[72:75], s15 offen lds
    buffer_load_dwordx4 v7, s[72:75], s15 offen offset:1024 lds
    s_waitcnt lgkmcnt(2)
    v_mfma_f32_32x32x16_bf16 v[96:111], v[32:35], v[228:231], v[96:111]
    ds_read_b64_tr_b16 v[24:25], v21 offset:28672
    ds_read_b64_tr_b16 v[26:27], v21 offset:29184
    s_waitcnt lgkmcnt(2)
    v_mfma_f32_32x32x16_bf16 v[112:127], v[36:39], v[228:231], v[112:127]
    ds_read_b64_tr_b16 v[28:29], v22 offset:28672
    ds_read_b64_tr_b16 v[30:31], v22 offset:29184
    s_waitcnt lgkmcnt(2)
    v_mfma_f32_32x32x16_bf16 v[96:111], v[24:27], v[232:235], v[96:111]
    ds_read_b64_tr_b16 v[32:33], v21 offset:30720
    ds_read_b64_tr_b16 v[34:35], v21 offset:31232
    s_waitcnt lgkmcnt(2)
    v_mfma_f32_32x32x16_bf16 v[112:127], v[28:31], v[232:235], v[112:127]
    ds_read_b64_tr_b16 v[36:37], v22 offset:30720
    ds_read_b64_tr_b16 v[38:39], v22 offset:31232
    s_waitcnt lgkmcnt(2)
    v_mfma_f32_32x32x16_bf16 v[96:111], v[32:35], v[236:239], v[96:111]
    ds_read_b64_tr_b16 v[24:25], v21 offset:45056
    ds_read_b64_tr_b16 v[26:27], v21 offset:45568
    s_waitcnt lgkmcnt(2)
    v_mfma_f32_32x32x16_bf16 v[112:127], v[36:39], v[236:239], v[112:127]
    ds_read_b64_tr_b16 v[28:29], v22 offset:45056
    ds_read_b64_tr_b16 v[30:31], v22 offset:45568
    s_waitcnt lgkmcnt(2)
    v_mfma_f32_32x32x16_bf16 v[96:111], v[24:27], v[240:243], v[96:111]
    ds_read_b64_tr_b16 v[32:33], v21 offset:47104
    ds_read_b64_tr_b16 v[34:35], v21 offset:47616
    s_waitcnt lgkmcnt(2)
    v_mfma_f32_32x32x16_bf16 v[112:127], v[28:31], v[240:243], v[112:127]
    ds_read_b64_tr_b16 v[36:37], v22 offset:47104
    ds_read_b64_tr_b16 v[38:39], v22 offset:47616
    s_waitcnt lgkmcnt(2)
    v_mfma_f32_32x32x16_bf16 v[96:111], v[32:35], v[244:247], v[96:111]
    ds_read_b64_tr_b16 v[24:25], v21 offset:61440
    ds_read_b64_tr_b16 v[26:27], v21 offset:61952
    s_waitcnt lgkmcnt(2)
    v_mfma_f32_32x32x16_bf16 v[112:127], v[36:39], v[244:247], v[112:127]
    ds_read_b64_tr_b16 v[28:29], v22 offset:61440
    ds_read_b64_tr_b16 v[30:31], v22 offset:61952
    s_waitcnt lgkmcnt(2)
    v_mfma_f32_32x32x16_bf16 v[96:111], v[24:27], v[248:251], v[96:111]
    ds_read_b64_tr_b16 v[32:33], v21 offset:63488
    ds_read_b64_tr_b16 v[34:35], v21 offset:64000
    s_waitcnt lgkmcnt(2)
    v_mfma_f32_32x32x16_bf16 v[112:127], v[28:31], v[248:251], v[112:127]
    ds_read_b64_tr_b16 v[36:37], v22 offset:63488
    ds_read_b64_tr_b16 v[38:39], v22 offset:64000
    s_waitcnt lgkmcnt(2)
    v_mfma_f32_32x32x16_bf16 v[96:111], v[32:35], v[252:255], v[96:111]
    s_waitcnt lgkmcnt(0)
    v_mfma_f32_32x32x16_bf16 v[112:127], v[36:39], v[252:255], v[112:127]
    s_nop 7
    s_nop 3
    v_pk_mul_f32 v[40:41], s[80:81], v[96:97] op_sel:[1,0] op_sel_hi:[1,1]
    v_pk_mul_f32 v[42:43], s[80:81], v[98:99] op_sel:[1,0] op_sel_hi:[1,1]
    v_pk_mul_f32 v[44:45], s[80:81], v[100:101] op_sel:[1,0] op_sel_hi:[1,1]
    v_pk_mul_f32 v[46:47], s[80:81], v[102:103] op_sel:[1,0] op_sel_hi:[1,1]
    v_exp_f32 v40, v40
    v_exp_f32 v41, v41
    v_pk_mul_f32 v[104:105], v[96:97], v[104:105]
    v_exp_f32 v42, v42
    v_exp_f32 v43, v43
    v_pk_mul_f32 v[106:107], v[98:99], v[106:107]
    v_exp_f32 v44, v44
    v_exp_f32 v45, v45
    v_pk_mul_f32 v[108:109], v[100:101], v[108:109]
    v_exp_f32 v46, v46
    v_exp_f32 v47, v47
    v_pk_mul_f32 v[110:111], v[102:103], v[110:111]
    v_pk_add_f32 v[40:41], v[40:41], 1.0 op_sel_hi:[1,0]
    v_pk_add_f32 v[42:43], v[42:43], 1.0 op_sel_hi:[1,0]
    v_pk_add_f32 v[44:45], v[44:45], 1.0 op_sel_hi:[1,0]
    v_pk_add_f32 v[46:47], v[46:47], 1.0 op_sel_hi:[1,0]
    v_rcp_f32 v40, v40
    v_rcp_f32 v41, v41
    v_rcp_f32 v42, v42
    v_rcp_f32 v43, v43
    v_pk_mul_f32 v[104:105], v[104:105], v[40:41]
    v_rcp_f32 v44, v44
    v_rcp_f32 v45, v45
    v_pk_mul_f32 v[106:107], v[106:107], v[42:43]
    v_rcp_f32 v46, v46
    v_rcp_f32 v47, v47
    v_pk_mul_f32 v[108:109], v[108:109], v[44:45]
    v_pk_mul_f32 v[110:111], v[110:111], v[46:47]
    v_cvt_pk_bf16_f32 v96, v104, v105
    v_cvt_pk_bf16_f32 v97, v106, v107
    v_cvt_pk_bf16_f32 v98, v108, v109
    v_cvt_pk_bf16_f32 v99, v110, v111
    buffer_store_dwordx4 v[96:99], v23, s[68:71], s83 offen offset:2048 sc1
    v_pk_mul_f32 v[40:41], s[80:81], v[112:113] op_sel:[1,0] op_sel_hi:[1,1]
    v_pk_mul_f32 v[42:43], s[80:81], v[114:115] op_sel:[1,0] op_sel_hi:[1,1]
    v_pk_mul_f32 v[44:45], s[80:81], v[116:117] op_sel:[1,0] op_sel_hi:[1,1]
    v_pk_mul_f32 v[46:47], s[80:81], v[118:119] op_sel:[1,0] op_sel_hi:[1,1]
    v_exp_f32 v40, v40
    v_exp_f32 v41, v41
    v_pk_mul_f32 v[120:121], v[112:113], v[120:121]
    v_exp_f32 v42, v42
    v_exp_f32 v43, v43
    v_pk_mul_f32 v[122:123], v[114:115], v[122:123]
    v_exp_f32 v44, v44
    v_exp_f32 v45, v45
    v_pk_mul_f32 v[124:125], v[116:117], v[124:125]
    v_exp_f32 v46, v46
    v_exp_f32 v47, v47
    v_pk_mul_f32 v[126:127], v[118:119], v[126:127]
    v_pk_add_f32 v[40:41], v[40:41], 1.0 op_sel_hi:[1,0]
    v_pk_add_f32 v[42:43], v[42:43], 1.0 op_sel_hi:[1,0]
    v_pk_add_f32 v[44:45], v[44:45], 1.0 op_sel_hi:[1,0]
    v_pk_add_f32 v[46:47], v[46:47], 1.0 op_sel_hi:[1,0]
    v_rcp_f32 v40, v40
    v_rcp_f32 v41, v41
    v_rcp_f32 v42, v42
    v_rcp_f32 v43, v43
    v_pk_mul_f32 v[120:121], v[120:121], v[40:41]
    v_rcp_f32 v44, v44
    v_rcp_f32 v45, v45
    v_pk_mul_f32 v[122:123], v[122:123], v[42:43]
    v_rcp_f32 v46, v46
    v_rcp_f32 v47, v47
    v_pk_mul_f32 v[124:125], v[124:125], v[44:45]
    v_pk_mul_f32 v[126:127], v[126:127], v[46:47]
    v_cvt_pk_bf16_f32 v112, v120, v121
    v_cvt_pk_bf16_f32 v113, v122, v123
    v_cvt_pk_bf16_f32 v114, v124, v125
    v_cvt_pk_bf16_f32 v115, v126, v127
    buffer_store_dwordx4 v[112:115], v23, s[68:71], s83 offen offset:3072 sc1
    s_waitcnt vmcnt(0)
    s_setprio 0
    s_barrier
    s_nop 11
    s_add_u32 m0, s94, 12288
    s_add_u32 s15, s95, 98304
    buffer_load_dwordx4 v6, s[72:75], s15 offen lds
    buffer_load_dwordx4 v7, s[72:75], s15 offen offset:1024 lds
    s_add_u32 m0, s94, 14336
    s_add_u32 s15, s95, 114688
    buffer_load_dwordx4 v6, s[72:75], s15 offen lds
    buffer_load_dwordx4 v7, s[72:75], s15 offen offset:1024 lds
    s_lshl_b32 s15, s4, 13
    s_add_u32 m0, s15, 131072
    s_add_u32 s15, s95, 393216
    buffer_load_dwordx4 v6, s[72:75], s15 offen lds
    buffer_load_dwordx4 v7, s[72:75], s15 offen offset:1024 lds
    s_lshl_b32 s15, s4, 13
    s_add_u32 m0, s15, 133120
    s_add_u32 s15, s95, 409600
    buffer_load_dwordx4 v6, s[72:75], s15 offen lds
    buffer_load_dwordx4 v7, s[72:75], s15 offen offset:1024 lds
    s_lshl_b32 s15, s4, 13
    s_add_u32 m0, s15, 135168
    s_add_u32 s15, s95, 425984
    buffer_load_dwordx4 v6, s[72:75], s15 offen lds
    buffer_load_dwordx4 v7, s[72:75], s15 offen offset:1024 lds
    s_lshl_b32 s15, s4, 13
    s_add_u32 m0, s15, 137216
    s_add_u32 s15, s95, 442368
    buffer_load_dwordx4 v6, s[72:75], s15 offen lds
    buffer_load_dwordx4 v7, s[72:75], s15 offen offset:1024 lds
    ds_read_b64_tr_b16 v[128:129], v8 offset:0
    ds_read_b64_tr_b16 v[130:131], v8 offset:1024
    ds_read_b64_tr_b16 v[132:133], v9 offset:0
    ds_read_b64_tr_b16 v[134:135], v9 offset:1024
    s_waitcnt lgkmcnt(0)
    s_add_u32 m0, s94, 0
    s_add_u32 s15, s95, 131072
    buffer_load_dwordx4 v6, s[72:75], s15 offen lds
    buffer_load_dwordx4 v7, s[72:75], s15 offen offset:1024 lds
    ds_read_b64_tr_b16 v[136:137], v8 offset:2048
    ds_read_b64_tr_b16 v[138:139], v8 offset:3072
    ds_read_b64_tr_b16 v[140:141], v9 offset:2048
    ds_read_b64_tr_b16 v[142:143], v9 offset:3072
    s_waitcnt lgkmcnt(0)
    s_add_u32 m0, s94, 2048
    s_add_u32 s15, s95, 147456
    buffer_load_dwordx4 v6, s[72:75], s15 offen lds
    buffer_load_dwordx4 v7, s[72:75], s15 offen offset:1024 lds
    ds_read_b64_tr_b16 v[144:145], v8 offset:4096
    ds_read_b64_tr_b16 v[146:147], v8 offset:5120
    ds_read_b64_tr_b16 v[148:149], v9 offset:4096
    ds_read_b64_tr_b16 v[150:151], v9 offset:5120
    s_waitcnt lgkmcnt(0)
    s_add_u32 m0, s94, 4096
    s_add_u32 s15, s95, 163840
    buffer_load_dwordx4 v6, s[72:75], s15 offen lds
    buffer_load_dwordx4 v7, s[72:75], s15 offen offset:1024 lds
    ds_read_b64_tr_b16 v[152:153], v8 offset:6144
    ds_read_b64_tr_b16 v[154:155], v8 offset:7168
    ds_read_b64_tr_b16 v[156:157], v9 offset:6144
    ds_read_b64_tr_b16 v[158:159], v9 offset:7168
    s_waitcnt lgkmcnt(0)
    s_add_u32 m0, s94, 6144
    s_add_u32 s15, s95, 180224
    buffer_load_dwordx4 v6, s[72:75], s15 offen lds
    buffer_load_dwordx4 v7, s[72:75], s15 offen offset:1024 lds
    ds_read_b64_tr_b16 v[160:161], v8 offset:8192
    ds_read_b64_tr_b16 v[162:163], v8 offset:9216
    ds_read_b64_tr_b16 v[164:165], v9 offset:8192
    ds_read_b64_tr_b16 v[166:167], v9 offset:9216
    s_waitcnt lgkmcnt(0)
    s_add_u32 m0, s94, 8192
    s_add_u32 s15, s95, 196608
    buffer_load_dwordx4 v6, s[72:75], s15 offen lds
    buffer_load_dwordx4 v7, s[72:75], s15 offen offset:1024 lds
    ds_read_b64_tr_b16 v[168:169], v8 offset:10240
    ds_read_b64_tr_b16 v[170:171], v8 offset:11264
    ds_read_b64_tr_b16 v[172:173], v9 offset:10240
    ds_read_b64_tr_b16 v[174:175], v9 offset:11264
    s_waitcnt lgkmcnt(0)
    s_add_u32 m0, s94, 10240
    s_add_u32 s15, s95, 212992
    buffer_load_dwordx4 v6, s[72:75], s15 offen lds
    buffer_load_dwordx4 v7, s[72:75], s15 offen offset:1024 lds
    s_waitcnt vmcnt(22)
    ds_read_b64_tr_b16 v[176:177], v8 offset:12288
    ds_read_b64_tr_b16 v[178:179], v8 offset:13312
    ds_read_b64_tr_b16 v[180:181], v9 offset:12288
    ds_read_b64_tr_b16 v[182:183], v9 offset:13312
    s_waitcnt lgkmcnt(0)
    s_add_u32 m0, s94, 12288
    s_add_u32 s15, s95, 229376
    buffer_load_dwordx4 v6, s[72:75], s15 offen lds
    buffer_load_dwordx4 v7, s[72:75], s15 offen offset:1024 lds
    s_waitcnt vmcnt(22)
    ds_read_b64_tr_b16 v[184:185], v8 offset:14336
    ds_read_b64_tr_b16 v[186:187], v8 offset:15360
    ds_read_b64_tr_b16 v[188:189], v9 offset:14336
    ds_read_b64_tr_b16 v[190:191], v9 offset:15360
    s_waitcnt lgkmcnt(0)
    s_add_u32 m0, s94, 14336
    s_add_u32 s15, s95, 245760
    buffer_load_dwordx4 v6, s[72:75], s15 offen lds
    buffer_load_dwordx4 v7, s[72:75], s15 offen offset:1024 lds
    s_waitcnt vmcnt(14)
    ds_read_b64_tr_b16 v[192:193], v8 offset:0
    ds_read_b64_tr_b16 v[194:195], v8 offset:1024
    ds_read_b64_tr_b16 v[196:197], v9 offset:0
    ds_read_b64_tr_b16 v[198:199], v9 offset:1024
    s_waitcnt lgkmcnt(0)
    s_add_u32 m0, s94, 0
    s_add_u32 s15, s95, 262144
    buffer_load_dwordx4 v6, s[72:75], s15 offen lds
    buffer_load_dwordx4 v7, s[72:75], s15 offen offset:1024 lds
    s_waitcnt vmcnt(14)
    ds_read_b64_tr_b16 v[200:201], v8 offset:2048
    ds_read_b64_tr_b16 v[202:203], v8 offset:3072
    ds_read_b64_tr_b16 v[204:205], v9 offset:2048
    ds_read_b64_tr_b16 v[206:207], v9 offset:3072
    s_waitcnt lgkmcnt(0)
    s_add_u32 m0, s94, 2048
    s_add_u32 s15, s95, 278528
    buffer_load_dwordx4 v6, s[72:75], s15 offen lds
    buffer_load_dwordx4 v7, s[72:75], s15 offen offset:1024 lds
    s_waitcnt vmcnt(14)
    ds_read_b64_tr_b16 v[208:209], v8 offset:4096
    ds_read_b64_tr_b16 v[210:211], v8 offset:5120
    ds_read_b64_tr_b16 v[212:213], v9 offset:4096
    ds_read_b64_tr_b16 v[214:215], v9 offset:5120
    s_waitcnt lgkmcnt(0)
    s_add_u32 m0, s94, 4096
    s_add_u32 s15, s95, 294912
    buffer_load_dwordx4 v6, s[72:75], s15 offen lds
    buffer_load_dwordx4 v7, s[72:75], s15 offen offset:1024 lds
    s_waitcnt vmcnt(14)
    ds_read_b64_tr_b16 v[216:217], v8 offset:6144
    ds_read_b64_tr_b16 v[218:219], v8 offset:7168
    ds_read_b64_tr_b16 v[220:221], v9 offset:6144
    ds_read_b64_tr_b16 v[222:223], v9 offset:7168
    s_waitcnt lgkmcnt(0)
    s_add_u32 m0, s94, 6144
    s_add_u32 s15, s95, 311296
    buffer_load_dwordx4 v6, s[72:75], s15 offen lds
    buffer_load_dwordx4 v7, s[72:75], s15 offen offset:1024 lds
    s_waitcnt vmcnt(14)
    ds_read_b64_tr_b16 v[224:225], v8 offset:8192
    ds_read_b64_tr_b16 v[226:227], v8 offset:9216
    ds_read_b64_tr_b16 v[228:229], v9 offset:8192
    ds_read_b64_tr_b16 v[230:231], v9 offset:9216
    s_waitcnt lgkmcnt(0)
    s_add_u32 m0, s94, 8192
    s_add_u32 s15, s95, 327680
    buffer_load_dwordx4 v6, s[72:75], s15 offen lds
    buffer_load_dwordx4 v7, s[72:75], s15 offen offset:1024 lds
    s_waitcnt vmcnt(14)
    ds_read_b64_tr_b16 v[232:233], v8 offset:10240
    ds_read_b64_tr_b16 v[234:235], v8 offset:11264
    ds_read_b64_tr_b16 v[236:237], v9 offset:10240
    ds_read_b64_tr_b16 v[238:239], v9 offset:11264
    s_waitcnt lgkmcnt(0)
    s_add_u32 m0, s94, 10240
    s_add_u32 s15, s95, 344064
    buffer_load_dwordx4 v6, s[72:75], s15 offen lds
    buffer_load_dwordx4 v7, s[72:75], s15 offen offset:1024 lds
    s_waitcnt vmcnt(14)
    ds_read_b64_tr_b16 v[240:241], v8 offset:12288
    ds_read_b64_tr_b16 v[242:243], v8 offset:13312
    ds_read_b64_tr_b16 v[244:245], v9 offset:12288
    ds_read_b64_tr_b16 v[246:247], v9 offset:13312
    s_waitcnt lgkmcnt(0)
    s_add_u32 m0, s94, 12288
    s_add_u32 s15, s95, 360448
    buffer_load_dwordx4 v6, s[72:75], s15 offen lds
    buffer_load_dwordx4 v7, s[72:75], s15 offen offset:1024 lds
    s_waitcnt vmcnt(14)
    ds_read_b64_tr_b16 v[248:249], v8 offset:14336
    ds_read_b64_tr_b16 v[250:251], v8 offset:15360
    ds_read_b64_tr_b16 v[252:253], v9 offset:14336
    ds_read_b64_tr_b16 v[254:255], v9 offset:15360
    s_waitcnt lgkmcnt(0)
    s_add_u32 m0, s94, 14336
    s_add_u32 s15, s95, 376832
    buffer_load_dwordx4 v6, s[72:75], s15 offen lds
    buffer_load_dwordx4 v7, s[72:75], s15 offen offset:1024 lds
    s_branch L_P2_1
L_body_X0:
    v_mov_b32 v237, 0
    s_lshl_b32 s12, s4, 3
    s_or_b32 s12, s12, s2
    s_cmp_ge_u32 s12, 8
    s_cbranch_scc1 L_ep_skip_1
    s_memrealtime s[88:89]
    s_waitcnt lgkmcnt(0)
    s_or_b32 s12, s88, 1
    v_mov_b32 v236, s12
    s_mov_b64 exec, 1
    global_atomic_cmpswap v237, v[236:237], s[46:47] sc1
    s_mov_b64 exec, -1
L_ep_skip_1:
    s_mov_b32 s52, s16
    s_and_b32 s53, s17, 0xffff
    s_mov_b32 s54, 2097152
    s_mov_b32 s55, 0x00020000
    s_mov_b32 s68, s48
    s_and_b32 s69, s49, 0xffff
    s_mov_b32 s70, 14721024
    s_mov_b32 s71, 0x00020000
    s_mov_b32 s81, 0xbfb8aa3b
    s_barrier
    s_lshl_b32 s12, s6, 7
    s_lshl_b32 s13, s85, 3
    s_add_u32 s12, s12, s13
    s_add_u32 s12, s12, s3
    s_lshl_b32 s13, s12, 10
    s_lshl_b32 s87, s12, 2
    s_add_u32 s87, s87, 14417920
    v_add_u32 v239, s13, v23
    s_add_u32 s93, s11, s4
    s_lshl_b32 s93, s93, 13
    s_add_u32 s93, s93, 14426112
    s_lshl_b32 s12, s6, 8
    s_add_u32 s93, s93, s12
    s_cmp_eq_u32 s4, 0
    s_cselect_b32 s13, 4, 0
    v_mul_u32_u24 v232, s13, v99
    s_add_u32 s12, s11, s4
    v_add_u32 v232, s12, v232
    v_min_u32 v232, 31, v232
    v_and_b32 v233, 30, v0
    v_lshl_add_u32 v232, v232, 5, v233
    s_mul_i32 s12, s4, 57344
    s_lshl_b32 s13, s10, 7
    s_add_u32 s12, s12, s13
    v_add_u32 v6, s12, v101
    v_add_u32 v7, 27648, v6
    v_xor_b32 v8, 64, v6
    v_xor_b32 v9, 64, v7
    v_bfe_u32 v102, v0, 1, 3
    v_xor_b32 v102, v102, v99
    v_lshlrev_b32 v102, 4, v102
    v_lshl_add_u32 v102, v100, 7, v102
    s_lshl_b32 s12, s4, 14
    v_add_u32 v10, s12, v102
    v_xor_b32 v11, 32, v10
    v_xor_b32 v12, 64, v10
    v_xor_b32 v13, 96, v10
    v_bfe_u32 v103, v0, 2, 2
    v_lshl_add_u32 v104, v99, 3, v103
    v_lshlrev_b32 v104, 7, v104
    v_and_b32 v107, 3, v0
    v_lshl_add_u32 v104, v107, 3, v104
    v_and_b32 v105, 1, v98
    v_lshrrev_b32 v106, 1, v103
    v_lshl_add_u32 v106, v105, 1, v106
    v_lshl_add_u32 v104, v106, 5, v104
    v_lshl_add_u32 v106, v105, 16, v104
    v_xor_b32 v21, 0, v106
    v_xor_b32 v22, 32, v21
    v_lshl_add_u32 v106, v105, 15, v104
    v_add_u32 v106, 65536, v106
    v_xor_b32 v18, 0, v106
    v_and_b32 v108, 1, v0
    v_lshrrev_b32 v109, 1, v100
    v_lshl_add_u32 v109, v108, 4, v109
    v_bfe_u32 v110, v109, 1, 2
    v_lshl_add_u32 v110, v108, 2, v110
    v_xor_b32 v110, v110, v99
    v_lshlrev_b32 v110, 4, v110
    v_lshl_add_u32 v110, v109, 7, v110
    v_add_u32 v14, 131072, v110
    v_xor_b32 v15, 32, v14
    v_xor_b32 v16, 64, v14
    v_xor_b32 v17, 96, v14
    s_lshr_b32 s80, s3, 1
    s_lshl_b32 s80, s80, 14
    s_and_b32 s12, s3, 1
    s_lshl_b32 s12, s12, 11
    s_add_u32 s80, s80, s12
    s_lshl_b32 s94, s3, 14
    s_lshl_b32 s12, s6, 2
    s_add_u32 s12, s12, s4
    s_mul_i32 s12, s12, 180224
    s_lshl_b32 s13, s9, 12
    s_add_u32 s82, s12, s13
    s_lshl_b32 s13, s10, 12
    s_add_u32 s83, s12, s13
    s_lshl_b32 s13, s11, 11
    s_add_u32 s84, s12, s13
    s_add_u32 s84, s84, 114688
    s_mul_i32 s35, s50, 360448
    s_lshl_b32 s12, s4, 14
    s_add_u32 s35, s35, s12
    s_add_u32 s35, s35, 114688
    s_lshl_b32 s95, s51, 16
    s_lshl_b32 s12, s4, 8
    s_add_u32 s95, s95, s12
    s_add_u32 m0, s78, 135168
    s_add_u32 s76, s1, 1
    s_and_b32 s76, s76, 7
    s_mul_i32 s76, s76, 128
    buffer_load_dwordx4 v1, s[56:59], s76 offen lds
    s_add_u32 m0, s79, 69632
    s_mul_i32 s77, s76, 1792
    buffer_load_dwordx4 v2, s[60:63], s77 offen lds
    buffer_load_dwordx4 v3, s[60:63], s77 offen offset:1024 lds
    s_add_u32 m0, s79, 102400
    s_nop 0
    buffer_load_dwordx4 v4, s[64:67], s77 offen lds
    buffer_load_dwordx4 v5, s[64:67], s77 offen offset:1024 lds
    s_waitcnt vmcnt(5)
    s_barrier
    ds_read_b128 v[128:131], v10 offset:0
    ds_read_b128 v[24:27], v14 offset:0
    ds_read_b64_tr_b16 v[28:29], v18 offset:0
    ds_read_b64_tr_b16 v[30:31], v18 offset:512
    s_waitcnt lgkmcnt(2)
    v_mfma_f32_32x32x16_bf16 v[48:63], v[128:131], v[24:27], 0
    ds_read_b128 v[132:135], v11 offset:0
    ds_read_b128 v[36:39], v15 offset:0
    s_add_u32 m0, s78, 139264
    s_add_u32 s76, s1, 2
    s_and_b32 s76, s76, 7
    s_mul_i32 s76, s76, 128
    buffer_load_dwordx4 v1, s[56:59], s76 offen lds
    s_add_u32 m0, s79, 73728
    s_mul_i32 s77, s76, 1792
    buffer_load_dwordx4 v2, s[60:63], s77 offen lds
    s_waitcnt lgkmcnt(2)
    v_mfma_f32_32x32x16_bf16 v[64:79], v[28:31], v[128:131], 0
    ds_read_b64_tr_b16 v[40:41], v18 offset:2048
    ds_read_b64_tr_b16 v[42:43], v18 offset:2560
    buffer_load_dwordx4 v3, s[60:63], s77 offen offset:1024 lds
    s_add_u32 m0, s79, 106496
    s_nop 0
    buffer_load_dwordx4 v4, s[64:67], s77 offen lds
    s_waitcnt lgkmcnt(2)
    v_mfma_f32_32x32x16_bf16 v[48:63], v[132:135], v[36:39], v[48:63]
    ds_read_b128 v[136:139], v12 offset:0
    ds_read_b128 v[24:27], v16 offset:0
    buffer_load_dwordx4 v5, s[64:67], s77 offen offset:1024 lds
    s_add_u32 m0, s78, 143360
    s_add_u32 s76, s1, 3
    s_and_b32 s76, s76, 7
    s_mul_i32 s76, s76, 128
    buffer_load_dwordx4 v1, s[56:59], s76 offen lds
    s_waitcnt lgkmcnt(2)
    v_mfma_f32_32x32x16_bf16 v[64:79], v[40:43], v[132:135], v[64:79]
    ds_read_b64_tr_b16 v[28:29], v18 offset:16384
    ds_read_b64_tr_b16 v[30:31], v18 offset:16896
    s_waitcnt lgkmcnt(2)
    v_mfma_f32_32x32x16_bf16 v[48:63], v[136:139], v[24:27], v[48:63]
    ds_read_b128 v[140:143], v13 offset:0
    ds_read_b128 v[36:39], v17 offset:0
    s_add_u32 m0, s79, 77824
    s_mul_i32 s77, s76, 1792
    buffer_load_dwordx4 v2, s[60:63], s77 offen lds
    s_waitcnt lgkmcnt(2)
    v_mfma_f32_32x32x16_bf16 v[64:79], v[28:31], v[136:139], v[64:79]
    ds_read_b64_tr_b16 v[40:41], v18 offset:18432
    ds_read_b64_tr_b16 v[42:43], v18 offset:18944
    s_waitcnt vmcnt(7) lgkmcnt(0)
    s_barrier
    v_mfma_f32_32x32x16_bf16 v[48:63], v[140:143], v[36:39], v[48:63]
    ds_read_b128 v[144:147], v10 offset:4096
    ds_read_b128 v[24:27], v14 offset:4096
    buffer_load_dwordx4 v3, s[60:63], s77 offen offset:1024 lds
    s_add_u32 m0, s79, 110592
    s_nop 0
    buffer_load_dwordx4 v4, s[64:67], s77 offen lds
    v_mfma_f32_32x32x16_bf16 v[64:79], v[40:43], v[140:143], v[64:79]
    ds_read_b64_tr_b16 v[28:29], v18 offset:4096
    ds_read_b64_tr_b16 v[30:31], v18 offset:4608
    buffer_load_dwordx4 v5, s[64:67], s77 offen offset:1024 lds
    s_add_u32 m0, s78, 131072
    s_add_u32 s76, s1, 4
    s_and_b32 s76, s76, 7
    s_mul_i32 s76, s76, 128
    buffer_load_dwordx4 v1, s[56:59], s76 offen lds
    s_waitcnt lgkmcnt(2)
    v_mfma_f32_32x32x16_bf16 v[48:63], v[144:147], v[24:27], v[48:63]
    ds_read_b128 v[148:151], v11 offset:4096
    ds_read_b128 v[36:39], v15 offset:4096
    s_add_u32 m0, s79, 65536
    s_mul_i32 s77, s76, 1792
    buffer_load_dwordx4 v2, s[60:63], s77 offen lds
    buffer_load_dwordx4 v3, s[60:63], s77 offen offset:1024 lds
    s_waitcnt lgkmcnt(2)
    v_mfma_f32_32x32x16_bf16 v[64:79], v[28:31], v[144:147], v[64:79]
    ds_read_b64_tr_b16 v[40:41], v18 offset:6144
    ds_read_b64_tr_b16 v[42:43], v18 offset:6656
    s_add_u32 m0, s79, 98304
    s_nop 0
    buffer_load_dwordx4 v4, s[64:67], s77 offen lds
    buffer_load_dwordx4 v5, s[64:67], s77 offen offset:1024 lds
    s_waitcnt lgkmcnt(2)
    v_mfma_f32_32x32x16_bf16 v[48:63], v[148:151], v[36:39], v[48:63]
    ds_read_b128 v[152:155], v12 offset:4096
    ds_read_b128 v[24:27], v16 offset:4096
    global_load_ushort v233, v232, s[18:19]
    global_load_ushort v234, v232, s[20:21]
    global_load_ushort v235, v232, s[30:31]
    s_waitcnt lgkmcnt(2)
    v_mfma_f32_32x32x16_bf16 v[64:79], v[40:43], v[148:151], v[64:79]
    ds_read_b64_tr_b16 v[28:29], v18 offset:20480
    ds_read_b64_tr_b16 v[30:31], v18 offset:20992
    s_waitcnt lgkmcnt(2)
    v_mfma_f32_32x32x16_bf16 v[48:63], v[152:155], v[24:27], v[48:63]
    ds_read_b128 v[156:159], v13 offset:4096
    ds_read_b128 v[36:39], v17 offset:4096
    buffer_load_dwordx4 v[224:227], v239, s[52:55], 0 offen
    s_waitcnt lgkmcnt(2)
    v_mfma_f32_32x32x16_bf16 v[64:79], v[28:31], v[152:155], v[64:79]
    ds_read_b64_tr_b16 v[40:41], v18 offset:22528
    ds_read_b64_tr_b16 v[42:43], v18 offset:23040
    s_waitcnt vmcnt(14) lgkmcnt(0)
    s_barrier
    v_mfma_f32_32x32x16_bf16 v[48:63], v[156:159], v[36:39], v[48:63]
    ds_read_b128 v[160:163], v10 offset:8192
    ds_read_b128 v[24:27], v14 offset:8192
    global_load_dwordx4 v[228:231], v23, s[42:43]
    s_add_u32 m0, s78, 135168
    s_add_u32 s76, s1, 5
    s_and_b32 s76, s76, 7
    s_mul_i32 s76, s76, 128
    buffer_load_dwordx4 v1, s[56:59], s76 offen lds
    v_mfma_f32_32x32x16_bf16 v[64:79], v[40:43], v[156:159], v[64:79]
    ds_read_b64_tr_b16 v[28:29], v18 offset:8192
    ds_read_b64_tr_b16 v[30:31], v18 offset:8704
    s_add_u32 m0, s79, 69632
    s_mul_i32 s77, s76, 1792
    buffer_load_dwordx4 v2, s[60:63], s77 offen lds
    s_waitcnt lgkmcnt(2)
    v_mfma_f32_32x32x16_bf16 v[48:63], v[160:163], v[24:27], v[48:63]
    ds_read_b128 v[164:167], v11 offset:8192
    ds_read_b128 v[36:39], v15 offset:8192
    buffer_load_dwordx4 v3, s[60:63], s77 offen offset:1024 lds
    s_waitcnt lgkmcnt(2)
    v_mfma_f32_32x32x16_bf16 v[64:79], v[28:31], v[160:163], v[64:79]
    ds_read_b64_tr_b16 v[40:41], v18 offset:10240
    ds_read_b64_tr_b16 v[42:43], v18 offset:10752
    s_cmp_lg_u32 s4, 0
    s_cbranch_scc1 L_epl_skip_2
    global_load_dword v238, v237, s[46:47] sc1
L_epl_skip_2:
    s_waitcnt lgkmcnt(2)
    v_mfma_f32_32x32x16_bf16 v[48:63], v[164:167], v[36:39], v[48:63]
    ds_read_b128 v[168:171], v12 offset:8192
    ds_read_b128 v[24:27], v16 offset:8192
    s_add_u32 m0, s79, 102400
    s_nop 0
    buffer_load_dwordx4 v4, s[64:67], s77 offen lds
    s_waitcnt lgkmcnt(2)
    v_mfma_f32_32x32x16_bf16 v[64:79], v[40:43], v[164:167], v[64:79]
    ds_read_b64_tr_b16 v[28:29], v18 offset:24576
    ds_read_b64_tr_b16 v[30:31], v18 offset:25088
    s_waitcnt lgkmcnt(2)
    v_mfma_f32_32x32x16_bf16 v[48:63], v[168:171], v[24:27], v[48:63]
    ds_read_b128 v[172:175], v13 offset:8192
    ds_read_b128 v[36:39], v17 offset:8192
    buffer_load_dwordx4 v5, s[64:67], s77 offen offset:1024 lds
    s_waitcnt vmcnt(7)
    v_lshlrev_b32 v90, 16, v233
    v_lshlrev_b32 v91, 16, v234
    v_lshlrev_b32 v92, 16, v235
    s_waitcnt lgkmcnt(2)
    v_mfma_f32_32x32x16_bf16 v[64:79], v[28:31], v[168:171], v[64:79]
    ds_read_b64_tr_b16 v[40:41], v18 offset:26624
    ds_read_b64_tr_b16 v[42:43], v18 offset:27136
    v_mul_f32 v92, 0x3fb8aa3b, v92
    v_exp_f32 v92, v92
    v_mul_f32 v85, v90, v90
    s_waitcnt lgkmcnt(0)
    s_barrier
    v_mfma_f32_32x32x16_bf16 v[48:63], v[172:175], v[36:39], v[48:63]
    ds_read_b128 v[176:179], v10 offset:12288
    ds_read_b128 v[24:27], v14 offset:12288
    s_add_u32 m0, s78, 139264
    s_add_u32 s76, s1, 6
    s_and_b32 s76, s76, 7
    s_mul_i32 s76, s76, 128
    buffer_load_dwordx4 v1, s[56:59], s76 offen lds
    v_cvt_pk_bf16_f32 v92, v92, v92
    v_lshlrev_b32 v92, 16, v92
    v_mul_f32 v80, v92, v90
    v_mfma_f32_32x32x16_bf16 v[64:79], v[40:43], v[172:175], v[64:79]
    ds_read_b64_tr_b16 v[28:29], v18 offset:12288
    ds_read_b64_tr_b16 v[30:31], v18 offset:12800
    s_add_u32 m0, s79, 73728
    s_mul_i32 s77, s76, 1792
    buffer_load_dwordx4 v2, s[60:63], s77 offen lds
    v_mul_f32 v81, v92, v91
    v_mul_f32 v80, 0x3fb8aa3b, v80
    v_exp_f32 v80, v80
    s_waitcnt lgkmcnt(2)
    v_mfma_f32_32x32x16_bf16 v[48:63], v[176:179], v[24:27], v[48:63]
    ds_read_b128 v[180:183], v11 offset:12288
    ds_read_b128 v[36:39], v15 offset:12288
    buffer_load_dwordx4 v3, s[60:63], s77 offen offset:1024 lds
    v_mul_f32 v81, 0x3e22f983, v81
    v_rndne_f32 v82, v81
    v_sub_f32 v81, v81, v82
    s_waitcnt lgkmcnt(2)
    v_mfma_f32_32x32x16_bf16 v[64:79], v[28:31], v[176:179], v[64:79]
    ds_read_b64_tr_b16 v[40:41], v18 offset:14336
    ds_read_b64_tr_b16 v[42:43], v18 offset:14848
    v_cos_f32 v82, v81
    v_sin_f32 v83, v81
    v_fmac_f32 v85, v91, v91
    s_waitcnt lgkmcnt(2)
    v_mfma_f32_32x32x16_bf16 v[48:63], v[180:183], v[36:39], v[48:63]
    ds_read_b128 v[184:187], v12 offset:12288
    ds_read_b128 v[24:27], v16 offset:12288
    s_add_u32 m0, s79, 106496
    s_nop 0
    buffer_load_dwordx4 v4, s[64:67], s77 offen lds
    v_mul_f32 v82, v80, v82
    v_mul_f32 v83, v80, v83
    v_rcp_f32 v85, v85
    s_waitcnt lgkmcnt(2)
    v_mfma_f32_32x32x16_bf16 v[64:79], v[40:43], v[180:183], v[64:79]
    ds_read_b64_tr_b16 v[28:29], v18 offset:28672
    ds_read_b64_tr_b16 v[30:31], v18 offset:29184
    v_add_f32 v84, -1.0, v82
    v_mul_f32 v86, v84, v90
    v_fmac_f32 v86, v83, v91
    s_waitcnt lgkmcnt(2)
    v_mfma_f32_32x32x16_bf16 v[48:63], v[184:187], v[24:27], v[48:63]
    ds_read_b128 v[188:191], v13 offset:12288
    ds_read_b128 v[36:39], v17 offset:12288
    buffer_load_dwordx4 v5, s[64:67], s77 offen offset:1024 lds
    v_mul_f32 v87, v83, v90
    v_fma_f32 v87, -v84, v91, v87
    v_add_f32 v85, v85, v85
    s_waitcnt lgkmcnt(2)
    v_mfma_f32_32x32x16_bf16 v[64:79], v[28:31], v[184:187], v[64:79]
    ds_read_b64_tr_b16 v[40:41], v18 offset:30720
    ds_read_b64_tr_b16 v[42:43], v18 offset:31232
    v_mul_f32 v86, v86, v85
    v_mul_f32 v87, v87, v85
    v_and_b32 v88, 1, v0
    s_waitcnt lgkmcnt(0)
    s_barrier
    v_mfma_f32_32x32x16_bf16 v[48:63], v[188:191], v[36:39], v[48:63]
    ds_read_b128 v[192:195], v10 offset:0
    ds_read_b128 v[24:27], v14 offset:0
    s_add_u32 m0, s78, 143360
    s_add_u32 s76, s1, 7
    s_and_b32 s76, s76, 7
    s_mul_i32 s76, s76, 128
    buffer_load_dwordx4 v1, s[56:59], s76 offen lds
    v_lshlrev_b32 v88, 31, v88
    v_xor_b32 v89, 0x80000000, v88
    v_xor_b32 v120, v88, v86
    v_mfma_f32_32x32x16_bf16 v[64:79], v[40:43], v[188:191], v[64:79]
    ds_read_b64_tr_b16 v[28:29], v18 offset:0
    ds_read_b64_tr_b16 v[30:31], v18 offset:512
    s_add_u32 m0, s79, 77824
    s_mul_i32 s77, s76, 1792
    buffer_load_dwordx4 v2, s[60:63], s77 offen lds
    v_xor_b32 v121, 0x80000000, v87
    v_mov_b32 v112, v82
    v_xor_b32 v113, v89, v83
    s_waitcnt lgkmcnt(2)
    v_mfma_f32_32x32x16_bf16 v[48:63], v[192:195], v[24:27], v[48:63]
    ds_read_b128 v[196:199], v11 offset:0
    ds_read_b128 v[36:39], v15 offset:0
    buffer_load_dwordx4 v3, s[60:63], s77 offen offset:1024 lds
    v_mul_f32 v84, v83, v83
    v_mul_f32 v85, v82, v83
    v_fma_f32 v82, v82, v82, -v84
    s_waitcnt lgkmcnt(2)
    v_mfma_f32_32x32x16_bf16 v[64:79], v[28:31], v[192:195], v[64:79]
    ds_read_b64_tr_b16 v[40:41], v18 offset:2048
    ds_read_b64_tr_b16 v[42:43], v18 offset:2560
    v_add_f32 v83, v85, v85
    v_mul_f32 v84, v83, v83
    v_mul_f32 v85, v82, v83
    s_waitcnt lgkmcnt(2)
    v_mfma_f32_32x32x16_bf16 v[48:63], v[196:199], v[36:39], v[48:63]
    ds_read_b128 v[200:203], v12 offset:0
    ds_read_b128 v[24:27], v16 offset:0
    s_add_u32 m0, s79, 110592
    s_nop 0
    buffer_load_dwordx4 v4, s[64:67], s77 offen lds
    v_fma_f32 v82, v82, v82, -v84
    v_add_f32 v83, v85, v85
    v_mul_f32 v84, v83, v83
    s_waitcnt lgkmcnt(2)
    v_mfma_f32_32x32x16_bf16 v[64:79], v[40:43], v[196:199], v[64:79]
    ds_read_b64_tr_b16 v[28:29], v18 offset:16384
    ds_read_b64_tr_b16 v[30:31], v18 offset:16896
    v_mul_f32 v85, v82, v83
    v_fma_f32 v82, v82, v82, -v84
    v_add_f32 v83, v85, v85
    s_waitcnt lgkmcnt(2)
    v_mfma_f32_32x32x16_bf16 v[48:63], v[200:203], v[24:27], v[48:63]
    ds_read_b128 v[204:207], v13 offset:0
    ds_read_b128 v[36:39], v17 offset:0
    buffer_load_dwordx4 v5, s[64:67], s77 offen offset:1024 lds
    v_mul_f32 v84, v83, v83
    v_mul_f32 v85, v82, v83
    v_fma_f32 v82, v82, v82, -v84
    s_waitcnt lgkmcnt(2)
    v_mfma_f32_32x32x16_bf16 v[64:79], v[28:31], v[200:203], v[64:79]
    ds_read_b64_tr_b16 v[40:41], v18 offset:18432
    ds_read_b64_tr_b16 v[42:43], v18 offset:18944
    v_add_f32 v83, v85, v85
    v_mov_b32 v114, v82
    v_xor_b32 v115, v89, v83
    s_cmp_lg_u32 s4, 0
    s_cbranch_scc1 L_ep_skip_3
    s_mov_b32 s86, 0
    s_waitcnt vmcnt(12)
L_ep_poll_4:
    v_cmp_ne_u32 vcc, 0, v238
    s_cbranch_vccnz L_ep_ok_5
    s_sleep 2
    global_load_dword v238, v237, s[46:47] sc1
    s_waitcnt vmcnt(0)
    s_add_u32 s86, s86, 1
    s_cmp_lt_u32 s86, 0x4000
    s_cbranch_scc1 L_ep_poll_4
L_ep_ok_5:
    v_mov_b32 v236, 161792
    ds_write_b32 v236, v238
    s_waitcnt lgkmcnt(0)
L_ep_skip_3:
    s_waitcnt vmcnt(10) lgkmcnt(0)
    s_barrier
    v_mfma_f32_32x32x16_bf16 v[48:63], v[204:207], v[36:39], v[48:63]
    ds_read_b128 v[208:211], v10 offset:4096
    ds_read_b128 v[24:27], v14 offset:4096
    s_add_u32 m0, s80, 0
    s_add_u32 s77, s1, 0
    s_and_b32 s77, s77, 7
    s_mul_i32 s77, s77, 229376
    buffer_load_dwordx4 v6, s[60:63], s77 offen lds
    v_mul_f32 v84, v83, v83
    v_mul_f32 v85, v82, v83
    v_fma_f32 v82, v82, v82, -v84
    v_mfma_f32_32x32x16_bf16 v[64:79], v[40:43], v[204:207], v[64:79]
    ds_read_b64_tr_b16 v[28:29], v18 offset:4096
    ds_read_b64_tr_b16 v[30:31], v18 offset:4608
    buffer_load_dwordx4 v7, s[60:63], s77 offen offset:1024 lds
    v_add_f32 v83, v85, v85
    v_mul_f32 v84, v83, v83
    v_mul_f32 v85, v82, v83
    s_waitcnt lgkmcnt(2)
    v_mfma_f32_32x32x16_bf16 v[48:63], v[208:211], v[24:27], v[48:63]
    ds_read_b128 v[212:215], v11 offset:4096
    ds_read_b128 v[36:39], v15 offset:4096
    s_add_u32 m0, s80, 65536
    s_nop 0
    buffer_load_dwordx4 v8, s[64:67], s77 offen lds
    v_fma_f32 v82, v82, v82, -v84
    v_add_f32 v83, v85, v85
    v_mul_f32 v84, v83, v83
    s_waitcnt lgkmcnt(2)
    v_mfma_f32_32x32x16_bf16 v[64:79], v[28:31], v[208:211], v[64:79]
    ds_read_b64_tr_b16 v[40:41], v18 offset:6144
    ds_read_b64_tr_b16 v[42:43], v18 offset:6656
    v_mul_f32 v85, v82, v83
    v_fma_f32 v82, v82, v82, -v84
    v_add_f32 v83, v85, v85
    v_mov_b32 v240, 161792
    ds_read_b32 v240, v240
    s_waitcnt lgkmcnt(3)
    v_mfma_f32_32x32x16_bf16 v[48:63], v[212:215], v[36:39], v[48:63]
    ds_read_b128 v[216:219], v12 offset:4096
    ds_read_b128 v[24:27], v16 offset:4096
    buffer_load_dwordx4 v9, s[64:67], s77 offen offset:1024 lds
    v_mov_b32 v116, v82
    v_xor_b32 v117, v89, v83
    v_mul_f32 v84, v83, v83
    s_waitcnt lgkmcnt(3)
    v_mfma_f32_32x32x16_bf16 v[64:79], v[40:43], v[212:215], v[64:79]
    ds_read_b64_tr_b16 v[28:29], v18 offset:20480
    ds_read_b64_tr_b16 v[30:31], v18 offset:20992
    v_mul_f32 v85, v82, v83
    v_fma_f32 v82, v82, v82, -v84
    v_add_f32 v83, v85, v85
    s_waitcnt lgkmcnt(4)
    v_readfirstlane_b32 s34, v240
    s_waitcnt lgkmcnt(2)
    v_mfma_f32_32x32x16_bf16 v[48:63], v[216:219], v[24:27], v[48:63]
    ds_read_b128 v[220:223], v13 offset:4096
    ds_read_b128 v[36:39], v17 offset:4096
    v_mov_b32 v118, v82
    v_xor_b32 v119, v89, v83
    s_cmp_eq_u32 s4, 0
    s_cselect_b32 s13, 6144, 0
    v_lshrrev_b32 v80, 5, v0
    v_mul_u32_u24 v80, s13, v80
    s_waitcnt lgkmcnt(2)
    v_mfma_f32_32x32x16_bf16 v[64:79], v[28:31], v[216:219], v[64:79]
    ds_read_b64_tr_b16 v[40:41], v18 offset:22528
    ds_read_b64_tr_b16 v[42:43], v18 offset:23040
    v_and_b32 v81, 31, v0
    v_mul_u32_u24 v81, 48, v81
    s_mul_i32 s12, s4, 1536
    s_add_u32 s12, s12, 147456
    v_add3_u32 v80, v80, v81, s12
    ds_write_b128 v80, v[112:115]
    ds_write_b128 v80, v[116:119] offset:16
    ds_write_b64 v80, v[120:121] offset:32
    v_lshlrev_b32 v96, 16, v224
    v_and_b32 v97, 0xffff0000, v224
    v_lshlrev_b32 v104, 16, v228
    v_and_b32 v105, 0xffff0000, v228
    v_lshlrev_b32 v98, 16, v225
    v_and_b32 v99, 0xffff0000, v225
    v_lshlrev_b32 v106, 16, v229
    v_and_b32 v107, 0xffff0000, v229
    v_lshlrev_b32 v100, 16, v226
    v_and_b32 v101, 0xffff0000, v226
    v_lshlrev_b32 v108, 16, v230
    v_and_b32 v109, 0xffff0000, v230
    v_lshlrev_b32 v102, 16, v227
    v_and_b32 v103, 0xffff0000, v227
    v_lshlrev_b32 v110, 16, v231
    v_and_b32 v111, 0xffff0000, v231
    v_mul_f32 v96, v96, v104
    s_waitcnt vmcnt(9) lgkmcnt(0)
    s_barrier
    v_mfma_f32_32x32x16_bf16 v[48:63], v[220:223], v[36:39], v[48:63]
    ds_read_b128 v[224:227], v10 offset:8192
    ds_read_b128 v[24:27], v14 offset:8192
    s_add_u32 m0, s80, 4096
    s_add_u32 s77, s1, 2
    s_and_b32 s77, s77, 7
    s_mul_i32 s77, s77, 229376
    buffer_load_dwordx4 v6, s[60:63], s77 offen lds
    v_mul_f32 v97, v97, v105
    v_mul_f32 v98, v98, v106
    v_mul_f32 v99, v99, v107
    v_mfma_f32_32x32x16_bf16 v[64:79], v[40:43], v[220:223], v[64:79]
    ds_read_b64_tr_b16 v[28:29], v18 offset:8192
    ds_read_b64_tr_b16 v[30:31], v18 offset:8704
    buffer_load_dwordx4 v7, s[60:63], s77 offen offset:1024 lds
    v_mul_f32 v100, v100, v108
    v_mul_f32 v101, v101, v109
    v_mul_f32 v102, v102, v110
    s_waitcnt lgkmcnt(2)
    v_mfma_f32_32x32x16_bf16 v[48:63], v[224:227], v[24:27], v[48:63]
    ds_read_b128 v[228:231], v11 offset:8192
    ds_read_b128 v[36:39], v15 offset:8192
    s_add_u32 m0, s80, 69632
    s_nop 0
    buffer_load_dwordx4 v8, s[64:67], s77 offen lds
    v_mul_f32 v103, v103, v111
    v_cvt_pk_bf16_f32 v104, v96, v97
    v_cvt_pk_bf16_f32 v105, v98, v99
    s_waitcnt lgkmcnt(2)
    v_mfma_f32_32x32x16_bf16 v[64:79], v[28:31], v[224:227], v[64:79]
    ds_read_b64_tr_b16 v[40:41], v18 offset:10240
    ds_read_b64_tr_b16 v[42:43], v18 offset:10752
    v_cvt_pk_bf16_f32 v106, v100, v101
    v_cvt_pk_bf16_f32 v107, v102, v103
    v_lshlrev_b32 v96, 16, v104
    s_waitcnt lgkmcnt(2)
    v_mfma_f32_32x32x16_bf16 v[48:63], v[228:231], v[36:39], v[48:63]
    ds_read_b128 v[232:235], v12 offset:8192
    ds_read_b128 v[24:27], v16 offset:8192
    buffer_load_dwordx4 v9, s[64:67], s77 offen offset:1024 lds
    v_and_b32 v97, 0xffff0000, v104
    v_lshlrev_b32 v98, 16, v105
    v_and_b32 v99, 0xffff0000, v105
    s_waitcnt lgkmcnt(2)
    v_mfma_f32_32x32x16_bf16 v[64:79], v[40:43], v[228:231], v[64:79]
    ds_read_b64_tr_b16 v[28:29], v18 offset:24576
    ds_read_b64_tr_b16 v[30:31], v18 offset:25088
    v_lshlrev_b32 v100, 16, v106
    v_and_b32 v101, 0xffff0000, v106
    v_lshlrev_b32 v102, 16, v107
    s_waitcnt lgkmcnt(2)
    v_mfma_f32_32x32x16_bf16 v[48:63], v[232:235], v[24:27], v[48:63]
    ds_read_b128 v[236:239], v13 offset:8192
    ds_read_b128 v[36:39], v17 offset:8192
    v_and_b32 v103, 0xffff0000, v107
    v_add_f32 v96, v96, v100
    v_add_f32 v97, v97, v101
    s_waitcnt lgkmcnt(2)
    v_mfma_f32_32x32x16_bf16 v[64:79], v[28:31], v[232:235], v[64:79]
    ds_read_b64_tr_b16 v[40:41], v18 offset:26624
    ds_read_b64_tr_b16 v[42:43], v18 offset:27136
    v_add_f32 v98, v98, v102
    v_add_f32 v99, v99, v103
    v_add_f32 v96, v96, v98
    s_waitcnt vmcnt(8) lgkmcnt(0)
    s_barrier
    v_mfma_f32_32x32x16_bf16 v[48:63], v[236:239], v[36:39], v[48:63]
    ds_read_b128 v[240:243], v10 offset:12288
    ds_read_b128 v[24:27], v14 offset:12288
    s_add_u32 m0, s80, 8192
    s_add_u32 s77, s1, 4
    s_and_b32 s77, s77, 7
    s_mul_i32 s77, s77, 229376
    buffer_load_dwordx4 v6, s[60:63], s77 offen lds
    v_add_f32 v97, v97, v99
    v_add_f32 v96, v96, v97
    s_nop 1
    v_add_f32_dpp v97, v96, v96 quad_perm:[1,0,3,2] row_mask:0xf bank_mask:0xf
    v_mfma_f32_32x32x16_bf16 v[64:79], v[40:43], v[236:239], v[64:79]
    ds_read_b64_tr_b16 v[28:29], v18 offset:12288
    ds_read_b64_tr_b16 v[30:31], v18 offset:12800
    buffer_load_dwordx4 v7, s[60:63], s77 offen offset:1024 lds
    s_nop 1
    v_add_f32_dpp v96, v97, v97 quad_perm:[2,3,0,1] row_mask:0xf bank_mask:0xf
    s_nop 1
    v_add_f32_dpp v97, v96, v96 row_half_mirror row_mask:0xf bank_mask:0xf
    s_nop 1
    v_add_f32_dpp v96, v97, v97 row_mirror row_mask:0xf bank_mask:0xf
    s_waitcnt lgkmcnt(2)
    v_mfma_f32_32x32x16_bf16 v[48:63], v[240:243], v[24:27], v[48:63]
    ds_read_b128 v[244:247], v11 offset:12288
    ds_read_b128 v[36:39], v15 offset:12288
    s_add_u32 m0, s80, 73728
    s_nop 0
    buffer_load_dwordx4 v8, s[64:67], s77 offen lds
    s_nop 0
    v_readlane_b32 s12, v96, 16
    v_readlane_b32 s13, v96, 32
    v_readlane_b32 s14, v96, 48
    s_nop 1
    v_add_f32 v96, s12, v96
    v_mov_b32 v97, s13
    v_add_f32 v97, s14, v97
    v_add_f32 v96, v96, v97
    v_cvt_pk_bf16_f32 v96, v96, v96
    s_waitcnt lgkmcnt(2)
    v_mfma_f32_32x32x16_bf16 v[64:79], v[28:31], v[240:243], v[64:79]
    ds_read_b64_tr_b16 v[40:41], v18 offset:14336
    ds_read_b64_tr_b16 v[42:43], v18 offset:14848
    v_lshlrev_b32 v96, 16, v96
    v_mul_f32 v96, s81, v96
    v_exp_f32 v96, v96
    s_waitcnt lgkmcnt(2)
    v_mfma_f32_32x32x16_bf16 v[48:63], v[244:247], v[36:39], v[48:63]
    ds_read_b128 v[248:251], v12 offset:12288
    ds_read_b128 v[24:27], v16 offset:12288
    buffer_load_dwordx4 v9, s[64:67], s77 offen offset:1024 lds
    s_lshl_b32 s12, s3, 2
    s_add_u32 s12, s12, 161856
    v_mov_b32 v97, s12
    v_add_f32 v96, 1.0, v96
    v_rcp_f32 v96, v96
    s_waitcnt lgkmcnt(2)
    v_mfma_f32_32x32x16_bf16 v[64:79], v[40:43], v[244:247], v[64:79]
    ds_read_b64_tr_b16 v[28:29], v18 offset:28672
    ds_read_b64_tr_b16 v[30:31], v18 offset:29184
    s_nop 0
    v_cvt_pk_bf16_f32 v96, v96, v96
    v_lshlrev_b32 v96, 16, v96
    s_mov_b64 exec, 1
    ds_write_b32 v97, v96
    s_mov_b64 exec, -1
    s_waitcnt lgkmcnt(3)
    v_mfma_f32_32x32x16_bf16 v[48:63], v[248:251], v[24:27], v[48:63]
    ds_read_b128 v[252:255], v13 offset:12288
    ds_read_b128 v[36:39], v17 offset:12288
    s_waitcnt lgkmcnt(3)
    v_mfma_f32_32x32x16_bf16 v[64:79], v[28:31], v[248:251], v[64:79]
    ds_read_b64_tr_b16 v[40:41], v18 offset:30720
    ds_read_b64_tr_b16 v[42:43], v18 offset:31232
    s_waitcnt vmcnt(8) lgkmcnt(0)
    s_barrier
    v_mfma_f32_32x32x16_bf16 v[48:63], v[252:255], v[36:39], v[48:63]
    ds_read_b64_tr_b16 v[24:25], v21 offset:0
    ds_read_b64_tr_b16 v[26:27], v21 offset:512
    s_add_u32 m0, s80, 12288
    s_add_u32 s77, s1, 6
    s_and_b32 s77, s77, 7
    s_mul_i32 s77, s77, 229376
    buffer_load_dwordx4 v6, s[60:63], s77 offen lds
    v_mfma_f32_32x32x16_bf16 v[64:79], v[40:43], v[252:255], v[64:79]
    ds_read_b64_tr_b16 v[28:29], v22 offset:0
    ds_read_b64_tr_b16 v[30:31], v22 offset:512
    buffer_load_dwordx4 v7, s[60:63], s77 offen offset:1024 lds
    s_setprio 1
    s_waitcnt lgkmcnt(2)
    v_mfma_f32_32x32x16_bf16 v[96:111], v[24:27], v[128:131], 0
    ds_read_b64_tr_b16 v[32:33], v21 offset:2048
    ds_read_b64_tr_b16 v[34:35], v21 offset:2560
    s_add_u32 m0, s80, 77824
    s_nop 0
    buffer_load_dwordx4 v8, s[64:67], s77 offen lds
    s_waitcnt lgkmcnt(2)
    v_mfma_f32_32x32x16_bf16 v[112:127], v[28:31], v[128:131], 0
    ds_read_b64_tr_b16 v[36:37], v22 offset:2048
    ds_read_b64_tr_b16 v[38:39], v22 offset:2560
    s_waitcnt lgkmcnt(2)
    v_mfma_f32_32x32x16_bf16 v[96:111], v[32:35], v[132:135], v[96:111]
    ds_read_b64_tr_b16 v[24:25], v21 offset:16384
    ds_read_b64_tr_b16 v[26:27], v21 offset:16896
    buffer_load_dwordx4 v9, s[64:67], s77 offen offset:1024 lds
    v_and_b32 v20, 31, v0
    v_mul_u32_u24 v20, 48, v20
    v_add_u32 v20, 147456, v20
    ds_read_b64 v[40:41], v20 offset:0
    v_lshlrev_b32 v1, 2, v0
    s_lshl_b32 s12, s4, 8
    s_add_u32 s12, s12, 131072
    v_add_u32 v1, s12, v1
    s_waitcnt lgkmcnt(3)
    v_mfma_f32_32x32x16_bf16 v[112:127], v[36:39], v[132:135], v[112:127]
    ds_read_b64_tr_b16 v[28:29], v22 offset:16384
    ds_read_b64_tr_b16 v[30:31], v22 offset:16896
    v_mov_b32 v2, 0
    ds_write_b32 v1, v2 offset:0
    s_nop 3
    s_waitcnt lgkmcnt(3)
    v_fma_f32 v11, v40, v48, v49
    s_nop 0
    v_fmac_f32_dpp v11, v48, v41 quad_perm:[1,0,3,2] row_mask:0xf bank_mask:0xf
    v_fma_f32 v10, v40, v11, v50
    s_nop 0
    v_fmac_f32_dpp v10, v11, v41 quad_perm:[1,0,3,2] row_mask:0xf bank_mask:0xf
    v_fma_f32 v11, v40, v10, v51
    s_nop 0
    v_fmac_f32_dpp v11, v10, v41 quad_perm:[1,0,3,2] row_mask:0xf bank_mask:0xf
    v_fma_f32 v10, v40, v11, v52
    s_nop 0
    v_fmac_f32_dpp v10, v11, v41 quad_perm:[1,0,3,2] row_mask:0xf bank_mask:0xf
    v_fma_f32 v11, v40, v10, v53
    s_nop 0
    v_fmac_f32_dpp v11, v10, v41 quad_perm:[1,0,3,2] row_mask:0xf bank_mask:0xf
    v_fma_f32 v10, v40, v11, v54
    s_nop 0
    v_fmac_f32_dpp v10, v11, v41 quad_perm:[1,0,3,2] row_mask:0xf bank_mask:0xf
    v_fma_f32 v11, v40, v10, v55
    s_nop 0
    v_fmac_f32_dpp v11, v10, v41 quad_perm:[1,0,3,2] row_mask:0xf bank_mask:0xf
    v_fma_f32 v10, v40, v11, v56
    s_nop 0
    v_fmac_f32_dpp v10, v11, v41 quad_perm:[1,0,3,2] row_mask:0xf bank_mask:0xf
    v_fma_f32 v11, v40, v10, v57
    s_nop 0
    v_fmac_f32_dpp v11, v10, v41 quad_perm:[1,0,3,2] row_mask:0xf bank_mask:0xf
    v_fma_f32 v10, v40, v11, v58
    s_nop 0
    v_fmac_f32_dpp v10, v11, v41 quad_perm:[1,0,3,2] row_mask:0xf bank_mask:0xf
    v_fma_f32 v11, v40, v10, v59
    s_nop 0
    v_fmac_f32_dpp v11, v10, v41 quad_perm:[1,0,3,2] row_mask:0xf bank_mask:0xf
    v_fma_f32 v10, v40, v11, v60
    s_nop 0
    v_fmac_f32_dpp v10, v11, v41 quad_perm:[1,0,3,2] row_mask:0xf bank_mask:0xf
    v_fma_f32 v11, v40, v10, v61
    s_nop 0
    v_fmac_f32_dpp v11, v10, v41 quad_perm:[1,0,3,2] row_mask:0xf bank_mask:0xf
    v_fma_f32 v10, v40, v11, v62
    s_nop 0
    v_fmac_f32_dpp v10, v11, v41 quad_perm:[1,0,3,2] row_mask:0xf bank_mask:0xf
    v_fma_f32 v11, v40, v10, v63
    s_nop 0
    v_fmac_f32_dpp v11, v10, v41 quad_perm:[1,0,3,2] row_mask:0xf bank_mask:0xf
    ds_write_b32 v1, v11 offset:1024
    s_add_u32 s12, s4, 0
    s_mul_i32 s13, s12, 1536
    v_add_u32 v3, s13, v20
    s_lshl_b32 s13, s12, 11
    s_add_u32 s13, s13, 131072
    v_and_b32 v2, 31, v0
    v_lshlrev_b32 v4, 3, v2
    v_lshl_add_u32 v2, v2, 2, s13
    s_waitcnt lgkmcnt(0)
    s_barrier
    s_cmp_ge_u32 s4, 1
    s_cbranch_scc1 L_pub_skip_6
    ds_read_b64 v[10:11], v3 offset:8
    ds_read_b32 v12, v2 offset:1024
    ds_read_b32 v13, v2 offset:1152
    ds_read_b32 v14, v2 offset:1280
    ds_read_b32 v15, v2 offset:1408
    ds_read_b32 v16, v2 offset:1536
    ds_read_b32 v17, v2 offset:1664
    ds_read_b32 v18, v2 offset:1792
    ds_read_b32 v19, v2 offset:1920
    s_add_u32 s12, s93, 4096
    s_waitcnt lgkmcnt(0)
    v_fmac_f32 v13, v10, v12
    s_nop 0
    v_fmac_f32_dpp v13, v12, v11 quad_perm:[1,0,3,2] row_mask:0xf bank_mask:0xf
    v_fmac_f32 v14, v10, v13
    s_nop 0
    v_fmac_f32_dpp v14, v13, v11 quad_perm:[1,0,3,2] row_mask:0xf bank_mask:0xf
    v_fmac_f32 v15, v10, v14
    s_nop 0
    v_fmac_f32_dpp v15, v14, v11 quad_perm:[1,0,3,2] row_mask:0xf bank_mask:0xf
    v_fmac_f32 v16, v10, v15
    s_nop 0
    v_fmac_f32_dpp v16, v15, v11 quad_perm:[1,0,3,2] row_mask:0xf bank_mask:0xf
    v_fmac_f32 v17, v10, v16
    s_nop 0
    v_fmac_f32_dpp v17, v16, v11 quad_perm:[1,0,3,2] row_mask:0xf bank_mask:0xf
    v_fmac_f32 v18, v10, v17
    s_nop 0
    v_fmac_f32_dpp v18, v17, v11 quad_perm:[1,0,3,2] row_mask:0xf bank_mask:0xf
    v_fmac_f32 v19, v10, v18
    s_nop 0
    v_fmac_f32_dpp v19, v18, v11 quad_perm:[1,0,3,2] row_mask:0xf bank_mask:0xf
    v_mov_b32 v11, s34
    v_mov_b32 v10, v19
    s_mov_b32 exec_hi, 0
    buffer_store_dwordx2 v[10:11], v4, s[68:71], s12 offen sc1
    s_mov_b64 exec, -1
L_pub_skip_6:
    v_lshrrev_b32 v12, 5, v0
    v_sub_u32 v12, 1, v12
    v_lshl_add_u32 v4, v12, 8, v4
    v_mfma_f32_32x32x16_bf16 v[96:111], v[24:27], v[136:139], v[96:111]
    ds_read_b64_tr_b16 v[32:33], v21 offset:18432
    ds_read_b64_tr_b16 v[34:35], v21 offset:18944
    v_pk_mul_f32 v[40:41], s[80:81], v[64:65] op_sel:[1,0] op_sel_hi:[1,1]
    v_pk_mul_f32 v[42:43], s[80:81], v[66:67] op_sel:[1,0] op_sel_hi:[1,1]
    v_pk_mul_f32 v[44:45], s[80:81], v[68:69] op_sel:[1,0] op_sel_hi:[1,1]
    v_pk_mul_f32 v[46:47], s[80:81], v[70:71] op_sel:[1,0] op_sel_hi:[1,1]
    v_exp_f32 v40, v40
    v_exp_f32 v41, v41
    v_mfma_f32_32x32x16_bf16 v[112:127], v[28:31], v[136:139], v[112:127]
    ds_read_b64_tr_b16 v[36:37], v22 offset:18432
    ds_read_b64_tr_b16 v[38:39], v22 offset:18944
    v_pk_mul_f32 v[72:73], v[64:65], v[72:73]
    v_exp_f32 v42, v42
    v_exp_f32 v43, v43
    v_pk_mul_f32 v[74:75], v[66:67], v[74:75]
    v_exp_f32 v44, v44
    v_exp_f32 v45, v45
    s_waitcnt lgkmcnt(2)
    v_mfma_f32_32x32x16_bf16 v[96:111], v[32:35], v[140:143], v[96:111]
    ds_read_b64_tr_b16 v[24:25], v21 offset:32768
    ds_read_b64_tr_b16 v[26:27], v21 offset:33280
    v_pk_mul_f32 v[76:77], v[68:69], v[76:77]
    v_exp_f32 v46, v46
    v_exp_f32 v47, v47
    v_pk_mul_f32 v[78:79], v[70:71], v[78:79]
    v_pk_add_f32 v[40:41], v[40:41], 1.0 op_sel_hi:[1,0]
    v_pk_add_f32 v[42:43], v[42:43], 1.0 op_sel_hi:[1,0]
    s_waitcnt lgkmcnt(2)
    v_mfma_f32_32x32x16_bf16 v[112:127], v[36:39], v[140:143], v[112:127]
    ds_read_b64_tr_b16 v[28:29], v22 offset:32768
    ds_read_b64_tr_b16 v[30:31], v22 offset:33280
    v_pk_add_f32 v[44:45], v[44:45], 1.0 op_sel_hi:[1,0]
    v_pk_add_f32 v[46:47], v[46:47], 1.0 op_sel_hi:[1,0]
    v_rcp_f32 v40, v40
    v_rcp_f32 v41, v41
    v_rcp_f32 v42, v42
    v_rcp_f32 v43, v43
    v_lshrrev_b32 v6, 3, v0
    v_lshrrev_b32 v7, 4, v0
    v_and_b32 v8, 7, v0
    v_xor_b32 v7, v7, v8
    v_lshlrev_b32 v7, 4, v7
    v_lshl_add_u32 v6, v6, 10, v7
    v_xor_b32 v7, 64, v6
    v_add_u32 v7, 7168, v7
    v_and_b32 v8, 31, v0
    v_lshlrev_b32 v8, 7, v8
    v_bfe_u32 v9, v0, 1, 3
    v_lshl_add_u32 v8, v9, 4, v8
    v_lshrrev_b32 v9, 5, v0
    v_lshl_add_u32 v8, v9, 12, v8
    v_add_u32 v8, s94, v8
    s_mov_b32 s72, s26
    s_and_b32 s73, s27, 0xffff
    s_mov_b32 s74, 524288
    s_mov_b32 s75, 0x00020000
    s_mov_b32 s56, s28
    s_and_b32 s57, s29, 0xffff
    s_mov_b32 s58, 524288
    s_mov_b32 s59, 0x00020000
    s_and_b32 s15, s50, 7
    s_lshl_b32 s15, s15, 10
    s_add_u32 s15, s15, s95
    s_sub_u32 s14, 3, s8
    s_lshl_b32 s14, s14, 16
    s_add_u32 s14, s14, s15
    v_and_b32 v128, 7, v0
    v_mul_u32_u24 v128, 3, v128
    v_add_u32 v128, s8, v128
    v_min_u32 v128, 7, v128
    v_lshlrev_b32 v128, 13, v128
    v_bfe_u32 v131, v0, 3, 1
    v_lshl_add_u32 v128, v131, 7, v128
    buffer_load_dword v129, v128, s[72:75], s14 offen
    buffer_load_dword v130, v128, s[56:59], s14 offen
    v_and_b32 v128, 7, v0
    v_lshlrev_b32 v128, 13, v128
    v_bfe_u32 v131, v0, 3, 1
    v_lshl_add_u32 v128, v131, 7, v128
    buffer_load_dword v129, v128, s[72:75], s15 offen
    buffer_load_dword v130, v128, s[56:59], s15 offen
    s_waitcnt lgkmcnt(2)
    v_mfma_f32_32x32x16_bf16 v[96:111], v[24:27], v[144:147], v[96:111]
    ds_read_b64_tr_b16 v[32:33], v21 offset:34816
    ds_read_b64_tr_b16 v[34:35], v21 offset:35328
    v_pk_mul_f32 v[72:73], v[72:73], v[40:41]
    v_rcp_f32 v44, v44
    v_rcp_f32 v45, v45
    v_pk_mul_f32 v[74:75], v[74:75], v[42:43]
    v_rcp_f32 v46, v46
    v_rcp_f32 v47, v47
    s_waitcnt lgkmcnt(2)
    v_mfma_f32_32x32x16_bf16 v[112:127], v[28:31], v[144:147], v[112:127]
    ds_read_b64_tr_b16 v[36:37], v22 offset:34816
    ds_read_b64_tr_b16 v[38:39], v22 offset:35328
    v_pk_mul_f32 v[76:77], v[76:77], v[44:45]
    v_pk_mul_f32 v[78:79], v[78:79], v[46:47]
    v_cvt_pk_bf16_f32 v64, v72, v73
    v_cvt_pk_bf16_f32 v65, v74, v75
    v_cvt_pk_bf16_f32 v66, v76, v77
    v_cvt_pk_bf16_f32 v67, v78, v79
    s_waitcnt lgkmcnt(2)
    v_mfma_f32_32x32x16_bf16 v[96:111], v[32:35], v[148:151], v[96:111]
    ds_read_b64_tr_b16 v[24:25], v21 offset:49152
    ds_read_b64_tr_b16 v[26:27], v21 offset:49664
    s_waitcnt lgkmcnt(2)
    v_mfma_f32_32x32x16_bf16 v[112:127], v[36:39], v[148:151], v[112:127]
    ds_read_b64_tr_b16 v[28:29], v22 offset:49152
    ds_read_b64_tr_b16 v[30:31], v22 offset:49664
    s_waitcnt lgkmcnt(2)
    v_mfma_f32_32x32x16_bf16 v[96:111], v[24:27], v[152:155], v[96:111]
    ds_read_b64_tr_b16 v[32:33], v21 offset:51200
    ds_read_b64_tr_b16 v[34:35], v21 offset:51712
    s_waitcnt lgkmcnt(2)
    v_mfma_f32_32x32x16_bf16 v[112:127], v[28:31], v[152:155], v[112:127]
    ds_read_b64_tr_b16 v[36:37], v22 offset:51200
    ds_read_b64_tr_b16 v[38:39], v22 offset:51712
    s_waitcnt vmcnt(12) lgkmcnt(0)
    s_barrier
    v_mfma_f32_32x32x16_bf16 v[96:111], v[32:35], v[156:159], v[96:111]
    ds_read_b64_tr_b16 v[24:25], v21 offset:4096
    ds_read_b64_tr_b16 v[26:27], v21 offset:4608
    v_mfma_f32_32x32x16_bf16 v[112:127], v[36:39], v[156:159], v[112:127]
    ds_read_b64_tr_b16 v[28:29], v22 offset:4096
    ds_read_b64_tr_b16 v[30:31], v22 offset:4608
    s_waitcnt lgkmcnt(2)
    v_mfma_f32_32x32x16_bf16 v[96:111], v[24:27], v[160:163], v[96:111]
    ds_read_b64_tr_b16 v[32:33], v21 offset:6144
    ds_read_b64_tr_b16 v[34:35], v21 offset:6656
    s_waitcnt lgkmcnt(2)
    v_mfma_f32_32x32x16_bf16 v[112:127], v[28:31], v[160:163], v[112:127]
    ds_read_b64_tr_b16 v[36:37], v22 offset:6144
    ds_read_b64_tr_b16 v[38:39], v22 offset:6656
    s_waitcnt lgkmcnt(2)
    v_mfma_f32_32x32x16_bf16 v[96:111], v[32:35], v[164:167], v[96:111]
    ds_read_b64_tr_b16 v[24:25], v21 offset:20480
    ds_read_b64_tr_b16 v[26:27], v21 offset:20992
    s_waitcnt lgkmcnt(2)
    v_mfma_f32_32x32x16_bf16 v[112:127], v[36:39], v[164:167], v[112:127]
    ds_read_b64_tr_b16 v[28:29], v22 offset:20480
    ds_read_b64_tr_b16 v[30:31], v22 offset:20992
    s_waitcnt lgkmcnt(2)
    v_mfma_f32_32x32x16_bf16 v[96:111], v[24:27], v[168:171], v[96:111]
    ds_read_b64_tr_b16 v[32:33], v21 offset:22528
    ds_read_b64_tr_b16 v[34:35], v21 offset:23040
    s_waitcnt lgkmcnt(2)
    v_mfma_f32_32x32x16_bf16 v[112:127], v[28:31], v[168:171], v[112:127]
    ds_read_b64_tr_b16 v[36:37], v22 offset:22528
    ds_read_b64_tr_b16 v[38:39], v22 offset:23040
    s_waitcnt lgkmcnt(2)
    v_mfma_f32_32x32x16_bf16 v[96:111], v[32:35], v[172:175], v[96:111]
    ds_read_b64_tr_b16 v[24:25], v21 offset:36864
    ds_read_b64_tr_b16 v[26:27], v21 offset:37376
    s_waitcnt lgkmcnt(2)
    v_mfma_f32_32x32x16_bf16 v[112:127], v[36:39], v[172:175], v[112:127]
    ds_read_b64_tr_b16 v[28:29], v22 offset:36864
    ds_read_b64_tr_b16 v[30:31], v22 offset:37376
    s_cmp_ge_u32 s4, 1
    s_cbranch_scc1 L_grl_skip_7
    s_cmp_eq_u32 s6, 0
    s_cbranch_scc1 L_grl_skip_7
    s_add_u32 s13, s6, 1
    s_lshr_b32 s13, s13, 1
    buffer_load_dwordx2 v[136:137], v4, s[68:71], s93 offen offset:3584 sc1
    s_cmp_eq_u32 s13, 1
    s_cbranch_scc1 L_grl_skip_7
    buffer_load_dwordx2 v[138:139], v4, s[68:71], s93 offen offset:3072 sc1
    s_cmp_eq_u32 s13, 2
    s_cbranch_scc1 L_grl_skip_7
    buffer_load_dwordx2 v[140:141], v4, s[68:71], s93 offen offset:2560 sc1
    s_cmp_eq_u32 s13, 3
    s_cbranch_scc1 L_grl_skip_7
    buffer_load_dwordx2 v[142:143], v4, s[68:71], s93 offen offset:2048 sc1
    s_cmp_eq_u32 s13, 4
    s_cbranch_scc1 L_grl_skip_7
    buffer_load_dwordx2 v[144:145], v4, s[68:71], s93 offen offset:1536 sc1
    s_cmp_eq_u32 s13, 5
    s_cbranch_scc1 L_grl_skip_7
    buffer_load_dwordx2 v[146:147], v4, s[68:71], s93 offen offset:1024 sc1
    s_cmp_eq_u32 s13, 6
    s_cbranch_scc1 L_grl_skip_7
    buffer_load_dwordx2 v[148:149], v4, s[68:71], s93 offen offset:512 sc1
    s_cmp_eq_u32 s13, 7
    s_cbranch_scc1 L_grl_skip_7
    buffer_load_dwordx2 v[150:151], v4, s[68:71], s93 offen offset:0 sc1
L_grl_skip_7:
    s_waitcnt lgkmcnt(2)
    v_mfma_f32_32x32x16_bf16 v[96:111], v[24:27], v[176:179], v[96:111]
    ds_read_b64_tr_b16 v[32:33], v21 offset:38912
    ds_read_b64_tr_b16 v[34:35], v21 offset:39424
    s_waitcnt lgkmcnt(2)
    v_mfma_f32_32x32x16_bf16 v[112:127], v[28:31], v[176:179], v[112:127]
    ds_read_b64_tr_b16 v[36:37], v22 offset:38912
    ds_read_b64_tr_b16 v[38:39], v22 offset:39424
    s_waitcnt lgkmcnt(2)
    v_mfma_f32_32x32x16_bf16 v[96:111], v[32:35], v[180:183], v[96:111]
    ds_read_b64_tr_b16 v[24:25], v21 offset:53248
    ds_read_b64_tr_b16 v[26:27], v21 offset:53760
    s_waitcnt lgkmcnt(2)
    v_mfma_f32_32x32x16_bf16 v[112:127], v[36:39], v[180:183], v[112:127]
    ds_read_b64_tr_b16 v[28:29], v22 offset:53248
    ds_read_b64_tr_b16 v[30:31], v22 offset:53760
    s_waitcnt lgkmcnt(2)
    v_mfma_f32_32x32x16_bf16 v[96:111], v[24:27], v[184:187], v[96:111]
    ds_read_b64_tr_b16 v[32:33], v21 offset:55296
    ds_read_b64_tr_b16 v[34:35], v21 offset:55808
    s_waitcnt lgkmcnt(2)
    v_mfma_f32_32x32x16_bf16 v[112:127], v[28:31], v[184:187], v[112:127]
    ds_read_b64_tr_b16 v[36:37], v22 offset:55296
    ds_read_b64_tr_b16 v[38:39], v22 offset:55808
    s_waitcnt vmcnt(8) lgkmcnt(0)
    s_barrier
    v_mfma_f32_32x32x16_bf16 v[96:111], v[32:35], v[188:191], v[96:111]
    ds_read_b64_tr_b16 v[24:25], v21 offset:8192
    ds_read_b64_tr_b16 v[26:27], v21 offset:8704
    v_mfma_f32_32x32x16_bf16 v[112:127], v[36:39], v[188:191], v[112:127]
    ds_read_b64_tr_b16 v[28:29], v22 offset:8192
    ds_read_b64_tr_b16 v[30:31], v22 offset:8704
    s_waitcnt lgkmcnt(2)
    v_mfma_f32_32x32x16_bf16 v[96:111], v[24:27], v[192:195], v[96:111]
    ds_read_b64_tr_b16 v[32:33], v21 offset:10240
    ds_read_b64_tr_b16 v[34:35], v21 offset:10752
    s_waitcnt lgkmcnt(2)
    v_mfma_f32_32x32x16_bf16 v[112:127], v[28:31], v[192:195], v[112:127]
    ds_read_b64_tr_b16 v[36:37], v22 offset:10240
    ds_read_b64_tr_b16 v[38:39], v22 offset:10752
    s_cmp_ge_u32 s4, 1
    s_cbranch_scc1 L_car_skip_8
    s_cmp_eq_u32 s6, 0
    s_cbranch_scc1 L_car_skip_8
    ds_read_b128 v[152:155], v3 offset:16
    s_add_u32 s13, s6, 1
    s_lshr_b32 s13, s13, 1
    s_bitcmp1_b32 s6, 0
    s_cselect_b32 s89, 0, -1
    s_mov_b32 s88, -1
    s_mov_b32 s86, 0
    s_waitcnt vmcnt(0)
L_car_poll_9:
    s_mov_b64 s[90:91], 0
    v_cmp_ne_u32 vcc, s34, v137
    s_cmp_eq_u32 s13, 1
    s_cbranch_scc1 L_car_chk_10
    s_or_b64 s[90:91], s[90:91], vcc
    v_cmp_ne_u32 vcc, s34, v139
    s_cmp_eq_u32 s13, 2
    s_cbranch_scc1 L_car_chk_10
    s_or_b64 s[90:91], s[90:91], vcc
    v_cmp_ne_u32 vcc, s34, v141
    s_cmp_eq_u32 s13, 3
    s_cbranch_scc1 L_car_chk_10
    s_or_b64 s[90:91], s[90:91], vcc
    v_cmp_ne_u32 vcc, s34, v143
    s_cmp_eq_u32 s13, 4
    s_cbranch_scc1 L_car_chk_10
    s_or_b64 s[90:91], s[90:91], vcc
    v_cmp_ne_u32 vcc, s34, v145
    s_cmp_eq_u32 s13, 5
    s_cbranch_scc1 L_car_chk_10
    s_or_b64 s[90:91], s[90:91], vcc
    v_cmp_ne_u32 vcc, s34, v147
    s_cmp_eq_u32 s13, 6
    s_cbranch_scc1 L_car_chk_10
    s_or_b64 s[90:91], s[90:91], vcc
    v_cmp_ne_u32 vcc, s34, v149
    s_cmp_eq_u32 s13, 7
    s_cbranch_scc1 L_car_chk_10
    s_or_b64 s[90:91], s[90:91], vcc
    v_cmp_ne_u32 vcc, s34, v151
L_car_chk_10:
    s_and_b64 vcc, vcc, s[88:89]
    s_or_b64 s[90:91], s[90:91], vcc
    s_cbranch_scc0 L_car_ok_11
    s_add_u32 s86, s86, 1
    s_cmp_ge_u32 s86, 0x4000
    s_cbranch_scc1 L_car_ok_11
    s_sleep 1
    buffer_load_dwordx2 v[136:137], v4, s[68:71], s93 offen offset:3584 sc1
    s_cmp_eq_u32 s13, 1
    s_cbranch_scc1 L_car_re_12
    buffer_load_dwordx2 v[138:139], v4, s[68:71], s93 offen offset:3072 sc1
    s_cmp_eq_u32 s13, 2
    s_cbranch_scc1 L_car_re_12
    buffer_load_dwordx2 v[140:141], v4, s[68:71], s93 offen offset:2560 sc1
    s_cmp_eq_u32 s13, 3
    s_cbranch_scc1 L_car_re_12
    buffer_load_dwordx2 v[142:143], v4, s[68:71], s93 offen offset:2048 sc1
    s_cmp_eq_u32 s13, 4
    s_cbranch_scc1 L_car_re_12
    buffer_load_dwordx2 v[144:145], v4, s[68:71], s93 offen offset:1536 sc1
    s_cmp_eq_u32 s13, 5
    s_cbranch_scc1 L_car_re_12
    buffer_load_dwordx2 v[146:147], v4, s[68:71], s93 offen offset:1024 sc1
    s_cmp_eq_u32 s13, 6
    s_cbranch_scc1 L_car_re_12
    buffer_load_dwordx2 v[148:149], v4, s[68:71], s93 offen offset:512 sc1
    s_cmp_eq_u32 s13, 7
    s_cbranch_scc1 L_car_re_12
    buffer_load_dwordx2 v[150:151], v4, s[68:71], s93 offen offset:0 sc1
L_car_re_12:
    s_waitcnt vmcnt(0)
    s_branch L_car_poll_9
L_car_ok_11:
    s_waitcnt lgkmcnt(0)
    v_mov_b32 v156, 0
    s_cmp_le_u32 s13, 7
    s_cbranch_scc1 L_hs_13
    s_cmp_eq_u32 s13, 8
    s_cselect_b64 vcc, s[88:89], -1
    v_cndmask_b32 v150, 0, v150, vcc
    v_fmac_f32 v150, v154, v156
    v_fmac_f32_dpp v150, v156, v155 quad_perm:[1,0,3,2] row_mask:0xf bank_mask:0xf
    v_mov_b32 v156, v150
L_hs_13:
    s_cmp_le_u32 s13, 6
    s_cbranch_scc1 L_hs_14
    s_cmp_eq_u32 s13, 7
    s_cselect_b64 vcc, s[88:89], -1
    v_cndmask_b32 v148, 0, v148, vcc
    v_fmac_f32 v148, v154, v156
    v_fmac_f32_dpp v148, v156, v155 quad_perm:[1,0,3,2] row_mask:0xf bank_mask:0xf
    v_mov_b32 v156, v148
L_hs_14:
    s_cmp_le_u32 s13, 5
    s_cbranch_scc1 L_hs_15
    s_cmp_eq_u32 s13, 6
    s_cselect_b64 vcc, s[88:89], -1
    v_cndmask_b32 v146, 0, v146, vcc
    v_fmac_f32 v146, v154, v156
    v_fmac_f32_dpp v146, v156, v155 quad_perm:[1,0,3,2] row_mask:0xf bank_mask:0xf
    v_mov_b32 v156, v146
L_hs_15:
    s_cmp_le_u32 s13, 4
    s_cbranch_scc1 L_hs_16
    s_cmp_eq_u32 s13, 5
    s_cselect_b64 vcc, s[88:89], -1
    v_cndmask_b32 v144, 0, v144, vcc
    v_fmac_f32 v144, v154, v156
    v_fmac_f32_dpp v144, v156, v155 quad_perm:[1,0,3,2] row_mask:0xf bank_mask:0xf
    v_mov_b32 v156, v144
L_hs_16:
    s_cmp_le_u32 s13, 3
    s_cbranch_scc1 L_hs_17
    s_cmp_eq_u32 s13, 4
    s_cselect_b64 vcc, s[88:89], -1
    v_cndmask_b32 v142, 0, v142, vcc
    v_fmac_f32 v142, v154, v156
    v_fmac_f32_dpp v142, v156, v155 quad_perm:[1,0,3,2] row_mask:0xf bank_mask:0xf
    v_mov_b32 v156, v142
L_hs_17:
    s_cmp_le_u32 s13, 2
    s_cbranch_scc1 L_hs_18
    s_cmp_eq_u32 s13, 3
    s_cselect_b64 vcc, s[88:89], -1
    v_cndmask_b32 v140, 0, v140, vcc
    v_fmac_f32 v140, v154, v156
    v_fmac_f32_dpp v140, v156, v155 quad_perm:[1,0,3,2] row_mask:0xf bank_mask:0xf
    v_mov_b32 v156, v140
L_hs_18:
    s_cmp_le_u32 s13, 1
    s_cbranch_scc1 L_hs_19
    s_cmp_eq_u32 s13, 2
    s_cselect_b64 vcc, s[88:89], -1
    v_cndmask_b32 v138, 0, v138, vcc
    v_fmac_f32 v138, v154, v156
    v_fmac_f32_dpp v138, v156, v155 quad_perm:[1,0,3,2] row_mask:0xf bank_mask:0xf
    v_mov_b32 v156, v138
L_hs_19:
    s_cmp_le_u32 s13, 0
    s_cbranch_scc1 L_hs_20
    s_cmp_eq_u32 s13, 1
    s_cselect_b64 vcc, s[88:89], -1
    v_cndmask_b32 v136, 0, v136, vcc
    v_fmac_f32 v136, v154, v156
    v_fmac_f32_dpp v136, v156, v155 quad_perm:[1,0,3,2] row_mask:0xf bank_mask:0xf
    v_mov_b32 v156, v136
L_hs_20:
    s_nop 0
    v_mul_f32 v157, v152, v156
    v_fmac_f32_dpp v157, v156, v153 quad_perm:[1,0,3,2] row_mask:0xf bank_mask:0xf
    v_mov_b32 v158, 0
    s_nop 0
    v_permlane32_swap_b32 v157, v158
    s_nop 0
    v_add_f32 v156, v156, v158
    s_mov_b32 exec_hi, 0
    ds_write_b32 v2, v156 offset:896
    s_mov_b64 exec, -1
    s_waitcnt lgkmcnt(0)
L_car_skip_8:
    s_waitcnt lgkmcnt(2)
    v_mfma_f32_32x32x16_bf16 v[96:111], v[32:35], v[196:199], v[96:111]
    ds_read_b64_tr_b16 v[24:25], v21 offset:24576
    ds_read_b64_tr_b16 v[26:27], v21 offset:25088
    s_waitcnt lgkmcnt(2)
    v_mfma_f32_32x32x16_bf16 v[112:127], v[36:39], v[196:199], v[112:127]
    ds_read_b64_tr_b16 v[28:29], v22 offset:24576
    ds_read_b64_tr_b16 v[30:31], v22 offset:25088
    s_add_u32 m0, s94, 0
    s_add_u32 s15, s95, 0
    buffer_load_dwordx4 v6, s[72:75], s15 offen lds
    buffer_load_dwordx4 v7, s[72:75], s15 offen offset:1024 lds
    s_add_u32 s15, s15, 14336
    buffer_load_dwordx4 v6, s[72:75], s15 offen offset:2048 lds
    buffer_load_dwordx4 v7, s[72:75], s15 offen offset:3072 lds
    s_add_u32 m0, s94, 4096
    s_add_u32 s15, s95, 0
    buffer_load_dwordx4 v6, s[56:59], s15 offen lds
    buffer_load_dwordx4 v7, s[56:59], s15 offen offset:1024 lds
    s_add_u32 s15, s15, 14336
    buffer_load_dwordx4 v6, s[56:59], s15 offen offset:2048 lds
    buffer_load_dwordx4 v7, s[56:59], s15 offen offset:3072 lds
    s_waitcnt lgkmcnt(2)
    v_mfma_f32_32x32x16_bf16 v[96:111], v[24:27], v[200:203], v[96:111]
    ds_read_b64_tr_b16 v[32:33], v21 offset:26624
    ds_read_b64_tr_b16 v[34:35], v21 offset:27136
    s_waitcnt lgkmcnt(2)
    v_mfma_f32_32x32x16_bf16 v[112:127], v[28:31], v[200:203], v[112:127]
    ds_read_b64_tr_b16 v[36:37], v22 offset:26624
    ds_read_b64_tr_b16 v[38:39], v22 offset:27136
    buffer_store_dwordx4 v[64:67], v23, s[68:71], s82 offen sc1
    v_lshlrev_b32 v16, 2, v0
    v_add_u32 v17, 161856, v16
    s_cmp_lg_u32 s4, 0
    s_cbranch_scc1 L_g_skip_21
    s_mov_b64 exec, 0xff
    ds_read_b32 v17, v17
    s_waitcnt lgkmcnt(0)
    buffer_store_dword v17, v16, s[68:71], s87 offen sc1
    s_mov_b64 exec, -1
L_g_skip_21:
    s_waitcnt lgkmcnt(2)
    v_mfma_f32_32x32x16_bf16 v[96:111], v[32:35], v[204:207], v[96:111]
    ds_read_b64_tr_b16 v[24:25], v21 offset:40960
    ds_read_b64_tr_b16 v[26:27], v21 offset:41472
    s_waitcnt lgkmcnt(2)
    v_mfma_f32_32x32x16_bf16 v[112:127], v[36:39], v[204:207], v[112:127]
    ds_read_b64_tr_b16 v[28:29], v22 offset:40960
    ds_read_b64_tr_b16 v[30:31], v22 offset:41472
    s_barrier
    s_waitcnt lgkmcnt(2)
    v_mfma_f32_32x32x16_bf16 v[96:111], v[24:27], v[208:211], v[96:111]
    ds_read_b64_tr_b16 v[32:33], v21 offset:43008
    ds_read_b64_tr_b16 v[34:35], v21 offset:43520
    ds_read_b128 v[136:139], v20 offset:0
    ds_read_b32 v140, v1 offset:0
    ds_read_b32 v141, v1 offset:128
    ds_read_b32 v142, v1 offset:256
    ds_read_b32 v143, v1 offset:384
    ds_read_b32 v144, v1 offset:512
    ds_read_b32 v145, v1 offset:640
    ds_read_b32 v146, v1 offset:768
    ds_read_b32 v147, v1 offset:896
    s_mul_i32 s78, s4, 1280
    s_add_u32 s78, s78, 141312
    v_and_b32 v10, 15, v0
    v_mul_u32_u24 v10, 80, v10
    v_lshrrev_b32 v11, 5, v0
    v_lshl_add_u32 v10, v11, 5, v10
    v_add_u32 v10, s78, v10
    v_bfe_u32 v12, v0, 2, 2
    v_lshl_add_u32 v11, v12, 1, v11
    s_waitcnt lgkmcnt(11)
    v_mfma_f32_32x32x16_bf16 v[112:127], v[28:31], v[208:211], v[112:127]
    ds_read_b64_tr_b16 v[36:37], v22 offset:43008
    ds_read_b64_tr_b16 v[38:39], v22 offset:43520
    v_mul_u32_u24 v11, 80, v11
    v_and_b32 v12, 1, v0
    v_lshl_add_u32 v11, v12, 5, v11
    v_bfe_u32 v12, v0, 4, 1
    v_lshl_add_u32 v11, v12, 4, v11
    v_bfe_u32 v12, v0, 1, 1
    v_lshl_add_u32 v11, v12, 3, v11
    v_add_u32 v11, s78, v11
    ds_read_b64 v[12:13], v20 offset:32
    s_waitcnt lgkmcnt(3)
    v_fmac_f32 v141, v138, v140
    s_nop 0
    v_fmac_f32_dpp v141, v140, v139 quad_perm:[1,0,3,2] row_mask:0xf bank_mask:0xf
    v_fmac_f32 v142, v138, v141
    v_mfma_f32_32x32x16_bf16 v[96:111], v[32:35], v[212:215], v[96:111]
    ds_read_b64_tr_b16 v[24:25], v21 offset:57344
    ds_read_b64_tr_b16 v[26:27], v21 offset:57856
    s_nop 0
    v_fmac_f32_dpp v142, v141, v139 quad_perm:[1,0,3,2] row_mask:0xf bank_mask:0xf
    v_fmac_f32 v143, v138, v142
    s_nop 0
    v_fmac_f32_dpp v143, v142, v139 quad_perm:[1,0,3,2] row_mask:0xf bank_mask:0xf
    v_fmac_f32 v144, v138, v143
    s_nop 0
    v_fmac_f32_dpp v144, v143, v139 quad_perm:[1,0,3,2] row_mask:0xf bank_mask:0xf
    v_fmac_f32 v145, v138, v144
    s_nop 0
    v_fmac_f32_dpp v145, v144, v139 quad_perm:[1,0,3,2] row_mask:0xf bank_mask:0xf
    v_fmac_f32 v146, v138, v145
    s_nop 0
    v_fmac_f32_dpp v146, v145, v139 quad_perm:[1,0,3,2] row_mask:0xf bank_mask:0xf
    v_fmac_f32 v147, v138, v146
    s_nop 0
    v_fmac_f32_dpp v147, v146, v139 quad_perm:[1,0,3,2] row_mask:0xf bank_mask:0xf
    s_waitcnt lgkmcnt(2)
    v_fmac_f32 v48, v136, v147
    v_mfma_f32_32x32x16_bf16 v[112:127], v[36:39], v[212:215], v[112:127]
    ds_read_b64_tr_b16 v[28:29], v22 offset:57344
    ds_read_b64_tr_b16 v[30:31], v22 offset:57856
    s_nop 0
    v_fmac_f32_dpp v48, v147, v137 quad_perm:[1,0,3,2] row_mask:0xf bank_mask:0xf
    v_fmac_f32 v49, v136, v48
    s_nop 0
    v_fmac_f32_dpp v49, v48, v137 quad_perm:[1,0,3,2] row_mask:0xf bank_mask:0xf
    v_fmac_f32 v50, v136, v49
    v_mul_f32 v148, v12, v48
    v_fmac_f32_dpp v148, v48, v13 quad_perm:[1,0,3,2] row_mask:0xf bank_mask:0xf
    v_fmac_f32_dpp v50, v49, v137 quad_perm:[1,0,3,2] row_mask:0xf bank_mask:0xf
    v_fmac_f32 v51, v136, v50
    v_mul_f32 v149, v12, v49
    v_fmac_f32_dpp v149, v49, v13 quad_perm:[1,0,3,2] row_mask:0xf bank_mask:0xf
    v_cvt_pk_bf16_f32 v140, v148, v149
    v_fmac_f32_dpp v51, v50, v137 quad_perm:[1,0,3,2] row_mask:0xf bank_mask:0xf
    v_fmac_f32 v52, v136, v51
    v_mul_f32 v148, v12, v50
    v_fmac_f32_dpp v148, v50, v13 quad_perm:[1,0,3,2] row_mask:0xf bank_mask:0xf
    v_fmac_f32_dpp v52, v51, v137 quad_perm:[1,0,3,2] row_mask:0xf bank_mask:0xf
    s_waitcnt lgkmcnt(2)
    v_mfma_f32_32x32x16_bf16 v[96:111], v[24:27], v[216:219], v[96:111]
    ds_read_b64_tr_b16 v[32:33], v21 offset:59392
    ds_read_b64_tr_b16 v[34:35], v21 offset:59904
    v_fmac_f32 v53, v136, v52
    v_mul_f32 v149, v12, v51
    v_fmac_f32_dpp v149, v51, v13 quad_perm:[1,0,3,2] row_mask:0xf bank_mask:0xf
    v_cvt_pk_bf16_f32 v141, v148, v149
    v_fmac_f32_dpp v53, v52, v137 quad_perm:[1,0,3,2] row_mask:0xf bank_mask:0xf
    v_fmac_f32 v54, v136, v53
    v_mul_f32 v148, v12, v52
    v_fmac_f32_dpp v148, v52, v13 quad_perm:[1,0,3,2] row_mask:0xf bank_mask:0xf
    v_fmac_f32_dpp v54, v53, v137 quad_perm:[1,0,3,2] row_mask:0xf bank_mask:0xf
    v_fmac_f32 v55, v136, v54
    v_mul_f32 v149, v12, v53
    v_fmac_f32_dpp v149, v53, v13 quad_perm:[1,0,3,2] row_mask:0xf bank_mask:0xf
    v_cvt_pk_bf16_f32 v142, v148, v149
    v_fmac_f32_dpp v55, v54, v137 quad_perm:[1,0,3,2] row_mask:0xf bank_mask:0xf
    v_fmac_f32 v56, v136, v55
    v_mul_f32 v148, v12, v54
    v_fmac_f32_dpp v148, v54, v13 quad_perm:[1,0,3,2] row_mask:0xf bank_mask:0xf
    v_fmac_f32_dpp v56, v55, v137 quad_perm:[1,0,3,2] row_mask:0xf bank_mask:0xf
    s_waitcnt lgkmcnt(2)
    v_mfma_f32_32x32x16_bf16 v[112:127], v[28:31], v[216:219], v[112:127]
    ds_read_b64_tr_b16 v[36:37], v22 offset:59392
    ds_read_b64_tr_b16 v[38:39], v22 offset:59904
    v_fmac_f32 v57, v136, v56
    v_mul_f32 v149, v12, v55
    v_fmac_f32_dpp v149, v55, v13 quad_perm:[1,0,3,2] row_mask:0xf bank_mask:0xf
    v_cvt_pk_bf16_f32 v143, v148, v149
    v_fmac_f32_dpp v57, v56, v137 quad_perm:[1,0,3,2] row_mask:0xf bank_mask:0xf
    v_fmac_f32 v58, v136, v57
    v_mul_f32 v148, v12, v56
    v_fmac_f32_dpp v148, v56, v13 quad_perm:[1,0,3,2] row_mask:0xf bank_mask:0xf
    v_fmac_f32_dpp v58, v57, v137 quad_perm:[1,0,3,2] row_mask:0xf bank_mask:0xf
    v_fmac_f32 v59, v136, v58
    v_mul_f32 v149, v12, v57
    v_fmac_f32_dpp v149, v57, v13 quad_perm:[1,0,3,2] row_mask:0xf bank_mask:0xf
    v_cvt_pk_bf16_f32 v144, v148, v149
    v_fmac_f32_dpp v59, v58, v137 quad_perm:[1,0,3,2] row_mask:0xf bank_mask:0xf
    v_fmac_f32 v60, v136, v59
    v_mul_f32 v148, v12, v58
    v_fmac_f32_dpp v148, v58, v13 quad_perm:[1,0,3,2] row_mask:0xf bank_mask:0xf
    v_fmac_f32_dpp v60, v59, v137 quad_perm:[1,0,3,2] row_mask:0xf bank_mask:0xf
    s_waitcnt vmcnt(13) lgkmcnt(0)
    s_barrier
    v_mfma_f32_32x32x16_bf16 v[96:111], v[32:35], v[220:223], v[96:111]
    ds_read_b64_tr_b16 v[24:25], v21 offset:12288
    ds_read_b64_tr_b16 v[26:27], v21 offset:12800
    v_fmac_f32 v61, v136, v60
    v_mul_f32 v149, v12, v59
    v_fmac_f32_dpp v149, v59, v13 quad_perm:[1,0,3,2] row_mask:0xf bank_mask:0xf
    v_cvt_pk_bf16_f32 v145, v148, v149
    v_fmac_f32_dpp v61, v60, v137 quad_perm:[1,0,3,2] row_mask:0xf bank_mask:0xf
    v_fmac_f32 v62, v136, v61
    v_mul_f32 v148, v12, v60
    v_fmac_f32_dpp v148, v60, v13 quad_perm:[1,0,3,2] row_mask:0xf bank_mask:0xf
    v_fmac_f32_dpp v62, v61, v137 quad_perm:[1,0,3,2] row_mask:0xf bank_mask:0xf
    v_fmac_f32 v63, v136, v62
    v_mul_f32 v149, v12, v61
    v_fmac_f32_dpp v149, v61, v13 quad_perm:[1,0,3,2] row_mask:0xf bank_mask:0xf
    v_cvt_pk_bf16_f32 v146, v148, v149
    v_fmac_f32_dpp v63, v62, v137 quad_perm:[1,0,3,2] row_mask:0xf bank_mask:0xf
    v_mul_f32 v148, v12, v62
    v_fmac_f32_dpp v148, v62, v13 quad_perm:[1,0,3,2] row_mask:0xf bank_mask:0xf
    v_mul_f32 v149, v12, v63
    v_fmac_f32_dpp v149, v63, v13 quad_perm:[1,0,3,2] row_mask:0xf bank_mask:0xf
    v_cvt_pk_bf16_f32 v147, v148, v149
    s_mov_b32 exec_lo, 0x0000ffff
    s_mov_b32 exec_hi, 0x0000ffff
    ds_write_b128 v10, v[140:143]
    ds_write_b128 v10, v[144:147] offset:16
    s_mov_b64 exec, -1
    v_mfma_f32_32x32x16_bf16 v[112:127], v[36:39], v[220:223], v[112:127]
    ds_read_b64_tr_b16 v[28:29], v22 offset:12288
    ds_read_b64_tr_b16 v[30:31], v22 offset:12800
    ds_read_b64_tr_b16 v[48:49], v11 offset:0
    ds_read_b64_tr_b16 v[50:51], v11 offset:640
    s_mov_b32 exec_lo, 0xffff0000
    s_mov_b32 exec_hi, 0xffff0000
    ds_write_b128 v10, v[140:143]
    ds_write_b128 v10, v[144:147] offset:16
    s_mov_b64 exec, -1
    ds_read_b64_tr_b16 v[52:53], v11 offset:0
    ds_read_b64_tr_b16 v[54:55], v11 offset:640
    s_waitcnt lgkmcnt(0)
    s_add_u32 s12, s84, 0
    buffer_store_dwordx4 v[48:51], v23, s[68:71], s12 offen sc1
    buffer_store_dwordx4 v[52:55], v23, s[68:71], s12 offen offset:1024 sc1
    v_mfma_f32_32x32x16_bf16 v[96:111], v[24:27], v[224:227], v[96:111]
    ds_read_b64_tr_b16 v[32:33], v21 offset:14336
    ds_read_b64_tr_b16 v[34:35], v21 offset:14848
    v_mfma_f32_32x32x16_bf16 v[112:127], v[28:31], v[224:227], v[112:127]
    ds_read_b64_tr_b16 v[36:37], v22 offset:14336
    ds_read_b64_tr_b16 v[38:39], v22 offset:14848
    s_waitcnt lgkmcnt(2)
    v_mfma_f32_32x32x16_bf16 v[96:111], v[32:35], v[228:231], v[96:111]
    ds_read_b64_tr_b16 v[24:25], v21 offset:28672
    ds_read_b64_tr_b16 v[26:27], v21 offset:29184
    s_waitcnt lgkmcnt(2)
    v_mfma_f32_32x32x16_bf16 v[112:127], v[36:39], v[228:231], v[112:127]
    ds_read_b64_tr_b16 v[28:29], v22 offset:28672
    ds_read_b64_tr_b16 v[30:31], v22 offset:29184
    s_waitcnt lgkmcnt(2)
    v_mfma_f32_32x32x16_bf16 v[96:111], v[24:27], v[232:235], v[96:111]
    ds_read_b64_tr_b16 v[32:33], v21 offset:30720
    ds_read_b64_tr_b16 v[34:35], v21 offset:31232
    s_waitcnt lgkmcnt(2)
    v_mfma_f32_32x32x16_bf16 v[112:127], v[28:31], v[232:235], v[112:127]
    ds_read_b64_tr_b16 v[36:37], v22 offset:30720
    ds_read_b64_tr_b16 v[38:39], v22 offset:31232
    s_waitcnt lgkmcnt(2)
    v_mfma_f32_32x32x16_bf16 v[96:111], v[32:35], v[236:239], v[96:111]
    ds_read_b64_tr_b16 v[24:25], v21 offset:45056
    ds_read_b64_tr_b16 v[26:27], v21 offset:45568
    s_waitcnt lgkmcnt(2)
    v_mfma_f32_32x32x16_bf16 v[112:127], v[36:39], v[236:239], v[112:127]
    ds_read_b64_tr_b16 v[28:29], v22 offset:45056
    ds_read_b64_tr_b16 v[30:31], v22 offset:45568
    s_waitcnt lgkmcnt(2)
    v_mfma_f32_32x32x16_bf16 v[96:111], v[24:27], v[240:243], v[96:111]
    ds_read_b64_tr_b16 v[32:33], v21 offset:47104
    ds_read_b64_tr_b16 v[34:35], v21 offset:47616
    s_waitcnt lgkmcnt(2)
    v_mfma_f32_32x32x16_bf16 v[112:127], v[28:31], v[240:243], v[112:127]
    ds_read_b64_tr_b16 v[36:37], v22 offset:47104
    ds_read_b64_tr_b16 v[38:39], v22 offset:47616
    s_waitcnt lgkmcnt(2)
    v_mfma_f32_32x32x16_bf16 v[96:111], v[32:35], v[244:247], v[96:111]
    ds_read_b64_tr_b16 v[24:25], v21 offset:61440
    ds_read_b64_tr_b16 v[26:27], v21 offset:61952
    s_waitcnt lgkmcnt(2)
    v_mfma_f32_32x32x16_bf16 v[112:127], v[36:39], v[244:247], v[112:127]
    ds_read_b64_tr_b16 v[28:29], v22 offset:61440
    ds_read_b64_tr_b16 v[30:31], v22 offset:61952
    s_waitcnt lgkmcnt(2)
    v_mfma_f32_32x32x16_bf16 v[96:111], v[24:27], v[248:251], v[96:111]
    ds_read_b64_tr_b16 v[32:33], v21 offset:63488
    ds_read_b64_tr_b16 v[34:35], v21 offset:64000
    s_waitcnt lgkmcnt(2)
    v_mfma_f32_32x32x16_bf16 v[112:127], v[28:31], v[248:251], v[112:127]
    ds_read_b64_tr_b16 v[36:37], v22 offset:63488
    ds_read_b64_tr_b16 v[38:39], v22 offset:64000
    s_waitcnt lgkmcnt(2)
    v_mfma_f32_32x32x16_bf16 v[96:111], v[32:35], v[252:255], v[96:111]
    s_waitcnt lgkmcnt(0)
    v_mfma_f32_32x32x16_bf16 v[112:127], v[36:39], v[252:255], v[112:127]
    s_nop 7
    s_nop 3
    v_pk_mul_f32 v[40:41], s[80:81], v[96:97] op_sel:[1,0] op_sel_hi:[1,1]
    v_pk_mul_f32 v[42:43], s[80:81], v[98:99] op_sel:[1,0] op_sel_hi:[1,1]
    v_pk_mul_f32 v[44:45], s[80:81], v[100:101] op_sel:[1,0] op_sel_hi:[1,1]
    v_pk_mul_f32 v[46:47], s[80:81], v[102:103] op_sel:[1,0] op_sel_hi:[1,1]
    v_exp_f32 v40, v40
    v_exp_f32 v41, v41
    v_pk_mul_f32 v[104:105], v[96:97], v[104:105]
    v_exp_f32 v42, v42
    v_exp_f32 v43, v43
    v_pk_mul_f32 v[106:107], v[98:99], v[106:107]
    v_exp_f32 v44, v44
    v_exp_f32 v45, v45
    v_pk_mul_f32 v[108:109], v[100:101], v[108:109]
    v_exp_f32 v46, v46
    v_exp_f32 v47, v47
    v_pk_mul_f32 v[110:111], v[102:103], v[110:111]
    v_pk_add_f32 v[40:41], v[40:41], 1.0 op_sel_hi:[1,0]
    v_pk_add_f32 v[42:43], v[42:43], 1.0 op_sel_hi:[1,0]
    v_pk_add_f32 v[44:45], v[44:45], 1.0 op_sel_hi:[1,0]
    v_pk_add_f32 v[46:47], v[46:47], 1.0 op_sel_hi:[1,0]
    v_rcp_f32 v40, v40
    v_rcp_f32 v41, v41
    v_rcp_f32 v42, v42
    v_rcp_f32 v43, v43
    v_pk_mul_f32 v[104:105], v[104:105], v[40:41]
    v_rcp_f32 v44, v44
    v_rcp_f32 v45, v45
    v_pk_mul_f32 v[106:107], v[106:107], v[42:43]
    v_rcp_f32 v46, v46
    v_rcp_f32 v47, v47
    v_pk_mul_f32 v[108:109], v[108:109], v[44:45]
    v_pk_mul_f32 v[110:111], v[110:111], v[46:47]
    v_cvt_pk_bf16_f32 v96, v104, v105
    v_cvt_pk_bf16_f32 v97, v106, v107
    v_cvt_pk_bf16_f32 v98, v108, v109
    v_cvt_pk_bf16_f32 v99, v110, v111
    buffer_store_dwordx4 v[96:99], v23, s[68:71], s83 offen sc1
    v_pk_mul_f32 v[40:41], s[80:81], v[112:113] op_sel:[1,0] op_sel_hi:[1,1]
    v_pk_mul_f32 v[42:43], s[80:81], v[114:115] op_sel:[1,0] op_sel_hi:[1,1]
    v_pk_mul_f32 v[44:45], s[80:81], v[116:117] op_sel:[1,0] op_sel_hi:[1,1]
    v_pk_mul_f32 v[46:47], s[80:81], v[118:119] op_sel:[1,0] op_sel_hi:[1,1]
    v_exp_f32 v40, v40
    v_exp_f32 v41, v41
    v_pk_mul_f32 v[120:121], v[112:113], v[120:121]
    v_exp_f32 v42, v42
    v_exp_f32 v43, v43
    v_pk_mul_f32 v[122:123], v[114:115], v[122:123]
    v_exp_f32 v44, v44
    v_exp_f32 v45, v45
    v_pk_mul_f32 v[124:125], v[116:117], v[124:125]
    v_exp_f32 v46, v46
    v_exp_f32 v47, v47
    v_pk_mul_f32 v[126:127], v[118:119], v[126:127]
    v_pk_add_f32 v[40:41], v[40:41], 1.0 op_sel_hi:[1,0]
    v_pk_add_f32 v[42:43], v[42:43], 1.0 op_sel_hi:[1,0]
    v_pk_add_f32 v[44:45], v[44:45], 1.0 op_sel_hi:[1,0]
    v_pk_add_f32 v[46:47], v[46:47], 1.0 op_sel_hi:[1,0]
    v_rcp_f32 v40, v40
    v_rcp_f32 v41, v41
    v_rcp_f32 v42, v42
    v_rcp_f32 v43, v43
    v_pk_mul_f32 v[120:121], v[120:121], v[40:41]
    v_rcp_f32 v44, v44
    v_rcp_f32 v45, v45
    v_pk_mul_f32 v[122:123], v[122:123], v[42:43]
    v_rcp_f32 v46, v46
    v_rcp_f32 v47, v47
    v_pk_mul_f32 v[124:125], v[124:125], v[44:45]
    v_pk_mul_f32 v[126:127], v[126:127], v[46:47]
    v_cvt_pk_bf16_f32 v112, v120, v121
    v_cvt_pk_bf16_f32 v113, v122, v123
    v_cvt_pk_bf16_f32 v114, v124, v125
    v_cvt_pk_bf16_f32 v115, v126, v127
    buffer_store_dwordx4 v[112:115], v23, s[68:71], s83 offen offset:1024 sc1
    s_waitcnt vmcnt(0)
    s_setprio 0
    s_barrier
    v_mov_b32 v1, s34
    v_mov_b32 v2, 0
    s_cmp_lg_u32 s4, 0
    s_cbranch_scc1 L_done_skip_22
    s_lshl_b32 s12, s6, 11
    s_lshl_b32 s13, s85, 7
    s_add_u32 s12, s12, s13
    s_add_u32 s12, s12, 14688256
    s_mov_b64 exec, 1
    buffer_store_dword v1, v2, s[68:71], s12 offen sc1
    s_mov_b64 exec, -1
L_done_skip_22:
    s_add_u32 m0, s94, 8192
    s_add_u32 s15, s95, 32768
    buffer_load_dwordx4 v6, s[72:75], s15 offen lds
    buffer_load_dwordx4 v7, s[72:75], s15 offen offset:1024 lds
    s_add_u32 s15, s15, 14336
    buffer_load_dwordx4 v6, s[72:75], s15 offen offset:2048 lds
    buffer_load_dwordx4 v7, s[72:75], s15 offen offset:3072 lds
    s_add_u32 m0, s94, 12288
    s_add_u32 s15, s95, 32768
    buffer_load_dwordx4 v6, s[56:59], s15 offen lds
    buffer_load_dwordx4 v7, s[56:59], s15 offen offset:1024 lds
    s_add_u32 s15, s15, 14336
    buffer_load_dwordx4 v6, s[56:59], s15 offen offset:2048 lds
    buffer_load_dwordx4 v7, s[56:59], s15 offen offset:3072 lds
    ds_read_b128 v[128:131], v8 offset:0
    v_xor_b32 v9, 16, v8
    ds_read_b128 v[136:139], v9 offset:0
    v_xor_b32 v9, 32, v8
    ds_read_b128 v[144:147], v9 offset:0
    v_xor_b32 v9, 48, v8
    ds_read_b128 v[152:155], v9 offset:0
    v_xor_b32 v9, 64, v8
    ds_read_b128 v[160:163], v9 offset:0
    v_xor_b32 v9, 80, v8
    ds_read_b128 v[168:171], v9 offset:0
    v_xor_b32 v9, 96, v8
    ds_read_b128 v[176:179], v9 offset:0
    v_xor_b32 v9, 112, v8
    ds_read_b128 v[184:187], v9 offset:0
    s_waitcnt lgkmcnt(0)
    s_add_u32 m0, s94, 0
    s_add_u32 s15, s95, 128
    buffer_load_dwordx4 v6, s[72:75], s15 offen lds
    buffer_load_dwordx4 v7, s[72:75], s15 offen offset:1024 lds
    s_add_u32 s15, s15, 14336
    buffer_load_dwordx4 v6, s[72:75], s15 offen offset:2048 lds
    buffer_load_dwordx4 v7, s[72:75], s15 offen offset:3072 lds
    s_add_u32 m0, s94, 4096
    s_add_u32 s15, s95, 128
    buffer_load_dwordx4 v6, s[56:59], s15 offen lds
    buffer_load_dwordx4 v7, s[56:59], s15 offen offset:1024 lds
    s_add_u32 s15, s15, 14336
    buffer_load_dwordx4 v6, s[56:59], s15 offen offset:2048 lds
    buffer_load_dwordx4 v7, s[56:59], s15 offen offset:3072 lds
    s_waitcnt vmcnt(8)
    ds_read_b128 v[132:135], v8 offset:8192
    v_xor_b32 v9, 16, v8
    ds_read_b128 v[140:143], v9 offset:8192
    v_xor_b32 v9, 32, v8
    ds_read_b128 v[148:151], v9 offset:8192
    v_xor_b32 v9, 48, v8
    ds_read_b128 v[156:159], v9 offset:8192
    v_xor_b32 v9, 64, v8
    ds_read_b128 v[164:167], v9 offset:8192
    v_xor_b32 v9, 80, v8
    ds_read_b128 v[172:175], v9 offset:8192
    v_xor_b32 v9, 96, v8
    ds_read_b128 v[180:183], v9 offset:8192
    v_xor_b32 v9, 112, v8
    ds_read_b128 v[188:191], v9 offset:8192
    s_waitcnt lgkmcnt(0)
    s_add_u32 m0, s94, 8192
    s_add_u32 s15, s95, 32896
    buffer_load_dwordx4 v6, s[72:75], s15 offen lds
    buffer_load_dwordx4 v7, s[72:75], s15 offen offset:1024 lds
    s_add_u32 s15, s15, 14336
    buffer_load_dwordx4 v6, s[72:75], s15 offen offset:2048 lds
    buffer_load_dwordx4 v7, s[72:75], s15 offen offset:3072 lds
    s_add_u32 m0, s94, 12288
    s_add_u32 s15, s95, 32896
    buffer_load_dwordx4 v6, s[56:59], s15 offen lds
    buffer_load_dwordx4 v7, s[56:59], s15 offen offset:1024 lds
    s_add_u32 s15, s15, 14336
    buffer_load_dwordx4 v6, s[56:59], s15 offen offset:2048 lds
    buffer_load_dwordx4 v7, s[56:59], s15 offen offset:3072 lds
    s_waitcnt vmcnt(8)
    ds_read_b128 v[192:195], v8 offset:0
    v_xor_b32 v9, 16, v8
    ds_read_b128 v[200:203], v9 offset:0
    v_xor_b32 v9, 32, v8
    ds_read_b128 v[208:211], v9 offset:0
    v_xor_b32 v9, 48, v8
    ds_read_b128 v[216:219], v9 offset:0
    v_xor_b32 v9, 64, v8
    ds_read_b128 v[224:227], v9 offset:0
    v_xor_b32 v9, 80, v8
    ds_read_b128 v[232:235], v9 offset:0
    v_xor_b32 v9, 96, v8
    ds_read_b128 v[240:243], v9 offset:0
    v_xor_b32 v9, 112, v8
    ds_read_b128 v[248:251], v9 offset:0
    s_waitcnt vmcnt(0)
    ds_read_b128 v[196:199], v8 offset:8192
    v_xor_b32 v9, 16, v8
    ds_read_b128 v[204:207], v9 offset:8192
    v_xor_b32 v9, 32, v8
    ds_read_b128 v[212:215], v9 offset:8192
    v_xor_b32 v9, 48, v8
    ds_read_b128 v[220:223], v9 offset:8192
    v_xor_b32 v9, 64, v8
    ds_read_b128 v[228:231], v9 offset:8192
    v_xor_b32 v9, 80, v8
    ds_read_b128 v[236:239], v9 offset:8192
    v_xor_b32 v9, 96, v8
    ds_read_b128 v[244:247], v9 offset:8192
    v_xor_b32 v9, 112, v8
    ds_read_b128 v[252:255], v9 offset:8192
    s_branch L_P2_0
L_P2_0:
    s_mov_b32 s64, s44
    s_and_b32 s65, s45, 0xffff
    s_mov_b32 s66, 4194304
    s_mov_b32 s67, 0x00020000
    s_add_u32 s60, s48, 180224
    s_addc_u32 s61, s49, 0
    s_and_b32 s61, s61, 0xffff
    s_mov_b32 s62, 14540800
    s_mov_b32 s63, 0x00020000
    v_mov_b32 v12, v23
    s_lshr_b32 s76, s50, 1
    s_lshl_b32 s76, s76, 11
    s_add_u32 s76, s76, 14688256
    v_and_b32 v1, 15, v0
    v_lshlrev_b32 v1, 7, v1
    s_cmp_lg_u32 s4, 0
    s_cbranch_scc1 L_nopoll_60
    s_mov_b32 s88, 0xffff
    s_mov_b64 exec, 0xffff
    s_mov_b32 s86, 0
L_pd_61:
    buffer_load_dword v2, v1, s[68:71], s76 offen sc1
    s_waitcnt vmcnt(0)
    v_cmp_ne_u32 vcc, s34, v2
    s_and_b32 s12, vcc_lo, s88
    s_cbranch_scc0 L_pd_ok_62
    s_sleep 1
    s_add_u32 s86, s86, 1
    s_cmp_lt_u32 s86, 0x4000
    s_cbranch_scc1 L_pd_61
L_pd_ok_62:
    s_mov_b64 exec, -1
L_nopoll_60:
    s_waitcnt vmcnt(0)
    s_waitcnt lgkmcnt(0)
    s_barrier
    s_setprio 0
    buffer_load_dwordx4 v[24:27], v12, s[68:71], s35 offen sc1
    buffer_load_dwordx4 v[28:31], v12, s[60:63], s35 offen sc1
    buffer_load_dwordx4 v[32:35], v12, s[68:71], s35 offen offset:1024 sc1
    buffer_load_dwordx4 v[36:39], v12, s[60:63], s35 offen offset:1024 sc1
    buffer_load_dwordx4 v[40:43], v12, s[68:71], s35 offen offset:2048 sc1
    buffer_load_dwordx4 v[44:47], v12, s[60:63], s35 offen offset:2048 sc1
    buffer_load_dwordx4 v[48:51], v12, s[68:71], s35 offen offset:3072 sc1
    buffer_load_dwordx4 v[52:55], v12, s[60:63], s35 offen offset:3072 sc1
    s_lshl_b32 s12, s4, 2
    s_add_u32 s12, s12, 0
    v_lshrrev_b32 v3, 4, v0
    v_add_u32 v3, s12, v3
    v_and_b32 v4, 15, v0
    s_lshl_b32 s13, s51, 6
    v_lshl_add_u32 v4, v4, 2, s13
    v_lshlrev_b32 v4, 1, v4
    s_lshl_b32 s13, s50, 6
    v_add_u32 v5, s13, v3
    v_lshl_add_u32 v5, v5, 10, v4
    v_lshlrev_b32 v3, 2, v3
    s_lshl_b32 s87, s50, 8
    s_add_u32 s87, s87, 14417920
    s_waitcnt vmcnt(7)
    v_mfma_f32_32x32x16_bf16 v[64:79], v[128:131], v[24:27], 0
    v_mfma_f32_32x32x16_bf16 v[80:95], v[132:135], v[24:27], 0
    s_waitcnt vmcnt(6)
    v_mfma_f32_32x32x16_bf16 v[96:111], v[128:131], v[28:31], 0
    v_mfma_f32_32x32x16_bf16 v[112:127], v[132:135], v[28:31], 0
    s_add_u32 s12, s35, 4096
    buffer_load_dwordx4 v[56:59], v12, s[68:71], s12 offen sc1
    buffer_load_dwordx4 v[60:63], v12, s[60:63], s12 offen sc1
    s_waitcnt vmcnt(7)
    v_mfma_f32_32x32x16_bf16 v[64:79], v[136:139], v[32:35], v[64:79]
    v_mfma_f32_32x32x16_bf16 v[80:95], v[140:143], v[32:35], v[80:95]
    s_waitcnt vmcnt(6)
    v_mfma_f32_32x32x16_bf16 v[96:111], v[136:139], v[36:39], v[96:111]
    v_mfma_f32_32x32x16_bf16 v[112:127], v[140:143], v[36:39], v[112:127]
    s_add_u32 s12, s35, 4096
    buffer_load_dwordx4 v[24:27], v12, s[68:71], s12 offen offset:1024 sc1
    buffer_load_dwordx4 v[28:31], v12, s[60:63], s12 offen offset:1024 sc1
    s_waitcnt vmcnt(7)
    v_mfma_f32_32x32x16_bf16 v[64:79], v[144:147], v[40:43], v[64:79]
    v_mfma_f32_32x32x16_bf16 v[80:95], v[148:151], v[40:43], v[80:95]
    s_waitcnt vmcnt(6)
    v_mfma_f32_32x32x16_bf16 v[96:111], v[144:147], v[44:47], v[96:111]
    v_mfma_f32_32x32x16_bf16 v[112:127], v[148:151], v[44:47], v[112:127]
    s_add_u32 s12, s35, 4096
    buffer_load_dwordx4 v[32:35], v12, s[68:71], s12 offen offset:2048 sc1
    buffer_load_dwordx4 v[36:39], v12, s[60:63], s12 offen offset:2048 sc1
    s_waitcnt vmcnt(7)
    v_mfma_f32_32x32x16_bf16 v[64:79], v[152:155], v[48:51], v[64:79]
    v_mfma_f32_32x32x16_bf16 v[80:95], v[156:159], v[48:51], v[80:95]
    s_waitcnt vmcnt(6)
    v_mfma_f32_32x32x16_bf16 v[96:111], v[152:155], v[52:55], v[96:111]
    v_mfma_f32_32x32x16_bf16 v[112:127], v[156:159], v[52:55], v[112:127]
    s_add_u32 s12, s35, 4096
    buffer_load_dwordx4 v[40:43], v12, s[68:71], s12 offen offset:3072 sc1
    buffer_load_dwordx4 v[44:47], v12, s[60:63], s12 offen offset:3072 sc1
    s_waitcnt vmcnt(7)
    v_mfma_f32_32x32x16_bf16 v[64:79], v[160:163], v[56:59], v[64:79]
    v_mfma_f32_32x32x16_bf16 v[80:95], v[164:167], v[56:59], v[80:95]
    s_waitcnt vmcnt(6)
    v_mfma_f32_32x32x16_bf16 v[96:111], v[160:163], v[60:63], v[96:111]
    v_mfma_f32_32x32x16_bf16 v[112:127], v[164:167], v[60:63], v[112:127]
    s_add_u32 s12, s35, 8192
    buffer_load_dwordx4 v[48:51], v12, s[68:71], s12 offen sc1
    buffer_load_dwordx4 v[52:55], v12, s[60:63], s12 offen sc1
    s_waitcnt vmcnt(7)
    v_mfma_f32_32x32x16_bf16 v[64:79], v[168:171], v[24:27], v[64:79]
    v_mfma_f32_32x32x16_bf16 v[80:95], v[172:175], v[24:27], v[80:95]
    s_waitcnt vmcnt(6)
    v_mfma_f32_32x32x16_bf16 v[96:111], v[168:171], v[28:31], v[96:111]
    v_mfma_f32_32x32x16_bf16 v[112:127], v[172:175], v[28:31], v[112:127]
    s_add_u32 s12, s35, 8192
    buffer_load_dwordx4 v[56:59], v12, s[68:71], s12 offen offset:1024 sc1
    buffer_load_dwordx4 v[60:63], v12, s[60:63], s12 offen offset:1024 sc1
    s_waitcnt vmcnt(7)
    v_mfma_f32_32x32x16_bf16 v[64:79], v[176:179], v[32:35], v[64:79]
    v_mfma_f32_32x32x16_bf16 v[80:95], v[180:183], v[32:35], v[80:95]
    s_waitcnt vmcnt(6)
    v_mfma_f32_32x32x16_bf16 v[96:111], v[176:179], v[36:39], v[96:111]
    v_mfma_f32_32x32x16_bf16 v[112:127], v[180:183], v[36:39], v[112:127]
    s_add_u32 s12, s35, 8192
    buffer_load_dwordx4 v[24:27], v12, s[68:71], s12 offen offset:2048 sc1
    buffer_load_dwordx4 v[28:31], v12, s[60:63], s12 offen offset:2048 sc1
    s_waitcnt vmcnt(7)
    v_mfma_f32_32x32x16_bf16 v[64:79], v[184:187], v[40:43], v[64:79]
    v_mfma_f32_32x32x16_bf16 v[80:95], v[188:191], v[40:43], v[80:95]
    s_waitcnt vmcnt(6)
    v_mfma_f32_32x32x16_bf16 v[96:111], v[184:187], v[44:47], v[96:111]
    v_mfma_f32_32x32x16_bf16 v[112:127], v[188:191], v[44:47], v[112:127]
    s_add_u32 s12, s35, 8192
    buffer_load_dwordx4 v[168:171], v12, s[68:71], s12 offen offset:3072 sc1
    buffer_load_dwordx4 v[172:175], v12, s[60:63], s12 offen offset:3072 sc1
    s_waitcnt vmcnt(7)
    v_mfma_f32_32x32x16_bf16 v[64:79], v[192:195], v[48:51], v[64:79]
    v_mfma_f32_32x32x16_bf16 v[80:95], v[196:199], v[48:51], v[80:95]
    s_waitcnt vmcnt(6)
    v_mfma_f32_32x32x16_bf16 v[96:111], v[192:195], v[52:55], v[96:111]
    v_mfma_f32_32x32x16_bf16 v[112:127], v[196:199], v[52:55], v[112:127]
    s_add_u32 s12, s35, 12288
    buffer_load_dwordx4 v[32:35], v12, s[68:71], s12 offen sc1
    buffer_load_dwordx4 v[36:39], v12, s[60:63], s12 offen sc1
    buffer_load_dword v13, v3, s[68:71], s87 offen sc1
    buffer_load_dword v14, v3, s[68:71], s87 offen offset:64 sc1
    global_load_dwordx2 v[6:7], v4, s[32:33]
    buffer_load_dwordx2 v[16:17], v5, s[52:55], 0 offen
    s_mov_b32 s12, 16384
    buffer_load_dwordx2 v[18:19], v5, s[52:55], s12 offen
    s_waitcnt vmcnt(12)
    v_mfma_f32_32x32x16_bf16 v[64:79], v[200:203], v[56:59], v[64:79]
    v_mfma_f32_32x32x16_bf16 v[80:95], v[204:207], v[56:59], v[80:95]
    s_waitcnt vmcnt(11)
    v_mfma_f32_32x32x16_bf16 v[96:111], v[200:203], v[60:63], v[96:111]
    v_mfma_f32_32x32x16_bf16 v[112:127], v[204:207], v[60:63], v[112:127]
    s_add_u32 s12, s35, 12288
    buffer_load_dwordx4 v[176:179], v12, s[68:71], s12 offen offset:1024 sc1
    buffer_load_dwordx4 v[180:183], v12, s[60:63], s12 offen offset:1024 sc1
    s_waitcnt vmcnt(12)
    v_mfma_f32_32x32x16_bf16 v[64:79], v[208:211], v[24:27], v[64:79]
    v_mfma_f32_32x32x16_bf16 v[80:95], v[212:215], v[24:27], v[80:95]
    s_waitcnt vmcnt(11)
    v_mfma_f32_32x32x16_bf16 v[96:111], v[208:211], v[28:31], v[96:111]
    v_mfma_f32_32x32x16_bf16 v[112:127], v[212:215], v[28:31], v[112:127]
    s_add_u32 s12, s35, 12288
    buffer_load_dwordx4 v[40:43], v12, s[68:71], s12 offen offset:2048 sc1
    buffer_load_dwordx4 v[44:47], v12, s[60:63], s12 offen offset:2048 sc1
    s_waitcnt vmcnt(12)
    v_mfma_f32_32x32x16_bf16 v[64:79], v[216:219], v[168:171], v[64:79]
    v_mfma_f32_32x32x16_bf16 v[80:95], v[220:223], v[168:171], v[80:95]
    s_waitcnt vmcnt(11)
    v_mfma_f32_32x32x16_bf16 v[96:111], v[216:219], v[172:175], v[96:111]
    v_mfma_f32_32x32x16_bf16 v[112:127], v[220:223], v[172:175], v[112:127]
    s_add_u32 s12, s35, 12288
    buffer_load_dwordx4 v[184:187], v12, s[68:71], s12 offen offset:3072 sc1
    buffer_load_dwordx4 v[188:191], v12, s[60:63], s12 offen offset:3072 sc1
    s_waitcnt vmcnt(12)
    v_mfma_f32_32x32x16_bf16 v[64:79], v[224:227], v[32:35], v[64:79]
    v_mfma_f32_32x32x16_bf16 v[80:95], v[228:231], v[32:35], v[80:95]
    s_waitcnt vmcnt(11)
    v_mfma_f32_32x32x16_bf16 v[96:111], v[224:227], v[36:39], v[96:111]
    v_mfma_f32_32x32x16_bf16 v[112:127], v[228:231], v[36:39], v[112:127]
    s_waitcnt vmcnt(5)
    v_mfma_f32_32x32x16_bf16 v[64:79], v[232:235], v[176:179], v[64:79]
    v_mfma_f32_32x32x16_bf16 v[80:95], v[236:239], v[176:179], v[80:95]
    s_waitcnt vmcnt(4)
    v_mfma_f32_32x32x16_bf16 v[96:111], v[232:235], v[180:183], v[96:111]
    v_mfma_f32_32x32x16_bf16 v[112:127], v[236:239], v[180:183], v[112:127]
    v_and_b32 v161, 31, v0
    v_lshrrev_b32 v162, 5, v0
    v_and_b32 v163, 7, v0
    v_xor_b32 v162, v162, v163
    v_lshlrev_b32 v162, 4, v162
    v_lshl_add_u32 v161, v161, 8, v162
    v_add_u32 v160, s94, v161
    v_xor_b32 v161, 32, v160
    v_xor_b32 v162, 64, v160
    v_xor_b32 v163, 96, v160
    v_lshrrev_b32 v164, 4, v0
    v_and_b32 v165, 15, v0
    v_xor_b32 v165, v165, v164
    v_lshlrev_b32 v165, 4, v165
    v_lshl_add_u32 v164, v164, 8, v165
    s_lshl_b32 s12, s3, 11
    v_add_u32 v164, s12, v164
    v_xor_b32 v165, 64, v164
    v_add_u32 v165, 1024, v165
    v_add_u32 v166, 65536, v164
    v_add_u32 v167, 65536, v165
    v_lshlrev_b32 v5, 1, v5
    v_lshlrev_b32 v152, 16, v6
    v_and_b32 v153, 0xffff0000, v6
    v_lshlrev_b32 v154, 16, v7
    v_and_b32 v155, 0xffff0000, v7
    v_lshlrev_b32 v144, 16, v16
    v_and_b32 v145, 0xffff0000, v16
    v_lshlrev_b32 v146, 16, v17
    v_and_b32 v147, 0xffff0000, v17
    v_mul_f32 v144, v144, v152
    v_mul_f32 v145, v145, v153
    v_mul_f32 v146, v146, v154
    v_mul_f32 v147, v147, v155
    v_cvt_pk_bf16_f32 v156, v144, v145
    v_lshlrev_b32 v144, 16, v156
    v_and_b32 v145, 0xffff0000, v156
    v_cvt_pk_bf16_f32 v156, v146, v147
    v_lshlrev_b32 v146, 16, v156
    v_and_b32 v147, 0xffff0000, v156
    v_sub_f32 v157, 1.0, v13
    v_cvt_pk_bf16_f32 v157, v157, v157
    v_lshlrev_b32 v157, 16, v157
    v_lshlrev_b32 v148, 16, v18
    v_and_b32 v149, 0xffff0000, v18
    v_lshlrev_b32 v150, 16, v19
    v_and_b32 v151, 0xffff0000, v19
    v_mul_f32 v148, v148, v152
    v_mul_f32 v149, v149, v153
    v_mul_f32 v150, v150, v154
    v_mul_f32 v151, v151, v155
    v_cvt_pk_bf16_f32 v156, v148, v149
    v_lshlrev_b32 v148, 16, v156
    v_and_b32 v149, 0xffff0000, v156
    v_cvt_pk_bf16_f32 v156, v150, v151
    v_lshlrev_b32 v150, 16, v156
    v_and_b32 v151, 0xffff0000, v156
    v_sub_f32 v158, 1.0, v14
    v_cvt_pk_bf16_f32 v158, v158, v158
    v_lshlrev_b32 v158, 16, v158
    s_waitcnt vmcnt(3)
    v_mfma_f32_32x32x16_bf16 v[64:79], v[240:243], v[40:43], v[64:79]
    v_mfma_f32_32x32x16_bf16 v[80:95], v[244:247], v[40:43], v[80:95]
    s_waitcnt vmcnt(2)
    v_mfma_f32_32x32x16_bf16 v[96:111], v[240:243], v[44:47], v[96:111]
    v_mfma_f32_32x32x16_bf16 v[112:127], v[244:247], v[44:47], v[112:127]
    s_waitcnt vmcnt(1)
    v_mfma_f32_32x32x16_bf16 v[64:79], v[248:251], v[184:187], v[64:79]
    v_mfma_f32_32x32x16_bf16 v[80:95], v[252:255], v[184:187], v[80:95]
    s_waitcnt vmcnt(0)
    v_mfma_f32_32x32x16_bf16 v[96:111], v[248:251], v[188:191], v[96:111]
    v_mfma_f32_32x32x16_bf16 v[112:127], v[252:255], v[188:191], v[112:127]
    s_nop 9
    ds_write_b128 v160, v[64:67] offset:0
    ds_write_b128 v161, v[68:71] offset:0
    ds_write_b128 v162, v[72:75] offset:0
    ds_write_b128 v163, v[76:79] offset:0
    ds_write_b128 v160, v[80:83] offset:128
    ds_write_b128 v161, v[84:87] offset:128
    ds_write_b128 v162, v[88:91] offset:128
    ds_write_b128 v163, v[92:95] offset:128
    ds_write_b128 v160, v[96:99] offset:8192
    ds_write_b128 v161, v[100:103] offset:8192
    ds_write_b128 v162, v[104:107] offset:8192
    ds_write_b128 v163, v[108:111] offset:8192
    ds_write_b128 v160, v[112:115] offset:8320
    ds_write_b128 v161, v[116:119] offset:8320
    ds_write_b128 v162, v[120:123] offset:8320
    ds_write_b128 v163, v[124:127] offset:8320
    s_waitcnt lgkmcnt(0)
    s_barrier
    ds_read_b128 v[64:67], v164 offset:0
    ds_read_b128 v[68:71], v165 offset:0
    ds_read_b128 v[72:75], v164 offset:16384
    ds_read_b128 v[76:79], v165 offset:16384
    ds_read_b128 v[80:83], v164 offset:32768
    ds_read_b128 v[84:87], v165 offset:32768
    ds_read_b128 v[88:91], v164 offset:49152
    ds_read_b128 v[92:95], v165 offset:49152
    ds_read_b128 v[96:99], v166 offset:0
    ds_read_b128 v[100:103], v167 offset:0
    ds_read_b128 v[104:107], v166 offset:16384
    ds_read_b128 v[108:111], v167 offset:16384
    ds_read_b128 v[112:115], v166 offset:32768
    ds_read_b128 v[116:119], v167 offset:32768
    ds_read_b128 v[120:123], v166 offset:49152
    ds_read_b128 v[124:127], v167 offset:49152
    s_waitcnt lgkmcnt(14)
    v_pk_add_f32 v[144:145], v[144:145], v[64:65]
    v_pk_add_f32 v[146:147], v[146:147], v[66:67]
    v_pk_add_f32 v[148:149], v[148:149], v[68:69]
    v_pk_add_f32 v[150:151], v[150:151], v[70:71]
    s_waitcnt lgkmcnt(12)
    v_pk_add_f32 v[144:145], v[144:145], v[72:73]
    v_pk_add_f32 v[146:147], v[146:147], v[74:75]
    v_pk_add_f32 v[148:149], v[148:149], v[76:77]
    v_pk_add_f32 v[150:151], v[150:151], v[78:79]
    s_waitcnt lgkmcnt(10)
    v_pk_add_f32 v[144:145], v[144:145], v[80:81]
    v_pk_add_f32 v[146:147], v[146:147], v[82:83]
    v_pk_add_f32 v[148:149], v[148:149], v[84:85]
    v_pk_add_f32 v[150:151], v[150:151], v[86:87]
    s_waitcnt lgkmcnt(8)
    v_pk_add_f32 v[144:145], v[144:145], v[88:89]
    v_pk_add_f32 v[146:147], v[146:147], v[90:91]
    v_pk_add_f32 v[148:149], v[148:149], v[92:93]
    v_pk_add_f32 v[150:151], v[150:151], v[94:95]
    v_mul_f32 v144, v13, v144
    v_mul_f32 v145, v13, v145
    v_mul_f32 v146, v13, v146
    v_mul_f32 v147, v13, v147
    v_mul_f32 v148, v14, v148
    v_mul_f32 v149, v14, v149
    v_mul_f32 v150, v14, v150
    v_mul_f32 v151, v14, v151
    s_waitcnt lgkmcnt(4)
    v_pk_add_f32 v[40:41], v[96:97], v[104:105]
    v_pk_add_f32 v[42:43], v[98:99], v[106:107]
    v_pk_add_f32 v[44:45], v[100:101], v[108:109]
    v_pk_add_f32 v[46:47], v[102:103], v[110:111]
    s_waitcnt lgkmcnt(0)
    v_pk_add_f32 v[112:113], v[112:113], v[120:121]
    v_pk_add_f32 v[114:115], v[114:115], v[122:123]
    v_pk_add_f32 v[116:117], v[116:117], v[124:125]
    v_pk_add_f32 v[118:119], v[118:119], v[126:127]
    v_pk_add_f32 v[40:41], v[40:41], v[112:113]
    v_pk_add_f32 v[42:43], v[42:43], v[114:115]
    v_pk_add_f32 v[44:45], v[44:45], v[116:117]
    v_pk_add_f32 v[46:47], v[46:47], v[118:119]
    v_fmac_f32 v144, v157, v40
    v_fmac_f32 v145, v157, v41
    v_fmac_f32 v146, v157, v42
    v_fmac_f32 v147, v157, v43
    v_fmac_f32 v148, v158, v44
    v_fmac_f32 v149, v158, v45
    v_fmac_f32 v150, v158, v46
    v_fmac_f32 v151, v158, v47
    buffer_store_dwordx4 v[144:147], v5, s[64:67], 0 offen sc1
    s_mov_b32 s12, 32768
    buffer_store_dwordx4 v[148:151], v5, s[64:67], s12 offen sc1
    s_endpgm
L_P2_1:
    s_mov_b32 s64, s44
    s_and_b32 s65, s45, 0xffff
    s_mov_b32 s66, 4194304
    s_mov_b32 s67, 0x00020000
    s_add_u32 s60, s48, 180224
    s_addc_u32 s61, s49, 0
    s_and_b32 s61, s61, 0xffff
    s_mov_b32 s62, 14540800
    s_mov_b32 s63, 0x00020000
    v_mov_b32 v12, v23
    s_lshr_b32 s76, s50, 1
    s_lshl_b32 s76, s76, 11
    s_add_u32 s76, s76, 14688256
    v_and_b32 v1, 15, v0
    v_lshlrev_b32 v1, 7, v1
    s_lshl_b32 s12, s4, 13
    s_add_u32 s12, s12, 131072
    s_sub_u32 s12, s12, s94
    v_add_u32 v10, s12, v8
    v_add_u32 v11, s12, v9
    s_waitcnt vmcnt(0)
    s_waitcnt lgkmcnt(0)
    s_barrier
    s_setprio 1
    buffer_load_dwordx4 v[24:27], v12, s[68:71], s35 offen sc1
    buffer_load_dwordx4 v[28:31], v12, s[60:63], s35 offen sc1
    buffer_load_dwordx4 v[32:35], v12, s[68:71], s35 offen offset:1024 sc1
    buffer_load_dwordx4 v[36:39], v12, s[60:63], s35 offen offset:1024 sc1
    buffer_load_dwordx4 v[40:43], v12, s[68:71], s35 offen offset:2048 sc1
    buffer_load_dwordx4 v[44:47], v12, s[60:63], s35 offen offset:2048 sc1
    buffer_load_dwordx4 v[48:51], v12, s[68:71], s35 offen offset:3072 sc1
    buffer_load_dwordx4 v[52:55], v12, s[60:63], s35 offen offset:3072 sc1
    s_lshl_b32 s12, s4, 2
    s_add_u32 s12, s12, 32
    v_lshrrev_b32 v3, 4, v0
    v_add_u32 v3, s12, v3
    v_and_b32 v4, 15, v0
    s_lshl_b32 s13, s51, 6
    v_lshl_add_u32 v4, v4, 2, s13
    v_lshlrev_b32 v4, 1, v4
    s_lshl_b32 s13, s50, 6
    v_add_u32 v5, s13, v3
    v_lshl_add_u32 v5, v5, 10, v4
    v_lshlrev_b32 v3, 2, v3
    s_lshl_b32 s87, s50, 8
    s_add_u32 s87, s87, 14417920
    s_waitcnt vmcnt(7)
    v_mfma_f32_32x32x16_bf16 v[64:79], v[128:131], v[24:27], 0
    v_mfma_f32_32x32x16_bf16 v[80:95], v[132:135], v[24:27], 0
    s_waitcnt vmcnt(6)
    v_mfma_f32_32x32x16_bf16 v[96:111], v[128:131], v[28:31], 0
    v_mfma_f32_32x32x16_bf16 v[112:127], v[132:135], v[28:31], 0
    s_add_u32 s12, s35, 4096
    buffer_load_dwordx4 v[56:59], v12, s[68:71], s12 offen sc1
    buffer_load_dwordx4 v[60:63], v12, s[60:63], s12 offen sc1
    s_waitcnt vmcnt(7)
    v_mfma_f32_32x32x16_bf16 v[64:79], v[136:139], v[32:35], v[64:79]
    v_mfma_f32_32x32x16_bf16 v[80:95], v[140:143], v[32:35], v[80:95]
    s_waitcnt vmcnt(6)
    v_mfma_f32_32x32x16_bf16 v[96:111], v[136:139], v[36:39], v[96:111]
    v_mfma_f32_32x32x16_bf16 v[112:127], v[140:143], v[36:39], v[112:127]
    s_add_u32 s12, s35, 4096
    buffer_load_dwordx4 v[24:27], v12, s[68:71], s12 offen offset:1024 sc1
    buffer_load_dwordx4 v[28:31], v12, s[60:63], s12 offen offset:1024 sc1
    s_waitcnt vmcnt(7)
    v_mfma_f32_32x32x16_bf16 v[64:79], v[144:147], v[40:43], v[64:79]
    v_mfma_f32_32x32x16_bf16 v[80:95], v[148:151], v[40:43], v[80:95]
    s_waitcnt vmcnt(6)
    v_mfma_f32_32x32x16_bf16 v[96:111], v[144:147], v[44:47], v[96:111]
    v_mfma_f32_32x32x16_bf16 v[112:127], v[148:151], v[44:47], v[112:127]
    s_add_u32 s12, s35, 4096
    buffer_load_dwordx4 v[32:35], v12, s[68:71], s12 offen offset:2048 sc1
    buffer_load_dwordx4 v[36:39], v12, s[60:63], s12 offen offset:2048 sc1
    s_waitcnt vmcnt(7)
    v_mfma_f32_32x32x16_bf16 v[64:79], v[152:155], v[48:51], v[64:79]
    v_mfma_f32_32x32x16_bf16 v[80:95], v[156:159], v[48:51], v[80:95]
    s_waitcnt vmcnt(6)
    v_mfma_f32_32x32x16_bf16 v[96:111], v[152:155], v[52:55], v[96:111]
    v_mfma_f32_32x32x16_bf16 v[112:127], v[156:159], v[52:55], v[112:127]
    s_add_u32 s12, s35, 4096
    buffer_load_dwordx4 v[40:43], v12, s[68:71], s12 offen offset:3072 sc1
    buffer_load_dwordx4 v[44:47], v12, s[60:63], s12 offen offset:3072 sc1
    s_waitcnt vmcnt(7)
    v_mfma_f32_32x32x16_bf16 v[64:79], v[160:163], v[56:59], v[64:79]
    v_mfma_f32_32x32x16_bf16 v[80:95], v[164:167], v[56:59], v[80:95]
    s_waitcnt vmcnt(6)
    v_mfma_f32_32x32x16_bf16 v[96:111], v[160:163], v[60:63], v[96:111]
    v_mfma_f32_32x32x16_bf16 v[112:127], v[164:167], v[60:63], v[112:127]
    s_add_u32 s12, s35, 8192
    buffer_load_dwordx4 v[48:51], v12, s[68:71], s12 offen sc1
    buffer_load_dwordx4 v[52:55], v12, s[60:63], s12 offen sc1
    s_waitcnt vmcnt(7)
    v_mfma_f32_32x32x16_bf16 v[64:79], v[168:171], v[24:27], v[64:79]
    v_mfma_f32_32x32x16_bf16 v[80:95], v[172:175], v[24:27], v[80:95]
    s_waitcnt vmcnt(6)
    v_mfma_f32_32x32x16_bf16 v[96:111], v[168:171], v[28:31], v[96:111]
    v_mfma_f32_32x32x16_bf16 v[112:127], v[172:175], v[28:31], v[112:127]
    s_add_u32 s12, s35, 8192
    buffer_load_dwordx4 v[56:59], v12, s[68:71], s12 offen offset:1024 sc1
    buffer_load_dwordx4 v[60:63], v12, s[60:63], s12 offen offset:1024 sc1
    s_waitcnt vmcnt(7)
    v_mfma_f32_32x32x16_bf16 v[64:79], v[176:179], v[32:35], v[64:79]
    v_mfma_f32_32x32x16_bf16 v[80:95], v[180:183], v[32:35], v[80:95]
    s_waitcnt vmcnt(6)
    v_mfma_f32_32x32x16_bf16 v[96:111], v[176:179], v[36:39], v[96:111]
    v_mfma_f32_32x32x16_bf16 v[112:127], v[180:183], v[36:39], v[112:127]
    s_add_u32 s12, s35, 8192
    buffer_load_dwordx4 v[24:27], v12, s[68:71], s12 offen offset:2048 sc1
    buffer_load_dwordx4 v[28:31], v12, s[60:63], s12 offen offset:2048 sc1
    s_waitcnt vmcnt(7)
    v_mfma_f32_32x32x16_bf16 v[64:79], v[184:187], v[40:43], v[64:79]
    v_mfma_f32_32x32x16_bf16 v[80:95], v[188:191], v[40:43], v[80:95]
    s_waitcnt vmcnt(6)
    v_mfma_f32_32x32x16_bf16 v[96:111], v[184:187], v[44:47], v[96:111]
    v_mfma_f32_32x32x16_bf16 v[112:127], v[188:191], v[44:47], v[112:127]
    s_add_u32 s12, s35, 8192
    buffer_load_dwordx4 v[168:171], v12, s[68:71], s12 offen offset:3072 sc1
    buffer_load_dwordx4 v[172:175], v12, s[60:63], s12 offen offset:3072 sc1
    s_waitcnt vmcnt(7)
    v_mfma_f32_32x32x16_bf16 v[64:79], v[192:195], v[48:51], v[64:79]
    v_mfma_f32_32x32x16_bf16 v[80:95], v[196:199], v[48:51], v[80:95]
    s_waitcnt vmcnt(6)
    v_mfma_f32_32x32x16_bf16 v[96:111], v[192:195], v[52:55], v[96:111]
    v_mfma_f32_32x32x16_bf16 v[112:127], v[196:199], v[52:55], v[112:127]
    s_add_u32 s12, s35, 12288
    buffer_load_dwordx4 v[32:35], v12, s[68:71], s12 offen sc1
    buffer_load_dwordx4 v[36:39], v12, s[60:63], s12 offen sc1
    s_waitcnt vmcnt(7)
    v_mfma_f32_32x32x16_bf16 v[64:79], v[200:203], v[56:59], v[64:79]
    v_mfma_f32_32x32x16_bf16 v[80:95], v[204:207], v[56:59], v[80:95]
    s_waitcnt vmcnt(6)
    v_mfma_f32_32x32x16_bf16 v[96:111], v[200:203], v[60:63], v[96:111]
    v_mfma_f32_32x32x16_bf16 v[112:127], v[204:207], v[60:63], v[112:127]
    s_add_u32 s12, s35, 12288
    buffer_load_dwordx4 v[176:179], v12, s[68:71], s12 offen offset:1024 sc1
    buffer_load_dwordx4 v[180:183], v12, s[60:63], s12 offen offset:1024 sc1
    s_waitcnt vmcnt(7)
    v_mfma_f32_32x32x16_bf16 v[64:79], v[208:211], v[24:27], v[64:79]
    v_mfma_f32_32x32x16_bf16 v[80:95], v[212:215], v[24:27], v[80:95]
    s_waitcnt vmcnt(6)
    v_mfma_f32_32x32x16_bf16 v[96:111], v[208:211], v[28:31], v[96:111]
    v_mfma_f32_32x32x16_bf16 v[112:127], v[212:215], v[28:31], v[112:127]
    s_add_u32 s12, s35, 12288
    buffer_load_dwordx4 v[40:43], v12, s[68:71], s12 offen offset:2048 sc1
    buffer_load_dwordx4 v[44:47], v12, s[60:63], s12 offen offset:2048 sc1
    s_waitcnt vmcnt(7)
    v_mfma_f32_32x32x16_bf16 v[64:79], v[216:219], v[168:171], v[64:79]
    v_mfma_f32_32x32x16_bf16 v[80:95], v[220:223], v[168:171], v[80:95]
    s_waitcnt vmcnt(6)
    v_mfma_f32_32x32x16_bf16 v[96:111], v[216:219], v[172:175], v[96:111]
    v_mfma_f32_32x32x16_bf16 v[112:127], v[220:223], v[172:175], v[112:127]
    s_add_u32 s12, s35, 12288
    buffer_load_dwordx4 v[184:187], v12, s[68:71], s12 offen offset:3072 sc1
    buffer_load_dwordx4 v[188:191], v12, s[60:63], s12 offen offset:3072 sc1
    s_waitcnt vmcnt(7)
    v_mfma_f32_32x32x16_bf16 v[64:79], v[224:227], v[32:35], v[64:79]
    v_mfma_f32_32x32x16_bf16 v[80:95], v[228:231], v[32:35], v[80:95]
    s_waitcnt vmcnt(6)
    v_mfma_f32_32x32x16_bf16 v[96:111], v[224:227], v[36:39], v[96:111]
    v_mfma_f32_32x32x16_bf16 v[112:127], v[228:231], v[36:39], v[112:127]
    s_add_u32 s12, s35, 16384
    buffer_load_dwordx4 v[48:51], v12, s[68:71], s12 offen sc1
    buffer_load_dwordx4 v[52:55], v12, s[60:63], s12 offen sc1
    s_waitcnt vmcnt(7)
    v_mfma_f32_32x32x16_bf16 v[64:79], v[232:235], v[176:179], v[64:79]
    v_mfma_f32_32x32x16_bf16 v[80:95], v[236:239], v[176:179], v[80:95]
    s_waitcnt vmcnt(6)
    v_mfma_f32_32x32x16_bf16 v[96:111], v[232:235], v[180:183], v[96:111]
    v_mfma_f32_32x32x16_bf16 v[112:127], v[236:239], v[180:183], v[112:127]
    s_add_u32 s12, s35, 16384
    buffer_load_dwordx4 v[192:195], v12, s[68:71], s12 offen offset:1024 sc1
    buffer_load_dwordx4 v[196:199], v12, s[60:63], s12 offen offset:1024 sc1
    s_waitcnt vmcnt(7)
    v_mfma_f32_32x32x16_bf16 v[64:79], v[240:243], v[40:43], v[64:79]
    v_mfma_f32_32x32x16_bf16 v[80:95], v[244:247], v[40:43], v[80:95]
    s_waitcnt vmcnt(6)
    v_mfma_f32_32x32x16_bf16 v[96:111], v[240:243], v[44:47], v[96:111]
    v_mfma_f32_32x32x16_bf16 v[112:127], v[244:247], v[44:47], v[112:127]
    s_add_u32 s12, s35, 16384
    buffer_load_dwordx4 v[56:59], v12, s[68:71], s12 offen offset:2048 sc1
    buffer_load_dwordx4 v[60:63], v12, s[60:63], s12 offen offset:2048 sc1
    ds_read_b64_tr_b16 v[128:129], v8 offset:0
    ds_read_b64_tr_b16 v[130:131], v8 offset:1024
    ds_read_b64_tr_b16 v[132:133], v9 offset:0
    ds_read_b64_tr_b16 v[134:135], v9 offset:1024
    s_waitcnt vmcnt(7)
    v_mfma_f32_32x32x16_bf16 v[64:79], v[248:251], v[184:187], v[64:79]
    v_mfma_f32_32x32x16_bf16 v[80:95], v[252:255], v[184:187], v[80:95]
    s_waitcnt vmcnt(6)
    v_mfma_f32_32x32x16_bf16 v[96:111], v[248:251], v[188:191], v[96:111]
    v_mfma_f32_32x32x16_bf16 v[112:127], v[252:255], v[188:191], v[112:127]
    s_add_u32 s12, s35, 16384
    buffer_load_dwordx4 v[200:203], v12, s[68:71], s12 offen offset:3072 sc1
    buffer_load_dwordx4 v[204:207], v12, s[60:63], s12 offen offset:3072 sc1
    ds_read_b64_tr_b16 v[136:137], v8 offset:2048
    ds_read_b64_tr_b16 v[138:139], v8 offset:3072
    ds_read_b64_tr_b16 v[140:141], v9 offset:2048
    ds_read_b64_tr_b16 v[142:143], v9 offset:3072
    s_waitcnt vmcnt(7) lgkmcnt(4)
    v_mfma_f32_32x32x16_bf16 v[64:79], v[128:131], v[48:51], v[64:79]
    v_mfma_f32_32x32x16_bf16 v[80:95], v[132:135], v[48:51], v[80:95]
    s_waitcnt vmcnt(6)
    v_mfma_f32_32x32x16_bf16 v[96:111], v[128:131], v[52:55], v[96:111]
    v_mfma_f32_32x32x16_bf16 v[112:127], v[132:135], v[52:55], v[112:127]
    s_add_u32 s12, s35, 20480
    buffer_load_dwordx4 v[24:27], v12, s[68:71], s12 offen sc1
    buffer_load_dwordx4 v[28:31], v12, s[60:63], s12 offen sc1
    ds_read_b64_tr_b16 v[128:129], v8 offset:4096
    ds_read_b64_tr_b16 v[130:131], v8 offset:5120
    ds_read_b64_tr_b16 v[132:133], v9 offset:4096
    ds_read_b64_tr_b16 v[134:135], v9 offset:5120
    s_waitcnt vmcnt(7) lgkmcnt(4)
    v_mfma_f32_32x32x16_bf16 v[64:79], v[136:139], v[192:195], v[64:79]
    v_mfma_f32_32x32x16_bf16 v[80:95], v[140:143], v[192:195], v[80:95]
    s_waitcnt vmcnt(6)
    v_mfma_f32_32x32x16_bf16 v[96:111], v[136:139], v[196:199], v[96:111]
    v_mfma_f32_32x32x16_bf16 v[112:127], v[140:143], v[196:199], v[112:127]
    s_add_u32 s12, s35, 20480
    buffer_load_dwordx4 v[208:211], v12, s[68:71], s12 offen offset:1024 sc1
    buffer_load_dwordx4 v[212:215], v12, s[60:63], s12 offen offset:1024 sc1
    ds_read_b64_tr_b16 v[136:137], v8 offset:6144
    ds_read_b64_tr_b16 v[138:139], v8 offset:7168
    ds_read_b64_tr_b16 v[140:141], v9 offset:6144
    ds_read_b64_tr_b16 v[142:143], v9 offset:7168
    s_waitcnt vmcnt(7) lgkmcnt(4)
    v_mfma_f32_32x32x16_bf16 v[64:79], v[128:131], v[56:59], v[64:79]
    v_mfma_f32_32x32x16_bf16 v[80:95], v[132:135], v[56:59], v[80:95]
    s_waitcnt vmcnt(6)
    v_mfma_f32_32x32x16_bf16 v[96:111], v[128:131], v[60:63], v[96:111]
    v_mfma_f32_32x32x16_bf16 v[112:127], v[132:135], v[60:63], v[112:127]
    s_add_u32 s12, s35, 20480
    buffer_load_dwordx4 v[168:171], v12, s[68:71], s12 offen offset:2048 sc1
    buffer_load_dwordx4 v[172:175], v12, s[60:63], s12 offen offset:2048 sc1
    ds_read_b64_tr_b16 v[128:129], v8 offset:8192
    ds_read_b64_tr_b16 v[130:131], v8 offset:9216
    ds_read_b64_tr_b16 v[132:133], v9 offset:8192
    ds_read_b64_tr_b16 v[134:135], v9 offset:9216
    s_waitcnt vmcnt(7) lgkmcnt(4)
    v_mfma_f32_32x32x16_bf16 v[64:79], v[136:139], v[200:203], v[64:79]
    v_mfma_f32_32x32x16_bf16 v[80:95], v[140:143], v[200:203], v[80:95]
    s_waitcnt vmcnt(6)
    v_mfma_f32_32x32x16_bf16 v[96:111], v[136:139], v[204:207], v[96:111]
    v_mfma_f32_32x32x16_bf16 v[112:127], v[140:143], v[204:207], v[112:127]
    s_add_u32 s12, s35, 20480
    buffer_load_dwordx4 v[216:219], v12, s[68:71], s12 offen offset:3072 sc1
    buffer_load_dwordx4 v[220:223], v12, s[60:63], s12 offen offset:3072 sc1
    ds_read_b64_tr_b16 v[136:137], v8 offset:10240
    ds_read_b64_tr_b16 v[138:139], v8 offset:11264
    ds_read_b64_tr_b16 v[140:141], v9 offset:10240
    ds_read_b64_tr_b16 v[142:143], v9 offset:11264
    s_waitcnt vmcnt(7) lgkmcnt(4)
    v_mfma_f32_32x32x16_bf16 v[64:79], v[128:131], v[24:27], v[64:79]
    v_mfma_f32_32x32x16_bf16 v[80:95], v[132:135], v[24:27], v[80:95]
    s_waitcnt vmcnt(6)
    v_mfma_f32_32x32x16_bf16 v[96:111], v[128:131], v[28:31], v[96:111]
    v_mfma_f32_32x32x16_bf16 v[112:127], v[132:135], v[28:31], v[112:127]
    s_add_u32 s12, s35, 24576
    buffer_load_dwordx4 v[32:35], v12, s[68:71], s12 offen sc1
    buffer_load_dwordx4 v[36:39], v12, s[60:63], s12 offen sc1
    buffer_load_dword v13, v3, s[68:71], s87 offen sc1
    buffer_load_dword v14, v3, s[68:71], s87 offen offset:64 sc1
    global_load_dwordx2 v[6:7], v4, s[32:33]
    buffer_load_dwordx2 v[16:17], v5, s[52:55], 0 offen
    s_mov_b32 s12, 16384
    buffer_load_dwordx2 v[18:19], v5, s[52:55], s12 offen
    ds_read_b64_tr_b16 v[128:129], v8 offset:12288
    ds_read_b64_tr_b16 v[130:131], v8 offset:13312
    ds_read_b64_tr_b16 v[132:133], v9 offset:12288
    ds_read_b64_tr_b16 v[134:135], v9 offset:13312
    s_waitcnt vmcnt(12) lgkmcnt(4)
    v_mfma_f32_32x32x16_bf16 v[64:79], v[136:139], v[208:211], v[64:79]
    v_mfma_f32_32x32x16_bf16 v[80:95], v[140:143], v[208:211], v[80:95]
    s_waitcnt vmcnt(11)
    v_mfma_f32_32x32x16_bf16 v[96:111], v[136:139], v[212:215], v[96:111]
    v_mfma_f32_32x32x16_bf16 v[112:127], v[140:143], v[212:215], v[112:127]
    s_add_u32 s12, s35, 24576
    buffer_load_dwordx4 v[224:227], v12, s[68:71], s12 offen offset:1024 sc1
    buffer_load_dwordx4 v[228:231], v12, s[60:63], s12 offen offset:1024 sc1
    ds_read_b64_tr_b16 v[136:137], v8 offset:14336
    ds_read_b64_tr_b16 v[138:139], v8 offset:15360
    ds_read_b64_tr_b16 v[140:141], v9 offset:14336
    ds_read_b64_tr_b16 v[142:143], v9 offset:15360
    s_waitcnt vmcnt(12) lgkmcnt(4)
    v_mfma_f32_32x32x16_bf16 v[64:79], v[128:131], v[168:171], v[64:79]
    v_mfma_f32_32x32x16_bf16 v[80:95], v[132:135], v[168:171], v[80:95]
    s_waitcnt vmcnt(11)
    v_mfma_f32_32x32x16_bf16 v[96:111], v[128:131], v[172:175], v[96:111]
    v_mfma_f32_32x32x16_bf16 v[112:127], v[132:135], v[172:175], v[112:127]
    s_add_u32 s12, s35, 24576
    buffer_load_dwordx4 v[176:179], v12, s[68:71], s12 offen offset:2048 sc1
    buffer_load_dwordx4 v[180:183], v12, s[60:63], s12 offen offset:2048 sc1
    ds_read_b64_tr_b16 v[128:129], v10 offset:0
    ds_read_b64_tr_b16 v[130:131], v10 offset:1024
    ds_read_b64_tr_b16 v[132:133], v11 offset:0
    ds_read_b64_tr_b16 v[134:135], v11 offset:1024
    s_waitcnt vmcnt(12) lgkmcnt(4)
    v_mfma_f32_32x32x16_bf16 v[64:79], v[136:139], v[216:219], v[64:79]
    v_mfma_f32_32x32x16_bf16 v[80:95], v[140:143], v[216:219], v[80:95]
    s_waitcnt vmcnt(11)
    v_mfma_f32_32x32x16_bf16 v[96:111], v[136:139], v[220:223], v[96:111]
    v_mfma_f32_32x32x16_bf16 v[112:127], v[140:143], v[220:223], v[112:127]
    s_add_u32 s12, s35, 24576
    buffer_load_dwordx4 v[232:235], v12, s[68:71], s12 offen offset:3072 sc1
    buffer_load_dwordx4 v[236:239], v12, s[60:63], s12 offen offset:3072 sc1
    ds_read_b64_tr_b16 v[136:137], v10 offset:2048
    ds_read_b64_tr_b16 v[138:139], v10 offset:3072
    ds_read_b64_tr_b16 v[140:141], v11 offset:2048
    ds_read_b64_tr_b16 v[142:143], v11 offset:3072
    s_waitcnt vmcnt(12) lgkmcnt(4)
    v_mfma_f32_32x32x16_bf16 v[64:79], v[128:131], v[32:35], v[64:79]
    v_mfma_f32_32x32x16_bf16 v[80:95], v[132:135], v[32:35], v[80:95]
    s_waitcnt vmcnt(11)
    v_mfma_f32_32x32x16_bf16 v[96:111], v[128:131], v[36:39], v[96:111]
    v_mfma_f32_32x32x16_bf16 v[112:127], v[132:135], v[36:39], v[112:127]
    ds_read_b64_tr_b16 v[128:129], v10 offset:4096
    ds_read_b64_tr_b16 v[130:131], v10 offset:5120
    ds_read_b64_tr_b16 v[132:133], v11 offset:4096
    ds_read_b64_tr_b16 v[134:135], v11 offset:5120
    s_waitcnt vmcnt(5) lgkmcnt(4)
    v_mfma_f32_32x32x16_bf16 v[64:79], v[136:139], v[224:227], v[64:79]
    v_mfma_f32_32x32x16_bf16 v[80:95], v[140:143], v[224:227], v[80:95]
    s_waitcnt vmcnt(4)
    v_mfma_f32_32x32x16_bf16 v[96:111], v[136:139], v[228:231], v[96:111]
    v_mfma_f32_32x32x16_bf16 v[112:127], v[140:143], v[228:231], v[112:127]
    v_and_b32 v161, 31, v0
    v_lshrrev_b32 v162, 5, v0
    v_and_b32 v163, 7, v0
    v_xor_b32 v162, v162, v163
    v_lshlrev_b32 v162, 4, v162
    v_lshl_add_u32 v161, v161, 8, v162
    v_add_u32 v160, s94, v161
    v_xor_b32 v161, 32, v160
    v_xor_b32 v162, 64, v160
    v_xor_b32 v163, 96, v160
    v_lshrrev_b32 v164, 4, v0
    v_and_b32 v165, 15, v0
    v_xor_b32 v165, v165, v164
    v_lshlrev_b32 v165, 4, v165
    v_lshl_add_u32 v164, v164, 8, v165
    s_lshl_b32 s12, s3, 11
    v_add_u32 v164, s12, v164
    v_xor_b32 v165, 64, v164
    v_add_u32 v165, 1024, v165
    v_add_u32 v166, 65536, v164
    v_add_u32 v167, 65536, v165
    v_lshlrev_b32 v5, 1, v5
    v_lshlrev_b32 v152, 16, v6
    v_and_b32 v153, 0xffff0000, v6
    v_lshlrev_b32 v154, 16, v7
    v_and_b32 v155, 0xffff0000, v7
    v_lshlrev_b32 v144, 16, v16
    v_and_b32 v145, 0xffff0000, v16
    v_lshlrev_b32 v146, 16, v17
    v_and_b32 v147, 0xffff0000, v17
    v_mul_f32 v144, v144, v152
    v_mul_f32 v145, v145, v153
    v_mul_f32 v146, v146, v154
    v_mul_f32 v147, v147, v155
    v_cvt_pk_bf16_f32 v156, v144, v145
    v_lshlrev_b32 v144, 16, v156
    v_and_b32 v145, 0xffff0000, v156
    v_cvt_pk_bf16_f32 v156, v146, v147
    v_lshlrev_b32 v146, 16, v156
    v_and_b32 v147, 0xffff0000, v156
    v_sub_f32 v157, 1.0, v13
    v_cvt_pk_bf16_f32 v157, v157, v157
    v_lshlrev_b32 v157, 16, v157
    v_lshlrev_b32 v148, 16, v18
    v_and_b32 v149, 0xffff0000, v18
    v_lshlrev_b32 v150, 16, v19
    v_and_b32 v151, 0xffff0000, v19
    v_mul_f32 v148, v148, v152
    v_mul_f32 v149, v149, v153
    v_mul_f32 v150, v150, v154
    v_mul_f32 v151, v151, v155
    v_cvt_pk_bf16_f32 v156, v148, v149
    v_lshlrev_b32 v148, 16, v156
    v_and_b32 v149, 0xffff0000, v156
    v_cvt_pk_bf16_f32 v156, v150, v151
    v_lshlrev_b32 v150, 16, v156
    v_and_b32 v151, 0xffff0000, v156
    v_sub_f32 v158, 1.0, v14
    v_cvt_pk_bf16_f32 v158, v158, v158
    v_lshlrev_b32 v158, 16, v158
    ds_read_b64_tr_b16 v[136:137], v10 offset:6144
    ds_read_b64_tr_b16 v[138:139], v10 offset:7168
    ds_read_b64_tr_b16 v[140:141], v11 offset:6144
    ds_read_b64_tr_b16 v[142:143], v11 offset:7168
    s_waitcnt vmcnt(3) lgkmcnt(4)
    v_mfma_f32_32x32x16_bf16 v[64:79], v[128:131], v[176:179], v[64:79]
    v_mfma_f32_32x32x16_bf16 v[80:95], v[132:135], v[176:179], v[80:95]
    s_waitcnt vmcnt(2)
    v_mfma_f32_32x32x16_bf16 v[96:111], v[128:131], v[180:183], v[96:111]
    v_mfma_f32_32x32x16_bf16 v[112:127], v[132:135], v[180:183], v[112:127]
    s_waitcnt vmcnt(1) lgkmcnt(0)
    v_mfma_f32_32x32x16_bf16 v[64:79], v[136:139], v[232:235], v[64:79]
    v_mfma_f32_32x32x16_bf16 v[80:95], v[140:143], v[232:235], v[80:95]
    s_waitcnt vmcnt(0)
    v_mfma_f32_32x32x16_bf16 v[96:111], v[136:139], v[236:239], v[96:111]
    v_mfma_f32_32x32x16_bf16 v[112:127], v[140:143], v[236:239], v[112:127]
    s_nop 9
    ds_write_b128 v160, v[64:67] offset:0
    ds_write_b128 v161, v[68:71] offset:0
    ds_write_b128 v162, v[72:75] offset:0
    ds_write_b128 v163, v[76:79] offset:0
    ds_write_b128 v160, v[80:83] offset:128
    ds_write_b128 v161, v[84:87] offset:128
    ds_write_b128 v162, v[88:91] offset:128
    ds_write_b128 v163, v[92:95] offset:128
    ds_write_b128 v160, v[96:99] offset:8192
    ds_write_b128 v161, v[100:103] offset:8192
    ds_write_b128 v162, v[104:107] offset:8192
    ds_write_b128 v163, v[108:111] offset:8192
    ds_write_b128 v160, v[112:115] offset:8320
    ds_write_b128 v161, v[116:119] offset:8320
    ds_write_b128 v162, v[120:123] offset:8320
    ds_write_b128 v163, v[124:127] offset:8320
    s_waitcnt lgkmcnt(0)
    s_barrier
    ds_read_b128 v[64:67], v164 offset:0
    ds_read_b128 v[68:71], v165 offset:0
    ds_read_b128 v[72:75], v164 offset:16384
    ds_read_b128 v[76:79], v165 offset:16384
    ds_read_b128 v[80:83], v164 offset:32768
    ds_read_b128 v[84:87], v165 offset:32768
    ds_read_b128 v[88:91], v164 offset:49152
    ds_read_b128 v[92:95], v165 offset:49152
    ds_read_b128 v[96:99], v166 offset:0
    ds_read_b128 v[100:103], v167 offset:0
    ds_read_b128 v[104:107], v166 offset:16384
    ds_read_b128 v[108:111], v167 offset:16384
    ds_read_b128 v[112:115], v166 offset:32768
    ds_read_b128 v[116:119], v167 offset:32768
    ds_read_b128 v[120:123], v166 offset:49152
    ds_read_b128 v[124:127], v167 offset:49152
    s_waitcnt lgkmcnt(14)
    v_pk_add_f32 v[144:145], v[144:145], v[64:65]
    v_pk_add_f32 v[146:147], v[146:147], v[66:67]
    v_pk_add_f32 v[148:149], v[148:149], v[68:69]
    v_pk_add_f32 v[150:151], v[150:151], v[70:71]
    s_waitcnt lgkmcnt(12)
    v_pk_add_f32 v[144:145], v[144:145], v[72:73]
    v_pk_add_f32 v[146:147], v[146:147], v[74:75]
    v_pk_add_f32 v[148:149], v[148:149], v[76:77]
    v_pk_add_f32 v[150:151], v[150:151], v[78:79]
    s_waitcnt lgkmcnt(10)
    v_pk_add_f32 v[144:145], v[144:145], v[80:81]
    v_pk_add_f32 v[146:147], v[146:147], v[82:83]
    v_pk_add_f32 v[148:149], v[148:149], v[84:85]
    v_pk_add_f32 v[150:151], v[150:151], v[86:87]
    s_waitcnt lgkmcnt(8)
    v_pk_add_f32 v[144:145], v[144:145], v[88:89]
    v_pk_add_f32 v[146:147], v[146:147], v[90:91]
    v_pk_add_f32 v[148:149], v[148:149], v[92:93]
    v_pk_add_f32 v[150:151], v[150:151], v[94:95]
    v_mul_f32 v144, v13, v144
    v_mul_f32 v145, v13, v145
    v_mul_f32 v146, v13, v146
    v_mul_f32 v147, v13, v147
    v_mul_f32 v148, v14, v148
    v_mul_f32 v149, v14, v149
    v_mul_f32 v150, v14, v150
    v_mul_f32 v151, v14, v151
    s_waitcnt lgkmcnt(4)
    v_pk_add_f32 v[40:41], v[96:97], v[104:105]
    v_pk_add_f32 v[42:43], v[98:99], v[106:107]
    v_pk_add_f32 v[44:45], v[100:101], v[108:109]
    v_pk_add_f32 v[46:47], v[102:103], v[110:111]
    s_waitcnt lgkmcnt(0)
    v_pk_add_f32 v[112:113], v[112:113], v[120:121]
    v_pk_add_f32 v[114:115], v[114:115], v[122:123]
    v_pk_add_f32 v[116:117], v[116:117], v[124:125]
    v_pk_add_f32 v[118:119], v[118:119], v[126:127]
    v_pk_add_f32 v[40:41], v[40:41], v[112:113]
    v_pk_add_f32 v[42:43], v[42:43], v[114:115]
    v_pk_add_f32 v[44:45], v[44:45], v[116:117]
    v_pk_add_f32 v[46:47], v[46:47], v[118:119]
    v_fmac_f32 v144, v157, v40
    v_fmac_f32 v145, v157, v41
    v_fmac_f32 v146, v157, v42
    v_fmac_f32 v147, v157, v43
    v_fmac_f32 v148, v158, v44
    v_fmac_f32 v149, v158, v45
    v_fmac_f32 v150, v158, v46
    v_fmac_f32 v151, v158, v47
    buffer_store_dwordx4 v[144:147], v5, s[64:67], 0 offen sc1
    s_mov_b32 s12, 32768
    buffer_store_dwordx4 v[148:151], v5, s[64:67], s12 offen sc1
    s_endpgm
L_exit:
    s_endpgm
L_code_end:
.section .rodata,"a"
.p2align 6
.amdhsa_kernel gated_mix__ssm_conv_s5__swiglu_ffn__prompt_kernel
  .amdhsa_next_free_vgpr 256
  .amdhsa_next_free_sgpr 102
  .amdhsa_accum_offset 256
  .amdhsa_group_segment_fixed_size 0
  .amdhsa_kernarg_size 136
  .amdhsa_user_sgpr_count 2
  .amdhsa_user_sgpr_kernarg_segment_ptr 1
  .amdhsa_system_sgpr_workgroup_id_x 1
  .amdhsa_float_denorm_mode_32 3
  .amdhsa_float_denorm_mode_16_64 3
.end_amdhsa_kernel
```
